```python
import torch

def _softmax(x, axis=-1):
    return torch.softmax(x, dim=axis)
def _gelu(x):
    return torch.nn.functional.gelu(x, approximate="tanh")
def _silu(x):
    return torch.nn.functional.silu(x)
def _sigmoid(x):
    return torch.sigmoid(x)
def _layernorm(x, axis=-1, eps=1e-5):
    m = x.mean(dim=axis, keepdim=True)
    v = x.var(dim=axis, keepdim=True, unbiased=False)
    return (x - m) / torch.sqrt(v + eps)
def _scatter_add(tgt, idx, src, axis=0):
    return tgt.clone().index_add_(axis, idx, src)
def _segment_sum(src, seg, n):
    out = torch.zeros((n,) + src.shape[1:], dtype=src.dtype)
    return out.index_add_(0, seg, src)
def _pad(x, pw):
    flat = tuple(v for pair in reversed(pw) for v in pair)
    return torch.nn.functional.pad(x, flat)

kernel_name = 'interleave_layers__ssm_conv_h3__dense_activation_squared_relu__prompt'

def setup_inputs():

    _w = (lambda a: (lambda t: t.to(torch.bfloat16) if t.is_floating_point() else t)(torch.as_tensor(a)))
    def _A_setup():
        B, S, D = 1, 2048, 512
        ks = 4
        return {
            "q": _w((lambda *s: torch.randn(*s, dtype=torch.bfloat16) * 0.05)(B, S, D)),
            "k": _w((lambda *s: torch.randn(*s, dtype=torch.bfloat16) * 0.8)(B, S, D)),
            "v": _w((lambda *s: torch.randn(*s, dtype=torch.bfloat16) * 0.8)(B, S, D)),
            "shift_k": _w((lambda *s: torch.randn(*s, dtype=torch.bfloat16) * 0.8)(D, ks) * 0.5),
            "ssm_k": _w((lambda *s: torch.randn(*s, dtype=torch.bfloat16) * 0.8)(D, S) * (1.0 / S ** 0.5)),
            "ssm_D": _w((lambda *s: torch.randn(*s, dtype=torch.bfloat16) * 0.8)(D)),
        }
    _A_in = _A_setup()

    def _B_setup():
        B, S, D, F = 1, 2048, 512, 1792
        return {
            "x": _w((lambda *s: torch.randn(*s, dtype=torch.bfloat16) * 0.05)(B, S, D)),
            "w1": _w((lambda *s: torch.randn(*s, dtype=torch.bfloat16) * 0.05)(D, F)),
            "b1": _w((lambda *s: torch.randn(*s, dtype=torch.bfloat16) * 0.4)(F)),
            "w2": _w((lambda *s: torch.randn(*s, dtype=torch.bfloat16) * 0.05)(F, D)),
            "b2": _w((lambda *s: torch.randn(*s, dtype=torch.bfloat16) * 1.6)(D)),
        }
    _B_in = _B_setup()

    return {
        "A_q": _A_in["q"],
        "A_k": _A_in["k"],
        "A_v": _A_in["v"],
        "A_shift_k": _A_in["shift_k"],
        "A_ssm_k": _A_in["ssm_k"],
        "A_ssm_D": _A_in["ssm_D"],
        "B_x": _B_in["x"],
        "B_w1": _B_in["w1"],
        "B_b1": _B_in["b1"],
        "B_w2": _B_in["w2"],
        "B_b2": _B_in["b2"],
    }

def reference(A_q, A_k, A_v, A_shift_k, A_ssm_k, A_ssm_D, B_x, B_w1, B_b1, B_w2, B_b2):
    def _A_ref(q, k, v, shift_k, ssm_k, ssm_D):
        B, S, D = q.shape
        ks = shift_k.shape[-1]
        k_pad = _pad(k, ((0, 0), (ks - 1, 0), (0, 0)))
        k_shift = torch.zeros_like(k)
        for t in range(ks):
            k_shift = k_shift + k_pad[:, t:t + S, :] * shift_k[:, ks - 1 - t][None, None, :]
        kv = k_shift * v
        L = 2 * S
        kv_pad = _pad(kv, ((0, 0), (0, S), (0, 0)))
        kf_pad = _pad(ssm_k, ((0, 0), (0, S)))
        kv_f = (lambda x, axes=(-2,-1): torch.fft.rfft2(x.float(), dim=axes))(kv_pad[:, None, :, :], axes=(1, 2))
        kf_f = (lambda x, axes=(-2,-1): torch.fft.rfft2(x.float(), dim=axes))(kf_pad[:, None, :], axes=(1, 2))
        kf_f = (lambda x, *d: x.permute(*d))(kf_f, 1, 2, 0)
        y_f = kv_f * kf_f[None, :, :, :]
        y = (lambda x, s, axes=(-2,-1): torch.fft.irfft2(x, s=s, dim=axes).to(torch.bfloat16))(y_f, (1, L), axes=(1, 2))[:, 0, :S, :]
        y = y + kv * ssm_D[None, None, :]
        return q * y

    def _B_ref(x, w1, b1, w2, b2):
        h = torch.einsum("bsd,df->bsf", x, w1) + b1
        zero = torch.zeros_like(h)
        r = torch.where(h > zero, h, zero)
        h = r * r
        out = torch.einsum("bsf,fd->bsd", h, w2) + b2
        return out

    x = A_q
    x = x + _A_ref(_layernorm(x, axis=-1), A_k, A_v, A_shift_k, A_ssm_k, A_ssm_D)
    x = x + _B_ref(_layernorm(x, axis=-1), B_w1, B_b1, B_w2, B_b2)
    x = x + _A_ref(_layernorm(x, axis=-1), A_k, A_v, A_shift_k, A_ssm_k, A_ssm_D)
    x = x + _B_ref(_layernorm(x, axis=-1), B_w1, B_b1, B_w2, B_b2)
    return x
```

```asm
; @launch grid=(256,1,1) block=(256,1,1) lds=163840
.amdgcn_target "amdgcn-amd-amdhsa--gfx950"
.text
.globl interleave_layers__ssm_conv_h3__dense_activation_squared_relu__prompt_kernel
.p2align 8
.type interleave_layers__ssm_conv_h3__dense_activation_squared_relu__prompt_kernel,@function
interleave_layers__ssm_conv_h3__dense_activation_squared_relu__prompt_kernel:
    s_cmp_ge_u32 s2, 256
    s_cbranch_scc1 K_END
    s_load_dwordx2 s[52:53], s[0:1], 104
    s_load_dwordx16 s[80:95], s[0:1], 0
    s_load_dwordx4 s[96:99], s[0:1], 64
    s_load_dwordx2 s[60:61], s[0:1], 80
    s_load_dwordx2 s[56:57], s[0:1], 88
    s_cmp_ge_u32 s2, 64
    s_cbranch_scc1 K_NOPF
    s_getpc_b64 s[64:65]
K_PC:
    s_and_b32 s65, s65, 0xffff
    s_mov_b32 s66, K_FAST_END-K_PC
    s_mov_b32 s67, 0x20000
    v_lshlrev_b32 v227, 7, v0
    s_and_b32 s26, s2, 8
    s_lshl_b32 s26, s26, 12
    buffer_load_dword v227, v227, s[64:67], s26 offen
K_NOPF:
    v_lshrrev_b32 v1, 6, v0
    v_and_b32 v2, 63, v0
    s_getreg_b32 s42, hwreg(HW_REG_XCC_ID)
    v_readfirstlane_b32 s18, v1
    s_and_b32 s21, s2, 7
    s_lshr_b32 s27, s2, 3
    s_lshl_b32 s16, s21, 1
    s_lshr_b32 s26, s27, 4
    s_add_u32 s16, s16, s26
    s_and_b32 s17, s27, 15
    s_lshr_b32 s19, s17, 3
    s_and_b32 s20, s17, 7
    s_lshr_b32 s22, s18, 1
    s_and_b32 s23, s18, 1
    s_and_b32 s42, s42, 15
    s_add_u32 s42, s42, 1
    s_lshl_b32 s44, s21, 5
    s_add_u32 s44, s44, s27
    s_lshl_b32 s45, s44, 13
    s_mov_b32 s67, 0x20000
    v_mov_b32 v14, 0x7fffffff
    v_mov_b32 v17, 0
    v_and_b32 v10, 7, v2
    v_lshrrev_b32 v11, 3, v2
    s_lshl_b32 s24, s27, 1
    s_add_u32 s24, s24, s23
    s_lshl_b32 s24, s24, 5
    v_lshlrev_b32 v12, 12, v10
    v_lshl_add_u32 v12, v11, 4, v12
    s_lshl_b32 s26, s24, 10
    s_lshl_b32 s29, s21, 7
    s_add_u32 s26, s26, s29
    v_add_u32 v12, s26, v12
    v_subrev_u32 v13, 0xc00, v12
    s_lshl_b32 s41, s16, 10
    s_add_u32 s41, s41, 0x808000
    s_lshl_b32 s12, s16, 2
    s_add_u32 s12, s12, s18
    s_lshl_b32 s3, s16, 1
    s_add_u32 s3, s3, s19
    s_lshl_b32 s6, s3, 1
    s_add_u32 s6, s6, s22
    s_lshl_b32 s15, s21, 10
    s_add_u32 s15, s15, 0x80c000
    s_lshl_b32 s14, s22, 5
    s_add_u32 s14, s14, s27
    s_lshl_b32 s14, s14, 1
    s_add_u32 s14, s14, s23
    s_lshl_b32 s14, s14, 3
    s_add_u32 s14, s14, s15
    s_lshl_b32 s74, s22, 4
    s_add_u32 s74, s74, s17
    s_lshl_b32 s74, s74, 1
    s_add_u32 s74, s74, s23
    s_lshl_b32 s74, s74, 2
    s_add_u32 s74, s74, s41
    s_and_b32 s68, s6, 3
    s_lshl_b32 s68, s68, 3
    s_add_u32 s68, s68, s20
    s_lshl_b32 s68, s68, 1
    s_add_u32 s68, s68, s23
    s_lshl_b32 s68, s68, 2
    s_add_u32 s68, s68, s41
    s_lshl_b32 s7, s6, 11
    s_lshl_b32 s32, s23, 9
    s_add_u32 s7, s7, s32
    s_add_u32 s7, s7, 0x880000
    v_lshrrev_b32 v4, 4, v2
    v_lshlrev_b32 v19, 2, v2
    v_mov_b32 v22, -1
    s_lshl_b32 s32, s16, 4
    s_add_u32 s32, s32, s17
    s_lshl_b32 s32, s32, 1
    s_add_u32 s32, s32, s23
    s_lshl_b32 s32, s32, 8
    s_add_u32 s32, s32, 0x880000
    s_lshl_b32 s26, s17, 1
    s_add_u32 s26, s26, s23
    s_lshl_b32 s33, s26, 8
    s_add_u32 s33, s33, s41
    s_cmp_lt_u32 s26, 3
    s_cselect_b32 s33, s33, 0x2000000
    v_and_b32 v3, 15, v0
    v_lshlrev_b32 v16, 4, v2
    v_lshlrev_b32 v234, 15, v11
    v_lshl_add_u32 v234, v10, 4, v234
    s_lshl_b32 s26, s21, 18
    s_lshl_b32 s29, s24, 2
    s_add_u32 s26, s26, s29
    v_add_u32 v234, s26, v234
    v_add_u32 v18, 162304, v19
    ds_write_b32 v18, v17
    s_waitcnt lgkmcnt(0)
    s_barrier
    s_add_u32 s50, s52, 0x80f000
    s_addc_u32 s51, s53, 0
    s_load_dwordx2 s[48:49], s[50:51], 0
    s_and_b32 s53, s53, 0xffff
    s_mov_b32 s54, 0x2000000
    s_mov_b32 s55, 0x20000
    s_cmp_ge_u32 s18, 2
    s_cbranch_scc1 K_ROLEB
    s_mov_b32 s64, s82
    s_and_b32 s65, s83, 0xffff
    s_mov_b32 s66, 0x200000
    buffer_load_dwordx4 v[24:27], v13, s[64:67], 0 offen offset:0 nt
    s_mov_b32 s64, s86
    s_and_b32 s65, s87, 0xffff
    s_mov_b32 s66, 0x1000
    v_lshlrev_b32 v20, 6, v11
    s_lshl_b32 s26, s21, 9
    buffer_load_dwordx4 v[68:71], v20, s[64:67], s26 offen offset:0
    buffer_load_dwordx4 v[72:75], v20, s[64:67], s26 offen offset:16
    buffer_load_dwordx4 v[76:79], v20, s[64:67], s26 offen offset:32
    buffer_load_dwordx4 v[80:83], v20, s[64:67], s26 offen offset:48
    s_mov_b32 s64, s82
    s_and_b32 s65, s83, 0xffff
    s_mov_b32 s66, 0x200000
    buffer_load_dwordx4 v[28:31], v13, s[64:67], 0 offen offset:1024 nt
    buffer_load_dwordx4 v[32:35], v13, s[64:67], 0 offen offset:2048 nt
    buffer_load_dwordx4 v[36:39], v12, s[64:67], 0 offen offset:0 nt
    buffer_load_dwordx4 v[40:43], v12, s[64:67], 0 offen offset:1024 nt
    buffer_load_dwordx4 v[44:47], v12, s[64:67], 0 offen offset:2048 nt
    buffer_load_dwordx4 v[48:51], v12, s[64:67], 0 offen offset:3072 nt
    s_mov_b32 s64, s84
    s_and_b32 s65, s85, 0xffff
    s_mov_b32 s66, 0x200000
    buffer_load_dwordx4 v[52:55], v12, s[64:67], 0 offen offset:0 nt
    buffer_load_dwordx4 v[56:59], v12, s[64:67], 0 offen offset:1024 nt
    buffer_load_dwordx4 v[60:63], v12, s[64:67], 0 offen offset:2048 nt
    buffer_load_dwordx4 v[64:67], v12, s[64:67], 0 offen offset:3072 nt
    buffer_load_dword v228, v16, s[52:55], s15 offen
    v_add_u32 v18, s33, v19
    buffer_store_dword v17, v18, s[52:55], 0 offen sc0 sc1
    buffer_store_dword v22, v19, s[52:55], s32 offen sc0 sc1
    s_add_u32 s32, s32, 0x20000
    buffer_store_dword v22, v19, s[52:55], s32 offen sc0 sc1
    s_add_u32 s32, s32, 0x20000
    buffer_store_dword v22, v19, s[52:55], s32 offen sc0 sc1
    s_add_u32 s32, s32, 0x20000
    buffer_store_dword v22, v19, s[52:55], s32 offen sc0 sc1
    s_lshl_b32 s26, s6, 5
    s_lshl_b32 s32, s23, 4
    s_add_u32 s26, s26, s32
    v_lshl_add_u32 v9, v11, 1, s26
    v_lshlrev_b32 v5, 10, v9
    v_lshl_add_u32 v5, v10, 4, v5
    v_accvgpr_write_b32 a255, v5
    s_mov_b32 s64, s80
    s_and_b32 s65, s81, 0xffff
    s_mov_b32 s66, 0x200000
    s_lshl_b32 s26, s20, 7
    buffer_load_dwordx4 a[224:227], v5, s[64:67], s26 offen offset:0 nt
    buffer_load_dwordx4 a[228:231], v5, s[64:67], s26 offen offset:1024 nt
    v_lshlrev_b32 v5, 15, v10
    v_lshl_add_u32 v9, v9, 1, v5
    s_and_b32 s57, s57, 0xffff
    s_mov_b32 s58, 0x200000
    s_mov_b32 s59, 0x20000
    s_and_b32 s61, s61, 0xffff
    s_mov_b32 s62, 0x400
    s_mov_b32 s63, 0x20000
    s_lshl_b32 s30, s21, 7
    s_add_u32 s30, s30, s27
    s_lshl_b32 s30, s30, 1
    s_add_u32 s30, s30, s23
    s_lshl_b32 s30, s30, 3
    s_add_u32 s30, s30, 0x800000
    v_lshlrev_b32 v8, 5, v3
    v_lshl_add_u32 v8, v4, 3, v8
    s_mov_b32 s78, 0x05040100
    s_mov_b32 s79, 0x07060302
    v_and_b32 v5, 1, v3
    v_cmp_eq_u32 vcc, 1, v5
    v_mov_b32 v6, 123508
    v_mov_b32 v7, 119346
    v_cndmask_b32 v5, v6, v7, vcc
    v_lshl_add_u32 v5, v3, 1, v5
    v_lshlrev_b32 v6, 4, v4
    v_sub_u32 v5, v5, v6
    s_mul_i32 s26, s23, 12928
    v_add_u32 v18, s26, v5
    v_add_u32 v19, 1024, v18
    v_add_u32 v20, 2048, v18
    v_add_u32 v21, 3072, v18
    s_mul_i32 s26, s23, 12928
    s_add_u32 s26, s26, 115216
    v_lshlrev_b32 v22, 5, v3
    v_lshl_add_u32 v22, v4, 4, v22
    v_sub_u32 v22, s26, v22
    v_cmp_eq_u32 vcc, 0, v2
    v_lshlrev_b32 v230, 3, v2
    v_and_b32 v229, 56, v230
    v_cndmask_b32 v222, v14, 0, vcc
    v_and_b32 v231, 0xf8, v230
    s_lshl_b32 s47, s21, 8
    s_add_u32 s47, s47, 0x80e400
    v_mov_b32 v188, 0
    v_mov_b32 v189, 0
    v_mov_b32 v190, 0
    v_mov_b32 v191, 0
    s_mul_i32 s26, s18, 12928
    s_add_u32 s26, s26, 118272
    v_max_u32 v5, 512, v16
    v_add_u32 v5, s26, v5
    ds_write_b128 v5, v[188:191]
    v_mov_b32 v7, 0x3f803f80
    s_mul_i32 s26, s18, 12928
    s_add_u32 s26, s26, 115192
    v_sub_u32 v23, s26, v230
    s_cmp_eq_u32 s18, 0
    s_cselect_b32 s78, s78, s79
    s_waitcnt vmcnt(18)
    v_lshlrev_b32 v84, 16, v68
    v_lshlrev_b32 v85, 16, v70
    v_and_b32 v86, 0xffff0000, v68
    v_and_b32 v87, 0xffff0000, v70
    v_lshlrev_b32 v88, 16, v69
    v_lshlrev_b32 v89, 16, v71
    v_and_b32 v90, 0xffff0000, v69
    v_and_b32 v91, 0xffff0000, v71
    v_lshlrev_b32 v92, 16, v72
    v_lshlrev_b32 v93, 16, v74
    v_and_b32 v94, 0xffff0000, v72
    v_and_b32 v95, 0xffff0000, v74
    v_lshlrev_b32 v96, 16, v73
    v_lshlrev_b32 v97, 16, v75
    v_and_b32 v98, 0xffff0000, v73
    v_and_b32 v99, 0xffff0000, v75
    v_lshlrev_b32 v100, 16, v76
    v_lshlrev_b32 v101, 16, v78
    v_and_b32 v102, 0xffff0000, v76
    v_and_b32 v103, 0xffff0000, v78
    v_lshlrev_b32 v104, 16, v77
    v_lshlrev_b32 v105, 16, v79
    v_and_b32 v106, 0xffff0000, v77
    v_and_b32 v107, 0xffff0000, v79
    v_lshlrev_b32 v108, 16, v80
    v_lshlrev_b32 v109, 16, v82
    v_and_b32 v110, 0xffff0000, v80
    v_and_b32 v111, 0xffff0000, v82
    v_lshlrev_b32 v112, 16, v81
    v_lshlrev_b32 v113, 16, v83
    v_and_b32 v114, 0xffff0000, v81
    v_and_b32 v115, 0xffff0000, v83
    v_lshlrev_b32 v116, 16, v24
    v_and_b32 v117, 0xffff0000, v24
    v_lshlrev_b32 v118, 16, v25
    v_and_b32 v119, 0xffff0000, v25
    v_lshlrev_b32 v120, 16, v26
    v_and_b32 v121, 0xffff0000, v26
    v_lshlrev_b32 v122, 16, v27
    v_and_b32 v123, 0xffff0000, v27
    s_waitcnt vmcnt(17)
    v_lshlrev_b32 v124, 16, v28
    v_and_b32 v125, 0xffff0000, v28
    v_lshlrev_b32 v126, 16, v29
    v_and_b32 v127, 0xffff0000, v29
    v_lshlrev_b32 v128, 16, v30
    v_and_b32 v129, 0xffff0000, v30
    v_lshlrev_b32 v130, 16, v31
    v_and_b32 v131, 0xffff0000, v31
    s_waitcnt vmcnt(16)
    v_lshlrev_b32 v132, 16, v32
    v_and_b32 v133, 0xffff0000, v32
    v_lshlrev_b32 v134, 16, v33
    v_and_b32 v135, 0xffff0000, v33
    v_lshlrev_b32 v136, 16, v34
    v_and_b32 v137, 0xffff0000, v34
    v_lshlrev_b32 v138, 16, v35
    v_and_b32 v139, 0xffff0000, v35
    s_waitcnt vmcnt(15)
    v_lshlrev_b32 v140, 16, v36
    v_and_b32 v141, 0xffff0000, v36
    v_lshlrev_b32 v142, 16, v37
    v_and_b32 v143, 0xffff0000, v37
    v_lshlrev_b32 v144, 16, v38
    v_and_b32 v145, 0xffff0000, v38
    v_lshlrev_b32 v146, 16, v39
    v_and_b32 v147, 0xffff0000, v39
    v_pk_mul_f32 v[188:189], v[116:117], v[90:91]
    v_pk_mul_f32 v[190:191], v[118:119], v[98:99]
    v_pk_mul_f32 v[192:193], v[120:121], v[106:107]
    v_pk_mul_f32 v[194:195], v[122:123], v[114:115]
    v_pk_mul_f32 v[196:197], v[124:125], v[88:89]
    v_pk_mul_f32 v[198:199], v[126:127], v[96:97]
    v_pk_mul_f32 v[200:201], v[128:129], v[104:105]
    v_pk_mul_f32 v[202:203], v[130:131], v[112:113]
    v_cvt_pk_bf16_f32 v204, v188, v196
    v_cvt_pk_bf16_f32 v205, v189, v197
    v_cvt_pk_bf16_f32 v206, v190, v198
    v_cvt_pk_bf16_f32 v207, v191, v199
    v_cvt_pk_bf16_f32 v208, v192, v200
    v_cvt_pk_bf16_f32 v209, v193, v201
    v_cvt_pk_bf16_f32 v210, v194, v202
    v_cvt_pk_bf16_f32 v211, v195, v203
    v_dot2_f32_bf16 v188, v204, v7, 0
    v_dot2_f32_bf16 v189, v205, v7, 0
    v_dot2_f32_bf16 v190, v206, v7, 0
    v_dot2_f32_bf16 v191, v207, v7, 0
    v_dot2_f32_bf16 v192, v208, v7, 0
    v_dot2_f32_bf16 v193, v209, v7, 0
    v_dot2_f32_bf16 v194, v210, v7, 0
    v_dot2_f32_bf16 v195, v211, v7, 0
    v_pk_mul_f32 v[196:197], v[132:133], v[86:87]
    v_pk_mul_f32 v[198:199], v[134:135], v[94:95]
    v_pk_mul_f32 v[200:201], v[136:137], v[102:103]
    v_pk_mul_f32 v[202:203], v[138:139], v[110:111]
    v_cvt_pk_bf16_f32 v204, v188, v196
    v_cvt_pk_bf16_f32 v205, v189, v197
    v_cvt_pk_bf16_f32 v206, v190, v198
    v_cvt_pk_bf16_f32 v207, v191, v199
    v_cvt_pk_bf16_f32 v208, v192, v200
    v_cvt_pk_bf16_f32 v209, v193, v201
    v_cvt_pk_bf16_f32 v210, v194, v202
    v_cvt_pk_bf16_f32 v211, v195, v203
    v_dot2_f32_bf16 v188, v204, v7, 0
    v_dot2_f32_bf16 v189, v205, v7, 0
    v_dot2_f32_bf16 v190, v206, v7, 0
    v_dot2_f32_bf16 v191, v207, v7, 0
    v_dot2_f32_bf16 v192, v208, v7, 0
    v_dot2_f32_bf16 v193, v209, v7, 0
    v_dot2_f32_bf16 v194, v210, v7, 0
    v_dot2_f32_bf16 v195, v211, v7, 0
    v_pk_mul_f32 v[196:197], v[140:141], v[84:85]
    v_pk_mul_f32 v[198:199], v[142:143], v[92:93]
    v_pk_mul_f32 v[200:201], v[144:145], v[100:101]
    v_pk_mul_f32 v[202:203], v[146:147], v[108:109]
    v_cvt_pk_bf16_f32 v204, v188, v196
    v_cvt_pk_bf16_f32 v205, v189, v197
    v_cvt_pk_bf16_f32 v206, v190, v198
    v_cvt_pk_bf16_f32 v207, v191, v199
    v_cvt_pk_bf16_f32 v208, v192, v200
    v_cvt_pk_bf16_f32 v209, v193, v201
    v_cvt_pk_bf16_f32 v210, v194, v202
    v_cvt_pk_bf16_f32 v211, v195, v203
    v_dot2_f32_bf16 v188, v204, v7, 0
    v_dot2_f32_bf16 v189, v205, v7, 0
    v_dot2_f32_bf16 v190, v206, v7, 0
    v_dot2_f32_bf16 v191, v207, v7, 0
    v_dot2_f32_bf16 v192, v208, v7, 0
    v_dot2_f32_bf16 v193, v209, v7, 0
    v_dot2_f32_bf16 v194, v210, v7, 0
    v_dot2_f32_bf16 v195, v211, v7, 0
    s_waitcnt vmcnt(11)
    v_lshlrev_b32 v196, 16, v52
    v_and_b32 v197, 0xffff0000, v52
    v_lshlrev_b32 v198, 16, v53
    v_and_b32 v199, 0xffff0000, v53
    v_lshlrev_b32 v200, 16, v54
    v_and_b32 v201, 0xffff0000, v54
    v_lshlrev_b32 v202, 16, v55
    v_and_b32 v203, 0xffff0000, v55
    v_cvt_pk_bf16_f32 v204, v188, v189
    v_cvt_pk_bf16_f32 v205, v190, v191
    v_cvt_pk_bf16_f32 v206, v192, v193
    v_cvt_pk_bf16_f32 v207, v194, v195
    v_lshlrev_b32 v188, 16, v204
    v_and_b32 v189, 0xffff0000, v204
    v_lshlrev_b32 v190, 16, v205
    v_and_b32 v191, 0xffff0000, v205
    v_lshlrev_b32 v192, 16, v206
    v_and_b32 v193, 0xffff0000, v206
    v_lshlrev_b32 v194, 16, v207
    v_and_b32 v195, 0xffff0000, v207
    v_pk_mul_f32 v[188:189], v[188:189], v[196:197]
    v_pk_mul_f32 v[190:191], v[190:191], v[198:199]
    v_pk_mul_f32 v[192:193], v[192:193], v[200:201]
    v_pk_mul_f32 v[194:195], v[194:195], v[202:203]
    v_cvt_pk_bf16_f32 v172, v188, v189
    v_cvt_pk_bf16_f32 v176, v190, v191
    v_cvt_pk_bf16_f32 v180, v192, v193
    v_cvt_pk_bf16_f32 v184, v194, v195
    v_lshlrev_b32 v148, 16, v40
    v_and_b32 v149, 0xffff0000, v40
    v_lshlrev_b32 v150, 16, v41
    v_and_b32 v151, 0xffff0000, v41
    v_lshlrev_b32 v152, 16, v42
    v_and_b32 v153, 0xffff0000, v42
    v_lshlrev_b32 v154, 16, v43
    v_and_b32 v155, 0xffff0000, v43
    v_pk_mul_f32 v[188:189], v[124:125], v[90:91]
    v_pk_mul_f32 v[190:191], v[126:127], v[98:99]
    v_pk_mul_f32 v[192:193], v[128:129], v[106:107]
    v_pk_mul_f32 v[194:195], v[130:131], v[114:115]
    v_pk_mul_f32 v[196:197], v[132:133], v[88:89]
    v_pk_mul_f32 v[198:199], v[134:135], v[96:97]
    v_pk_mul_f32 v[200:201], v[136:137], v[104:105]
    v_pk_mul_f32 v[202:203], v[138:139], v[112:113]
    v_cvt_pk_bf16_f32 v204, v188, v196
    v_cvt_pk_bf16_f32 v205, v189, v197
    v_cvt_pk_bf16_f32 v206, v190, v198
    v_cvt_pk_bf16_f32 v207, v191, v199
    v_cvt_pk_bf16_f32 v208, v192, v200
    v_cvt_pk_bf16_f32 v209, v193, v201
    v_cvt_pk_bf16_f32 v210, v194, v202
    v_cvt_pk_bf16_f32 v211, v195, v203
    v_dot2_f32_bf16 v188, v204, v7, 0
    v_dot2_f32_bf16 v189, v205, v7, 0
    v_dot2_f32_bf16 v190, v206, v7, 0
    v_dot2_f32_bf16 v191, v207, v7, 0
    v_dot2_f32_bf16 v192, v208, v7, 0
    v_dot2_f32_bf16 v193, v209, v7, 0
    v_dot2_f32_bf16 v194, v210, v7, 0
    v_dot2_f32_bf16 v195, v211, v7, 0
    v_pk_mul_f32 v[196:197], v[140:141], v[86:87]
    v_pk_mul_f32 v[198:199], v[142:143], v[94:95]
    v_pk_mul_f32 v[200:201], v[144:145], v[102:103]
    v_pk_mul_f32 v[202:203], v[146:147], v[110:111]
    v_cvt_pk_bf16_f32 v204, v188, v196
    v_cvt_pk_bf16_f32 v205, v189, v197
    v_cvt_pk_bf16_f32 v206, v190, v198
    v_cvt_pk_bf16_f32 v207, v191, v199
    v_cvt_pk_bf16_f32 v208, v192, v200
    v_cvt_pk_bf16_f32 v209, v193, v201
    v_cvt_pk_bf16_f32 v210, v194, v202
    v_cvt_pk_bf16_f32 v211, v195, v203
    v_dot2_f32_bf16 v188, v204, v7, 0
    v_dot2_f32_bf16 v189, v205, v7, 0
    v_dot2_f32_bf16 v190, v206, v7, 0
    v_dot2_f32_bf16 v191, v207, v7, 0
    v_dot2_f32_bf16 v192, v208, v7, 0
    v_dot2_f32_bf16 v193, v209, v7, 0
    v_dot2_f32_bf16 v194, v210, v7, 0
    v_dot2_f32_bf16 v195, v211, v7, 0
    v_pk_mul_f32 v[196:197], v[148:149], v[84:85]
    v_pk_mul_f32 v[198:199], v[150:151], v[92:93]
    v_pk_mul_f32 v[200:201], v[152:153], v[100:101]
    v_pk_mul_f32 v[202:203], v[154:155], v[108:109]
    v_cvt_pk_bf16_f32 v204, v188, v196
    v_cvt_pk_bf16_f32 v205, v189, v197
    v_cvt_pk_bf16_f32 v206, v190, v198
    v_cvt_pk_bf16_f32 v207, v191, v199
    v_cvt_pk_bf16_f32 v208, v192, v200
    v_cvt_pk_bf16_f32 v209, v193, v201
    v_cvt_pk_bf16_f32 v210, v194, v202
    v_cvt_pk_bf16_f32 v211, v195, v203
    v_dot2_f32_bf16 v188, v204, v7, 0
    v_dot2_f32_bf16 v189, v205, v7, 0
    v_dot2_f32_bf16 v190, v206, v7, 0
    v_dot2_f32_bf16 v191, v207, v7, 0
    v_dot2_f32_bf16 v192, v208, v7, 0
    v_dot2_f32_bf16 v193, v209, v7, 0
    v_dot2_f32_bf16 v194, v210, v7, 0
    v_dot2_f32_bf16 v195, v211, v7, 0
    s_waitcnt vmcnt(10)
    v_lshlrev_b32 v196, 16, v56
    v_and_b32 v197, 0xffff0000, v56
    v_lshlrev_b32 v198, 16, v57
    v_and_b32 v199, 0xffff0000, v57
    v_lshlrev_b32 v200, 16, v58
    v_and_b32 v201, 0xffff0000, v58
    v_lshlrev_b32 v202, 16, v59
    v_and_b32 v203, 0xffff0000, v59
    v_cvt_pk_bf16_f32 v204, v188, v189
    v_cvt_pk_bf16_f32 v205, v190, v191
    v_cvt_pk_bf16_f32 v206, v192, v193
    v_cvt_pk_bf16_f32 v207, v194, v195
    v_lshlrev_b32 v188, 16, v204
    v_and_b32 v189, 0xffff0000, v204
    v_lshlrev_b32 v190, 16, v205
    v_and_b32 v191, 0xffff0000, v205
    v_lshlrev_b32 v192, 16, v206
    v_and_b32 v193, 0xffff0000, v206
    v_lshlrev_b32 v194, 16, v207
    v_and_b32 v195, 0xffff0000, v207
    v_pk_mul_f32 v[188:189], v[188:189], v[196:197]
    v_pk_mul_f32 v[190:191], v[190:191], v[198:199]
    v_pk_mul_f32 v[192:193], v[192:193], v[200:201]
    v_pk_mul_f32 v[194:195], v[194:195], v[202:203]
    v_cvt_pk_bf16_f32 v173, v188, v189
    v_cvt_pk_bf16_f32 v177, v190, v191
    v_cvt_pk_bf16_f32 v181, v192, v193
    v_cvt_pk_bf16_f32 v185, v194, v195
    v_lshlrev_b32 v156, 16, v44
    v_and_b32 v157, 0xffff0000, v44
    v_lshlrev_b32 v158, 16, v45
    v_and_b32 v159, 0xffff0000, v45
    v_lshlrev_b32 v160, 16, v46
    v_and_b32 v161, 0xffff0000, v46
    v_lshlrev_b32 v162, 16, v47
    v_and_b32 v163, 0xffff0000, v47
    v_pk_mul_f32 v[188:189], v[132:133], v[90:91]
    v_pk_mul_f32 v[190:191], v[134:135], v[98:99]
    v_pk_mul_f32 v[192:193], v[136:137], v[106:107]
    v_pk_mul_f32 v[194:195], v[138:139], v[114:115]
    v_pk_mul_f32 v[196:197], v[140:141], v[88:89]
    v_pk_mul_f32 v[198:199], v[142:143], v[96:97]
    v_pk_mul_f32 v[200:201], v[144:145], v[104:105]
    v_pk_mul_f32 v[202:203], v[146:147], v[112:113]
    v_cvt_pk_bf16_f32 v204, v188, v196
    v_cvt_pk_bf16_f32 v205, v189, v197
    v_cvt_pk_bf16_f32 v206, v190, v198
    v_cvt_pk_bf16_f32 v207, v191, v199
    v_cvt_pk_bf16_f32 v208, v192, v200
    v_cvt_pk_bf16_f32 v209, v193, v201
    v_cvt_pk_bf16_f32 v210, v194, v202
    v_cvt_pk_bf16_f32 v211, v195, v203
    v_dot2_f32_bf16 v188, v204, v7, 0
    v_dot2_f32_bf16 v189, v205, v7, 0
    v_dot2_f32_bf16 v190, v206, v7, 0
    v_dot2_f32_bf16 v191, v207, v7, 0
    v_dot2_f32_bf16 v192, v208, v7, 0
    v_dot2_f32_bf16 v193, v209, v7, 0
    v_dot2_f32_bf16 v194, v210, v7, 0
    v_dot2_f32_bf16 v195, v211, v7, 0
    v_pk_mul_f32 v[196:197], v[148:149], v[86:87]
    v_pk_mul_f32 v[198:199], v[150:151], v[94:95]
    v_pk_mul_f32 v[200:201], v[152:153], v[102:103]
    v_pk_mul_f32 v[202:203], v[154:155], v[110:111]
    v_cvt_pk_bf16_f32 v204, v188, v196
    v_cvt_pk_bf16_f32 v205, v189, v197
    v_cvt_pk_bf16_f32 v206, v190, v198
    v_cvt_pk_bf16_f32 v207, v191, v199
    v_cvt_pk_bf16_f32 v208, v192, v200
    v_cvt_pk_bf16_f32 v209, v193, v201
    v_cvt_pk_bf16_f32 v210, v194, v202
    v_cvt_pk_bf16_f32 v211, v195, v203
    v_dot2_f32_bf16 v188, v204, v7, 0
    v_dot2_f32_bf16 v189, v205, v7, 0
    v_dot2_f32_bf16 v190, v206, v7, 0
    v_dot2_f32_bf16 v191, v207, v7, 0
    v_dot2_f32_bf16 v192, v208, v7, 0
    v_dot2_f32_bf16 v193, v209, v7, 0
    v_dot2_f32_bf16 v194, v210, v7, 0
    v_dot2_f32_bf16 v195, v211, v7, 0
    v_pk_mul_f32 v[196:197], v[156:157], v[84:85]
    v_pk_mul_f32 v[198:199], v[158:159], v[92:93]
    v_pk_mul_f32 v[200:201], v[160:161], v[100:101]
    v_pk_mul_f32 v[202:203], v[162:163], v[108:109]
    v_cvt_pk_bf16_f32 v204, v188, v196
    v_cvt_pk_bf16_f32 v205, v189, v197
    v_cvt_pk_bf16_f32 v206, v190, v198
    v_cvt_pk_bf16_f32 v207, v191, v199
    v_cvt_pk_bf16_f32 v208, v192, v200
    v_cvt_pk_bf16_f32 v209, v193, v201
    v_cvt_pk_bf16_f32 v210, v194, v202
    v_cvt_pk_bf16_f32 v211, v195, v203
    v_dot2_f32_bf16 v188, v204, v7, 0
    v_dot2_f32_bf16 v189, v205, v7, 0
    v_dot2_f32_bf16 v190, v206, v7, 0
    v_dot2_f32_bf16 v191, v207, v7, 0
    v_dot2_f32_bf16 v192, v208, v7, 0
    v_dot2_f32_bf16 v193, v209, v7, 0
    v_dot2_f32_bf16 v194, v210, v7, 0
    v_dot2_f32_bf16 v195, v211, v7, 0
    s_waitcnt vmcnt(9)
    v_lshlrev_b32 v196, 16, v60
    v_and_b32 v197, 0xffff0000, v60
    v_lshlrev_b32 v198, 16, v61
    v_and_b32 v199, 0xffff0000, v61
    v_lshlrev_b32 v200, 16, v62
    v_and_b32 v201, 0xffff0000, v62
    v_lshlrev_b32 v202, 16, v63
    v_and_b32 v203, 0xffff0000, v63
    v_cvt_pk_bf16_f32 v204, v188, v189
    v_cvt_pk_bf16_f32 v205, v190, v191
    v_cvt_pk_bf16_f32 v206, v192, v193
    v_cvt_pk_bf16_f32 v207, v194, v195
    v_lshlrev_b32 v188, 16, v204
    v_and_b32 v189, 0xffff0000, v204
    v_lshlrev_b32 v190, 16, v205
    v_and_b32 v191, 0xffff0000, v205
    v_lshlrev_b32 v192, 16, v206
    v_and_b32 v193, 0xffff0000, v206
    v_lshlrev_b32 v194, 16, v207
    v_and_b32 v195, 0xffff0000, v207
    v_pk_mul_f32 v[188:189], v[188:189], v[196:197]
    v_pk_mul_f32 v[190:191], v[190:191], v[198:199]
    v_pk_mul_f32 v[192:193], v[192:193], v[200:201]
    v_pk_mul_f32 v[194:195], v[194:195], v[202:203]
    v_cvt_pk_bf16_f32 v174, v188, v189
    v_cvt_pk_bf16_f32 v178, v190, v191
    v_cvt_pk_bf16_f32 v182, v192, v193
    v_cvt_pk_bf16_f32 v186, v194, v195
    v_lshlrev_b32 v164, 16, v48
    v_and_b32 v165, 0xffff0000, v48
    v_lshlrev_b32 v166, 16, v49
    v_and_b32 v167, 0xffff0000, v49
    v_lshlrev_b32 v168, 16, v50
    v_and_b32 v169, 0xffff0000, v50
    v_lshlrev_b32 v170, 16, v51
    v_and_b32 v171, 0xffff0000, v51
    v_pk_mul_f32 v[188:189], v[140:141], v[90:91]
    v_pk_mul_f32 v[190:191], v[142:143], v[98:99]
    v_pk_mul_f32 v[192:193], v[144:145], v[106:107]
    v_pk_mul_f32 v[194:195], v[146:147], v[114:115]
    v_pk_mul_f32 v[196:197], v[148:149], v[88:89]
    v_pk_mul_f32 v[198:199], v[150:151], v[96:97]
    v_pk_mul_f32 v[200:201], v[152:153], v[104:105]
    v_pk_mul_f32 v[202:203], v[154:155], v[112:113]
    v_cvt_pk_bf16_f32 v204, v188, v196
    v_cvt_pk_bf16_f32 v205, v189, v197
    v_cvt_pk_bf16_f32 v206, v190, v198
    v_cvt_pk_bf16_f32 v207, v191, v199
    v_cvt_pk_bf16_f32 v208, v192, v200
    v_cvt_pk_bf16_f32 v209, v193, v201
    v_cvt_pk_bf16_f32 v210, v194, v202
    v_cvt_pk_bf16_f32 v211, v195, v203
    v_dot2_f32_bf16 v188, v204, v7, 0
    v_dot2_f32_bf16 v189, v205, v7, 0
    v_dot2_f32_bf16 v190, v206, v7, 0
    v_dot2_f32_bf16 v191, v207, v7, 0
    v_dot2_f32_bf16 v192, v208, v7, 0
    v_dot2_f32_bf16 v193, v209, v7, 0
    v_dot2_f32_bf16 v194, v210, v7, 0
    v_dot2_f32_bf16 v195, v211, v7, 0
    v_pk_mul_f32 v[196:197], v[156:157], v[86:87]
    v_pk_mul_f32 v[198:199], v[158:159], v[94:95]
    v_pk_mul_f32 v[200:201], v[160:161], v[102:103]
    v_pk_mul_f32 v[202:203], v[162:163], v[110:111]
    v_cvt_pk_bf16_f32 v204, v188, v196
    v_cvt_pk_bf16_f32 v205, v189, v197
    v_cvt_pk_bf16_f32 v206, v190, v198
    v_cvt_pk_bf16_f32 v207, v191, v199
    v_cvt_pk_bf16_f32 v208, v192, v200
    v_cvt_pk_bf16_f32 v209, v193, v201
    v_cvt_pk_bf16_f32 v210, v194, v202
    v_cvt_pk_bf16_f32 v211, v195, v203
    v_dot2_f32_bf16 v188, v204, v7, 0
    v_dot2_f32_bf16 v189, v205, v7, 0
    v_dot2_f32_bf16 v190, v206, v7, 0
    v_dot2_f32_bf16 v191, v207, v7, 0
    v_dot2_f32_bf16 v192, v208, v7, 0
    v_dot2_f32_bf16 v193, v209, v7, 0
    v_dot2_f32_bf16 v194, v210, v7, 0
    v_dot2_f32_bf16 v195, v211, v7, 0
    v_pk_mul_f32 v[196:197], v[164:165], v[84:85]
    v_pk_mul_f32 v[198:199], v[166:167], v[92:93]
    v_pk_mul_f32 v[200:201], v[168:169], v[100:101]
    v_pk_mul_f32 v[202:203], v[170:171], v[108:109]
    v_cvt_pk_bf16_f32 v204, v188, v196
    v_cvt_pk_bf16_f32 v205, v189, v197
    v_cvt_pk_bf16_f32 v206, v190, v198
    v_cvt_pk_bf16_f32 v207, v191, v199
    v_cvt_pk_bf16_f32 v208, v192, v200
    v_cvt_pk_bf16_f32 v209, v193, v201
    v_cvt_pk_bf16_f32 v210, v194, v202
    v_cvt_pk_bf16_f32 v211, v195, v203
    v_dot2_f32_bf16 v188, v204, v7, 0
    v_dot2_f32_bf16 v189, v205, v7, 0
    v_dot2_f32_bf16 v190, v206, v7, 0
    v_dot2_f32_bf16 v191, v207, v7, 0
    v_dot2_f32_bf16 v192, v208, v7, 0
    v_dot2_f32_bf16 v193, v209, v7, 0
    v_dot2_f32_bf16 v194, v210, v7, 0
    v_dot2_f32_bf16 v195, v211, v7, 0
    s_waitcnt vmcnt(8)
    v_lshlrev_b32 v196, 16, v64
    v_and_b32 v197, 0xffff0000, v64
    v_lshlrev_b32 v198, 16, v65
    v_and_b32 v199, 0xffff0000, v65
    v_lshlrev_b32 v200, 16, v66
    v_and_b32 v201, 0xffff0000, v66
    v_lshlrev_b32 v202, 16, v67
    v_and_b32 v203, 0xffff0000, v67
    v_cvt_pk_bf16_f32 v204, v188, v189
    v_cvt_pk_bf16_f32 v205, v190, v191
    v_cvt_pk_bf16_f32 v206, v192, v193
    v_cvt_pk_bf16_f32 v207, v194, v195
    v_lshlrev_b32 v188, 16, v204
    v_and_b32 v189, 0xffff0000, v204
    v_lshlrev_b32 v190, 16, v205
    v_and_b32 v191, 0xffff0000, v205
    v_lshlrev_b32 v192, 16, v206
    v_and_b32 v193, 0xffff0000, v206
    v_lshlrev_b32 v194, 16, v207
    v_and_b32 v195, 0xffff0000, v207
    v_pk_mul_f32 v[188:189], v[188:189], v[196:197]
    v_pk_mul_f32 v[190:191], v[190:191], v[198:199]
    v_pk_mul_f32 v[192:193], v[192:193], v[200:201]
    v_pk_mul_f32 v[194:195], v[194:195], v[202:203]
    v_cvt_pk_bf16_f32 v175, v188, v189
    v_cvt_pk_bf16_f32 v179, v190, v191
    v_cvt_pk_bf16_f32 v183, v192, v193
    v_cvt_pk_bf16_f32 v187, v194, v195
    s_waitcnt lgkmcnt(0)
    s_add_u32 s48, s48, 16
    s_add_u32 s49, s49, 1
    s_add_u32 s50, s48, 2
    s_add_u32 s51, s48, 3
    v_mov_b32 v255, s49
    s_mov_b32 s26, 0x0
    buffer_store_dwordx4 v[172:175], v234, s[52:55], s26 offen sc0 sc1
    s_mov_b32 s26, 0x2000
    buffer_store_dwordx4 v[176:179], v234, s[52:55], s26 offen sc0 sc1
    s_mov_b32 s26, 0x4000
    buffer_store_dwordx4 v[180:183], v234, s[52:55], s26 offen sc0 sc1
    s_mov_b32 s26, 0x6000
    buffer_store_dwordx4 v[184:187], v234, s[52:55], s26 offen sc0 sc1
    buffer_load_dwordx2 v[232:233], v231, s[52:55], s47 offen sc1
    s_lshl_b32 s26, s23, 2
    s_add_u32 s26, s26, 162304
    v_mov_b32 v219, s26
    s_add_u32 s29, s48, 1
    v_mov_b32 v254, s29
    s_waitcnt vmcnt(0)
    v_subrev_u32 v232, s48, v232
    v_xor_b32 v233, s49, v233
    v_lshrrev_b32 v235, 4, v232
    v_or_b32 v235, v235, v233
    v_cmp_ne_u32 vcc, 0, v235
    s_cbranch_vccz XTOK_1
    s_mov_b32 s40, 200000
POLL_4:
    buffer_load_dwordx2 v[232:233], v231, s[52:55], s47 offen offset:0 sc1
    s_sub_u32 s40, s40, 1
    s_cbranch_scc1 POLLX_5
    s_waitcnt vmcnt(0)
    v_subrev_u32 v232, s48, v232
    v_xor_b32 v233, s49, v233
    v_lshrrev_b32 v235, 4, v232
    v_or_b32 v235, v235, v233
    v_cmp_ne_u32 vcc, 0, v235
    s_cbranch_vccnz POLL_4
POLLX_5:
    s_waitcnt vmcnt(0)
XTOK_1:
    v_cmp_ne_u32 vcc, s42, v232
    s_mov_b32 s46, 0
    s_cbranch_vccnz FSL_2
    s_mov_b32 s46, 1
    buffer_store_dwordx2 v[254:255], v222, s[52:55], s14 offen
    s_branch FDN_3
FSL_2:
    buffer_store_dwordx2 v[254:255], v222, s[52:55], s14 offen sc0 sc1
FDN_3:
K_UPDONE:
    s_mov_b32 s40, 200000
POLL_6:
    buffer_load_dwordx2 v[232:233], v230, s[52:55], s15 offen offset:0 sc1
    s_sub_u32 s40, s40, 1
    s_cbranch_scc1 POLLX_7
    s_waitcnt vmcnt(0)
    v_subrev_u32 v232, s48, v232
    v_xor_b32 v233, s49, v233
    v_lshrrev_b32 v235, 4, v232
    v_or_b32 v235, v235, v233
    v_cmp_ne_u32 vcc, 0, v235
    s_cbranch_vccnz POLL_6
POLLX_7:
    s_waitcnt vmcnt(0)
    s_add_u32 s26, s45, 4096
    buffer_load_dwordx4 v[24:27], v16, s[52:55], s45 offen offset:0 sc1
    buffer_load_dwordx4 v[28:31], v16, s[52:55], s45 offen offset:1024 sc1
    buffer_load_dwordx4 v[32:35], v16, s[52:55], s45 offen offset:2048 sc1
    buffer_load_dwordx4 v[36:39], v16, s[52:55], s45 offen offset:3072 sc1
    buffer_load_dwordx4 v[40:43], v16, s[52:55], s26 offen offset:0 sc1
    buffer_load_dwordx4 v[44:47], v16, s[52:55], s26 offen offset:1024 sc1
    buffer_load_dwordx4 v[48:51], v16, s[52:55], s26 offen offset:2048 sc1
    buffer_load_dwordx4 v[52:55], v16, s[52:55], s26 offen offset:3072 sc1
    s_mov_b64 s[80:81], s[90:91]
    s_mov_b64 s[82:83], s[96:97]
    s_mov_b64 s[36:37], s[94:95]
    s_mov_b32 s84, s98
    s_and_b32 s85, s99, 0xffff
    s_mov_b32 s86, 1835008
    s_mov_b32 s87, 0x20000
    s_lshr_b32 s26, s12, 1
    s_mul_i32 s10, s26, 229376
    s_mul_i32 s32, s17, 7168
    s_add_u32 s10, s10, s32
    s_lshl_b32 s32, s23, 8
    s_add_u32 s10, s10, s32
    s_add_u32 s10, s10, 0x1000000
    s_add_u32 s11, s10, 4096
    s_add_u32 s4, s10, 114688
    s_add_u32 s5, s11, 114688
    s_lshl_b32 s13, s12, 4
    s_add_u32 s13, s13, s17
    s_lshl_b32 s13, s13, 7
    s_add_u32 s13, s13, 0x830000
    s_lshl_b32 s43, s6, 2
    s_add_u32 s43, s43, s18
    s_lshl_b32 s43, s43, 9
    s_lshl_b32 s32, s23, 5
    s_add_u32 s43, s43, s32
    s_add_u32 s43, s43, 0x830000
    s_mul_i32 s88, s3, 229376
    s_mul_i32 s32, s18, 28672
    s_add_u32 s88, s88, s32
    s_add_u32 s88, s88, 0x1000000
    s_add_u32 s95, s88, 114688
    s_add_u32 s89, s88, 4096
    s_add_u32 s96, s95, 4096
    s_add_u32 s90, s89, 4096
    s_add_u32 s97, s96, 4096
    s_add_u32 s91, s90, 4096
    s_add_u32 s98, s97, 4096
    s_add_u32 s92, s91, 4096
    s_add_u32 s99, s98, 4096
    s_add_u32 s93, s92, 4096
    s_add_u32 s100, s99, 4096
    s_add_u32 s94, s93, 4096
    s_add_u32 s101, s100, 4096
    s_lshl_b32 s75, s19, 2
    s_add_u32 s75, s75, s18
    s_lshl_b32 s75, s75, 5
    s_add_u32 s75, s75, s41
    s_lshl_b32 s69, s18, 6
    s_add_u32 s69, s69, s41
    s_add_u32 s9, s7, 0x40000
    s_lshl_b32 s8, s12, 11
    s_add_u32 s8, s8, 0x8c0000
    s_lshl_b32 s28, s6, 15
    s_lshl_b32 s32, s20, 11
    s_add_u32 s28, s28, s32
    s_lshl_b32 s32, s23, 7
    s_add_u32 s28, s28, s32
    s_add_u32 s33, s28, 16384
    s_mul_i32 s76, s18, 458752
    s_lshl_b32 s26, s20, 7
    s_add_u32 s76, s76, s26
    v_accvgpr_read_b32 v221, a224
    v_lshlrev_b32 v192, 16, v221
    v_and_b32 v193, 0xffff0000, v221
    v_accvgpr_read_b32 v221, a225
    v_lshlrev_b32 v194, 16, v221
    v_and_b32 v195, 0xffff0000, v221
    v_accvgpr_read_b32 v221, a226
    v_lshlrev_b32 v196, 16, v221
    v_and_b32 v197, 0xffff0000, v221
    v_accvgpr_read_b32 v221, a227
    v_lshlrev_b32 v198, 16, v221
    v_and_b32 v199, 0xffff0000, v221
    v_pk_add_f32 v[204:205], v[192:193], v[194:195]
    v_pk_mul_f32 v[206:207], v[192:193], v[192:193]
    v_pk_fma_f32 v[206:207], v[194:195], v[194:195], v[206:207]
    v_pk_add_f32 v[204:205], v[204:205], v[196:197]
    v_pk_fma_f32 v[206:207], v[196:197], v[196:197], v[206:207]
    v_pk_add_f32 v[204:205], v[204:205], v[198:199]
    v_pk_fma_f32 v[206:207], v[198:199], v[198:199], v[206:207]
    v_add_f32 v224, v204, v205
    v_add_f32 v225, v206, v207
    v_accvgpr_read_b32 v221, a228
    v_lshlrev_b32 v192, 16, v221
    v_and_b32 v193, 0xffff0000, v221
    v_accvgpr_read_b32 v221, a229
    v_lshlrev_b32 v194, 16, v221
    v_and_b32 v195, 0xffff0000, v221
    v_accvgpr_read_b32 v221, a230
    v_lshlrev_b32 v196, 16, v221
    v_and_b32 v197, 0xffff0000, v221
    v_accvgpr_read_b32 v221, a231
    v_lshlrev_b32 v198, 16, v221
    v_and_b32 v199, 0xffff0000, v221
    v_pk_add_f32 v[204:205], v[192:193], v[194:195]
    v_pk_mul_f32 v[206:207], v[192:193], v[192:193]
    v_pk_fma_f32 v[206:207], v[194:195], v[194:195], v[206:207]
    v_pk_add_f32 v[204:205], v[204:205], v[196:197]
    v_pk_fma_f32 v[206:207], v[196:197], v[196:197], v[206:207]
    v_pk_add_f32 v[204:205], v[204:205], v[198:199]
    v_pk_fma_f32 v[206:207], v[198:199], v[198:199], v[206:207]
    v_add_f32 v226, v204, v205
    v_add_f32 v227, v206, v207
    s_nop 1
    v_add_f32_dpp v224, v224, v224 quad_perm:[1,0,3,2] row_mask:0xf bank_mask:0xf
    v_add_f32_dpp v225, v225, v225 quad_perm:[1,0,3,2] row_mask:0xf bank_mask:0xf
    v_add_f32_dpp v226, v226, v226 quad_perm:[1,0,3,2] row_mask:0xf bank_mask:0xf
    v_add_f32_dpp v227, v227, v227 quad_perm:[1,0,3,2] row_mask:0xf bank_mask:0xf
    v_add_f32_dpp v224, v224, v224 quad_perm:[2,3,0,1] row_mask:0xf bank_mask:0xf
    v_add_f32_dpp v225, v225, v225 quad_perm:[2,3,0,1] row_mask:0xf bank_mask:0xf
    v_add_f32_dpp v226, v226, v226 quad_perm:[2,3,0,1] row_mask:0xf bank_mask:0xf
    v_add_f32_dpp v227, v227, v227 quad_perm:[2,3,0,1] row_mask:0xf bank_mask:0xf
    v_add_f32_dpp v224, v224, v224 row_half_mirror row_mask:0xf bank_mask:0xf
    v_add_f32_dpp v225, v225, v225 row_half_mirror row_mask:0xf bank_mask:0xf
    v_add_f32_dpp v226, v226, v226 row_half_mirror row_mask:0xf bank_mask:0xf
    v_add_f32_dpp v227, v227, v227 row_half_mirror row_mask:0xf bank_mask:0xf
    v_and_b32 v225, 0x7fffffff, v225
    v_and_b32 v227, 0x7fffffff, v227
    s_and_b32 s37, s37, 0xffff
    s_mov_b32 s38, 1835008
    s_mov_b32 s39, 0x20000
    v_lshrrev_b32 v223, 5, v2
    v_lshlrev_b32 v223, 3, v223
    v_bfe_u32 v221, v2, 2, 2
    v_add_u32 v223, v223, v221
    v_lshlrev_b32 v223, 7, v223
    v_and_b32 v221, 1, v4
    v_lshl_add_u32 v223, v221, 5, v223
    v_and_b32 v221, 1, v2
    v_lshl_add_u32 v223, v221, 4, v223
    v_bfe_u32 v221, v2, 1, 1
    v_lshl_add_u32 v223, v221, 3, v223
    v_lshrrev_b32 v220, 3, v2
    v_lshlrev_b32 v220, 10, v220
    v_and_b32 v221, 0x70, v16
    v_add_u32 v220, v220, v221
    s_mov_b32 s64, s80
    s_and_b32 s65, s81, 0xffff
    s_mov_b32 s66, 0x400
    s_lshl_b32 s26, s44, 2
    s_lshl_b32 s29, s18, 1
    s_add_u32 s26, s26, s29
    buffer_load_ushort v216, v17, s[64:67], s26 offen
    v_and_b32 v231, 0x1c0, v230
    v_and_b32 v5, 7, v2
    v_lshl_add_u32 v231, v5, 28, v231
    s_lshl_b32 s26, s20, 3
    v_add_u32 v231, s26, v231
    s_waitcnt vmcnt(8)
    v_perm_b32 v56, v26, v27, s78
    v_perm_b32 v57, v24, v25, s78
    ds_write_b64 v23, v[56:57] offset:3584
    v_mov_b32 v218, 2
    ds_write_b32 v219, v218 offset:8
    s_waitcnt vmcnt(7)
    v_perm_b32 v58, v30, v31, s78
    v_perm_b32 v59, v28, v29, s78
    ds_write_b64 v23, v[58:59] offset:3072
    s_waitcnt vmcnt(6)
    v_perm_b32 v60, v34, v35, s78
    v_perm_b32 v61, v32, v33, s78
    ds_write_b64 v23, v[60:61] offset:2560
    s_waitcnt vmcnt(5)
    v_perm_b32 v62, v38, v39, s78
    v_perm_b32 v63, v36, v37, s78
    ds_write_b64 v23, v[62:63] offset:2048
    s_waitcnt vmcnt(4)
    v_perm_b32 v64, v42, v43, s78
    v_perm_b32 v65, v40, v41, s78
    ds_write_b64 v23, v[64:65] offset:1536
    s_waitcnt vmcnt(3)
    v_perm_b32 v66, v46, v47, s78
    v_perm_b32 v67, v44, v45, s78
    ds_write_b64 v23, v[66:67] offset:1024
    s_waitcnt vmcnt(2)
    v_perm_b32 v68, v50, v51, s78
    v_perm_b32 v69, v48, v49, s78
    ds_write_b64 v23, v[68:69] offset:512
    s_waitcnt vmcnt(1)
    v_perm_b32 v70, v54, v55, s78
    v_perm_b32 v71, v52, v53, s78
    ds_write_b64 v23, v[70:71] offset:0
    s_cmp_eq_u32 s46, 0
    s_cbranch_scc1 S0S_8
    buffer_store_dwordx2 v[224:225], v231, s[52:55], s7 offen offset:0
    buffer_store_dwordx2 v[226:227], v231, s[52:55], s7 offen offset:1024
    s_branch S0D_9
S0S_8:
    buffer_store_dwordx2 v[224:225], v231, s[52:55], s7 offen offset:0 sc0 sc1
    buffer_store_dwordx2 v[226:227], v231, s[52:55], s7 offen offset:1024 sc0 sc1
S0D_9:
    s_mov_b32 s40, 1600000
LW_10:
    ds_read_b32 v218, v219 offset:0
    s_sub_u32 s40, s40, 1
    s_cbranch_scc1 LWX_11
    s_waitcnt lgkmcnt(0)
    v_cmp_gt_u32 vcc, 1, v218
    s_cbranch_vccz LWX_11
    s_sleep 1
    s_branch LW_10
LWX_11:
    s_waitcnt lgkmcnt(0)
    ds_read2_b32 v[56:57], v18 offset0:0 offset1:1
    ds_read2_b32 v[58:59], v18 offset0:2 offset1:3
    ds_read_b128 v[88:91], v22 offset:3584
    ds_read2_b32 v[60:61], v18 offset0:128 offset1:129
    ds_read2_b32 v[62:63], v18 offset0:130 offset1:131
    ds_read_b128 v[92:95], v22 offset:3072
    ds_read2_b32 v[64:65], v19 offset0:0 offset1:1
    ds_read2_b32 v[66:67], v19 offset0:2 offset1:3
    ds_read_b128 v[96:99], v22 offset:2560
    ds_read2_b32 v[68:69], v19 offset0:128 offset1:129
    ds_read2_b32 v[70:71], v19 offset0:130 offset1:131
    ds_read_b128 v[100:103], v22 offset:2048
    s_waitcnt lgkmcnt(9)
    v_mfma_f32_16x16x32_bf16 v[24:27], v[56:59], v[88:91], 0
    ds_read2_b32 v[72:73], v20 offset0:0 offset1:1
    s_waitcnt lgkmcnt(7)
    v_mfma_f32_16x16x32_bf16 v[28:31], v[56:59], v[92:95], 0
    ds_read2_b32 v[74:75], v20 offset0:2 offset1:3
    v_mfma_f32_16x16x32_bf16 v[28:31], v[60:63], v[88:91], v[28:31]
    ds_read_b128 v[104:107], v22 offset:1536
    v_mfma_f32_16x16x32_bf16 v[32:35], v[60:63], v[92:95], 0
    ds_read2_b32 v[76:77], v20 offset0:128 offset1:129
    s_waitcnt lgkmcnt(7)
    v_mfma_f32_16x16x32_bf16 v[32:35], v[56:59], v[96:99], v[32:35]
    ds_read2_b32 v[78:79], v20 offset0:130 offset1:131
    v_mfma_f32_16x16x32_bf16 v[32:35], v[64:67], v[88:91], v[32:35]
    ds_read_b128 v[108:111], v22 offset:1024
    v_mfma_f32_16x16x32_bf16 v[36:39], v[60:63], v[96:99], 0
    ds_read2_b32 v[80:81], v21 offset0:0 offset1:1
    v_mfma_f32_16x16x32_bf16 v[36:39], v[64:67], v[92:95], v[36:39]
    ds_read2_b32 v[82:83], v21 offset0:2 offset1:3
    v_mfma_f32_16x16x32_bf16 v[40:43], v[64:67], v[96:99], 0
    ds_read_b128 v[112:115], v22 offset:512
    s_waitcnt lgkmcnt(9)
    v_mfma_f32_16x16x32_bf16 v[36:39], v[56:59], v[100:103], v[36:39]
    ds_read2_b32 v[84:85], v21 offset0:128 offset1:129
    v_mfma_f32_16x16x32_bf16 v[36:39], v[68:71], v[88:91], v[36:39]
    ds_read2_b32 v[86:87], v21 offset0:130 offset1:131
    v_mfma_f32_16x16x32_bf16 v[40:43], v[60:63], v[100:103], v[40:43]
    ds_read_b128 v[116:119], v22 offset:0
    v_mfma_f32_16x16x32_bf16 v[40:43], v[68:71], v[92:95], v[40:43]
    ds_read2_b32 v[120:121], v18 offset0:16 offset1:17
    s_mul_i32 s26, s18, 12928
    v_mfma_f32_16x16x32_bf16 v[44:47], v[64:67], v[100:103], 0
    ds_read2_b32 v[122:123], v18 offset0:18 offset1:19
    s_add_u32 s26, s26, 115192
    v_mfma_f32_16x16x32_bf16 v[44:47], v[68:71], v[96:99], v[44:47]
    ds_read_b128 v[152:155], v22 offset:3648
    v_sub_u32 v10, s26, v8
    v_mfma_f32_16x16x32_bf16 v[48:51], v[68:71], v[100:103], 0
    ds_read2_b32 v[124:125], v18 offset0:144 offset1:145
    ds_read_b64 v[236:237], v10 offset:3584
    s_waitcnt lgkmcnt(14)
    v_mfma_f32_16x16x32_bf16 v[40:43], v[56:59], v[104:107], v[40:43]
    ds_read2_b32 v[126:127], v18 offset0:146 offset1:147
    ds_read_b64 v[238:239], v10 offset:3072
    v_mfma_f32_16x16x32_bf16 v[40:43], v[72:75], v[88:91], v[40:43]
    ds_read_b128 v[156:159], v22 offset:3136
    ds_read_b64 v[240:241], v10 offset:2560
    v_mfma_f32_16x16x32_bf16 v[44:47], v[60:63], v[104:107], v[44:47]
    ds_read2_b32 v[128:129], v19 offset0:16 offset1:17
    ds_read_b64 v[242:243], v10 offset:2048
    v_mfma_f32_16x16x32_bf16 v[44:47], v[72:75], v[92:95], v[44:47]
    ds_read2_b32 v[130:131], v19 offset0:18 offset1:19
    ds_read_b64 v[244:245], v10 offset:1536
    v_mfma_f32_16x16x32_bf16 v[48:51], v[64:67], v[104:107], v[48:51]
    ds_read_b128 v[160:163], v22 offset:2624
    ds_read_b64 v[246:247], v10 offset:1024
    v_mfma_f32_16x16x32_bf16 v[48:51], v[72:75], v[96:99], v[48:51]
    ds_read2_b32 v[132:133], v19 offset0:144 offset1:145
    ds_read_b64 v[248:249], v10 offset:512
    v_mfma_f32_16x16x32_bf16 v[52:55], v[68:71], v[104:107], 0
    ds_read2_b32 v[134:135], v19 offset0:146 offset1:147
    ds_read_b64 v[250:251], v10 offset:0
    v_mfma_f32_16x16x32_bf16 v[52:55], v[72:75], v[100:103], v[52:55]
    ds_read_b128 v[164:167], v22 offset:2112
    s_waitcnt lgkmcnt(15)
    v_mfma_f32_16x16x32_bf16 v[44:47], v[56:59], v[108:111], v[44:47]
    ds_read2_b32 v[136:137], v20 offset0:16 offset1:17
    v_mfma_f32_16x16x32_bf16 v[44:47], v[76:79], v[88:91], v[44:47]
    ds_read2_b32 v[138:139], v20 offset0:18 offset1:19
    v_mfma_f32_16x16x32_bf16 v[48:51], v[60:63], v[108:111], v[48:51]
    ds_read_b128 v[168:171], v22 offset:1600
    v_mfma_f32_16x16x32_bf16 v[48:51], v[76:79], v[92:95], v[48:51]
    ds_read2_b32 v[140:141], v20 offset0:144 offset1:145
    v_mfma_f32_16x16x32_bf16 v[52:55], v[64:67], v[108:111], v[52:55]
    ds_read2_b32 v[142:143], v20 offset0:146 offset1:147
    v_mfma_f32_16x16x32_bf16 v[52:55], v[76:79], v[96:99], v[52:55]
    ds_read_b128 v[172:175], v22 offset:1088
    s_waitcnt lgkmcnt(15)
    v_mfma_f32_16x16x32_bf16 v[48:51], v[56:59], v[112:115], v[48:51]
    ds_read2_b32 v[144:145], v21 offset0:16 offset1:17
    v_mfma_f32_16x16x32_bf16 v[48:51], v[80:83], v[88:91], v[48:51]
    ds_read2_b32 v[146:147], v21 offset0:18 offset1:19
    v_mfma_f32_16x16x32_bf16 v[52:55], v[60:63], v[112:115], v[52:55]
    ds_read_b128 v[176:179], v22 offset:576
    v_mfma_f32_16x16x32_bf16 v[52:55], v[80:83], v[92:95], v[52:55]
    ds_read2_b32 v[148:149], v21 offset0:144 offset1:145
    s_waitcnt vmcnt(0) lgkmcnt(11)
    v_mfma_f32_16x16x32_bf16 v[52:55], v[56:59], v[116:119], v[52:55]
    ds_read2_b32 v[150:151], v21 offset0:146 offset1:147
    v_lshlrev_b32 v216, 16, v216
    v_mfma_f32_16x16x32_bf16 v[52:55], v[84:87], v[88:91], v[52:55]
    ds_read_b128 v[180:183], v22 offset:64
    v_and_b32 v184, 0xffff0000, v237
    s_waitcnt lgkmcnt(12)
    v_mfma_f32_16x16x32_bf16 v[24:27], v[120:123], v[152:155], v[24:27]
    ds_read2_b32 v[56:57], v18 offset0:32 offset1:33
    v_mul_f32 v184, v184, v216
    v_mfma_f32_16x16x32_bf16 v[28:31], v[120:123], v[156:159], v[28:31]
    ds_read2_b32 v[58:59], v18 offset0:34 offset1:35
    v_lshlrev_b32 v185, 16, v237
    v_mfma_f32_16x16x32_bf16 v[28:31], v[124:127], v[152:155], v[28:31]
    ds_read_b128 v[88:91], v22 offset:3712
    v_mul_f32 v185, v185, v216
    v_mfma_f32_16x16x32_bf16 v[32:35], v[124:127], v[156:159], v[32:35]
    ds_read2_b32 v[60:61], v18 offset0:160 offset1:161
    v_and_b32 v186, 0xffff0000, v236
    v_mfma_f32_16x16x32_bf16 v[32:35], v[120:123], v[160:163], v[32:35]
    ds_read2_b32 v[62:63], v18 offset0:162 offset1:163
    v_mul_f32 v186, v186, v216
    v_mfma_f32_16x16x32_bf16 v[32:35], v[128:131], v[152:155], v[32:35]
    ds_read_b128 v[92:95], v22 offset:3200
    v_lshlrev_b32 v187, 16, v236
    v_mfma_f32_16x16x32_bf16 v[36:39], v[124:127], v[160:163], v[36:39]
    ds_read2_b32 v[64:65], v19 offset0:32 offset1:33
    v_mul_f32 v187, v187, v216
    v_mfma_f32_16x16x32_bf16 v[36:39], v[128:131], v[156:159], v[36:39]
    ds_read2_b32 v[66:67], v19 offset0:34 offset1:35
    v_and_b32 v188, 0xffff0000, v239
    v_mfma_f32_16x16x32_bf16 v[40:43], v[128:131], v[160:163], v[40:43]
    ds_read_b128 v[96:99], v22 offset:2688
    v_mul_f32 v188, v188, v216
    v_mfma_f32_16x16x32_bf16 v[36:39], v[120:123], v[164:167], v[36:39]
    ds_read2_b32 v[68:69], v19 offset0:160 offset1:161
    v_lshlrev_b32 v189, 16, v239
    v_mfma_f32_16x16x32_bf16 v[36:39], v[132:135], v[152:155], v[36:39]
    ds_read2_b32 v[70:71], v19 offset0:162 offset1:163
    v_mul_f32 v189, v189, v216
    v_mfma_f32_16x16x32_bf16 v[40:43], v[124:127], v[164:167], v[40:43]
    ds_read_b128 v[100:103], v22 offset:2176
    v_and_b32 v190, 0xffff0000, v238
    v_mfma_f32_16x16x32_bf16 v[40:43], v[132:135], v[156:159], v[40:43]
    ds_read2_b32 v[72:73], v20 offset0:32 offset1:33
    v_mul_f32 v190, v190, v216
    v_mfma_f32_16x16x32_bf16 v[44:47], v[128:131], v[164:167], v[44:47]
    ds_read2_b32 v[74:75], v20 offset0:34 offset1:35
    v_lshlrev_b32 v191, 16, v238
    v_mfma_f32_16x16x32_bf16 v[44:47], v[132:135], v[160:163], v[44:47]
    ds_read_b128 v[104:107], v22 offset:1664
    v_mul_f32 v191, v191, v216
    v_mfma_f32_16x16x32_bf16 v[48:51], v[132:135], v[164:167], v[48:51]
    ds_read2_b32 v[76:77], v20 offset0:160 offset1:161
    v_and_b32 v192, 0xffff0000, v241
    s_waitcnt lgkmcnt(15)
    v_mfma_f32_16x16x32_bf16 v[40:43], v[120:123], v[168:171], v[40:43]
    ds_read2_b32 v[78:79], v20 offset0:162 offset1:163
    v_mul_f32 v192, v192, v216
    v_mfma_f32_16x16x32_bf16 v[40:43], v[136:139], v[152:155], v[40:43]
    ds_read_b128 v[108:111], v22 offset:1152
    v_lshlrev_b32 v193, 16, v241
    v_mfma_f32_16x16x32_bf16 v[44:47], v[124:127], v[168:171], v[44:47]
    ds_read2_b32 v[80:81], v21 offset0:32 offset1:33
    v_mul_f32 v193, v193, v216
    v_mfma_f32_16x16x32_bf16 v[44:47], v[136:139], v[156:159], v[44:47]
    ds_read2_b32 v[82:83], v21 offset0:34 offset1:35
    v_and_b32 v194, 0xffff0000, v240
    v_mfma_f32_16x16x32_bf16 v[48:51], v[128:131], v[168:171], v[48:51]
    ds_read_b128 v[112:115], v22 offset:640
    v_mul_f32 v194, v194, v216
    v_mfma_f32_16x16x32_bf16 v[48:51], v[136:139], v[160:163], v[48:51]
    ds_read2_b32 v[84:85], v21 offset0:160 offset1:161
    v_lshlrev_b32 v195, 16, v240
    v_mfma_f32_16x16x32_bf16 v[52:55], v[132:135], v[168:171], v[52:55]
    ds_read2_b32 v[86:87], v21 offset0:162 offset1:163
    v_mul_f32 v195, v195, v216
    v_mfma_f32_16x16x32_bf16 v[52:55], v[136:139], v[164:167], v[52:55]
    ds_read_b128 v[116:119], v22 offset:128
    v_and_b32 v196, 0xffff0000, v243
    v_mfma_f32_16x16x32_bf16 v[44:47], v[120:123], v[172:175], v[44:47]
    v_mul_f32 v196, v196, v216
    v_lshlrev_b32 v197, 16, v243
    v_mfma_f32_16x16x32_bf16 v[44:47], v[140:143], v[152:155], v[44:47]
    v_mul_f32 v197, v197, v216
    v_and_b32 v198, 0xffff0000, v242
    v_mfma_f32_16x16x32_bf16 v[48:51], v[124:127], v[172:175], v[48:51]
    v_mul_f32 v198, v198, v216
    v_lshlrev_b32 v199, 16, v242
    v_mfma_f32_16x16x32_bf16 v[48:51], v[140:143], v[156:159], v[48:51]
    v_mul_f32 v199, v199, v216
    v_and_b32 v200, 0xffff0000, v245
    v_mfma_f32_16x16x32_bf16 v[52:55], v[128:131], v[172:175], v[52:55]
    v_mul_f32 v200, v200, v216
    v_lshlrev_b32 v201, 16, v245
    v_mfma_f32_16x16x32_bf16 v[52:55], v[140:143], v[160:163], v[52:55]
    v_mul_f32 v201, v201, v216
    v_and_b32 v202, 0xffff0000, v244
    v_mfma_f32_16x16x32_bf16 v[48:51], v[120:123], v[176:179], v[48:51]
    v_mul_f32 v202, v202, v216
    v_lshlrev_b32 v203, 16, v244
    v_mfma_f32_16x16x32_bf16 v[48:51], v[144:147], v[152:155], v[48:51]
    v_mul_f32 v203, v203, v216
    v_and_b32 v204, 0xffff0000, v247
    v_mfma_f32_16x16x32_bf16 v[52:55], v[124:127], v[176:179], v[52:55]
    v_mul_f32 v204, v204, v216
    v_lshlrev_b32 v205, 16, v247
    v_mfma_f32_16x16x32_bf16 v[52:55], v[144:147], v[156:159], v[52:55]
    v_mul_f32 v205, v205, v216
    v_and_b32 v206, 0xffff0000, v246
    v_mfma_f32_16x16x32_bf16 v[52:55], v[120:123], v[180:183], v[52:55]
    v_mul_f32 v206, v206, v216
    v_lshlrev_b32 v207, 16, v246
    v_mfma_f32_16x16x32_bf16 v[52:55], v[148:151], v[152:155], v[52:55]
    v_mul_f32 v207, v207, v216
    v_and_b32 v208, 0xffff0000, v249
    s_waitcnt lgkmcnt(12)
    v_mfma_f32_16x16x32_bf16 v[24:27], v[56:59], v[88:91], v[24:27]
    ds_read2_b32 v[120:121], v18 offset0:48 offset1:49
    v_mul_f32 v208, v208, v216
    v_mfma_f32_16x16x32_bf16 v[28:31], v[56:59], v[92:95], v[28:31]
    ds_read2_b32 v[122:123], v18 offset0:50 offset1:51
    v_lshlrev_b32 v209, 16, v249
    v_mfma_f32_16x16x32_bf16 v[28:31], v[60:63], v[88:91], v[28:31]
    ds_read_b128 v[152:155], v22 offset:3776
    v_mul_f32 v209, v209, v216
    v_mfma_f32_16x16x32_bf16 v[32:35], v[60:63], v[92:95], v[32:35]
    ds_read2_b32 v[124:125], v18 offset0:176 offset1:177
    v_and_b32 v210, 0xffff0000, v248
    v_mfma_f32_16x16x32_bf16 v[32:35], v[56:59], v[96:99], v[32:35]
    ds_read2_b32 v[126:127], v18 offset0:178 offset1:179
    v_mul_f32 v210, v210, v216
    v_mfma_f32_16x16x32_bf16 v[32:35], v[64:67], v[88:91], v[32:35]
    ds_read_b128 v[156:159], v22 offset:3264
    v_lshlrev_b32 v211, 16, v248
    v_mfma_f32_16x16x32_bf16 v[36:39], v[60:63], v[96:99], v[36:39]
    ds_read2_b32 v[128:129], v19 offset0:48 offset1:49
    v_mul_f32 v211, v211, v216
    v_mfma_f32_16x16x32_bf16 v[36:39], v[64:67], v[92:95], v[36:39]
    ds_read2_b32 v[130:131], v19 offset0:50 offset1:51
    v_and_b32 v212, 0xffff0000, v251
    v_mfma_f32_16x16x32_bf16 v[40:43], v[64:67], v[96:99], v[40:43]
    ds_read_b128 v[160:163], v22 offset:2752
    v_mul_f32 v212, v212, v216
    v_mfma_f32_16x16x32_bf16 v[36:39], v[56:59], v[100:103], v[36:39]
    ds_read2_b32 v[132:133], v19 offset0:176 offset1:177
    v_lshlrev_b32 v213, 16, v251
    v_mfma_f32_16x16x32_bf16 v[36:39], v[68:71], v[88:91], v[36:39]
    ds_read2_b32 v[134:135], v19 offset0:178 offset1:179
    v_mul_f32 v213, v213, v216
    v_mfma_f32_16x16x32_bf16 v[40:43], v[60:63], v[100:103], v[40:43]
    ds_read_b128 v[164:167], v22 offset:2240
    v_and_b32 v214, 0xffff0000, v250
    v_mfma_f32_16x16x32_bf16 v[40:43], v[68:71], v[92:95], v[40:43]
    ds_read2_b32 v[136:137], v20 offset0:48 offset1:49
    v_mul_f32 v214, v214, v216
    v_mfma_f32_16x16x32_bf16 v[44:47], v[64:67], v[100:103], v[44:47]
    ds_read2_b32 v[138:139], v20 offset0:50 offset1:51
    v_lshlrev_b32 v215, 16, v250
    v_mfma_f32_16x16x32_bf16 v[44:47], v[68:71], v[96:99], v[44:47]
    ds_read_b128 v[168:171], v22 offset:1728
    v_mul_f32 v215, v215, v216
    v_mfma_f32_16x16x32_bf16 v[48:51], v[68:71], v[100:103], v[48:51]
    ds_read2_b32 v[140:141], v20 offset0:176 offset1:177
    s_lshl_b32 s29, s18, 12
    s_waitcnt lgkmcnt(15)
    v_mfma_f32_16x16x32_bf16 v[40:43], v[56:59], v[104:107], v[40:43]
    ds_read2_b32 v[142:143], v20 offset0:178 offset1:179
    s_add_u32 s29, s29, s45
    v_mfma_f32_16x16x32_bf16 v[40:43], v[72:75], v[88:91], v[40:43]
    ds_read_b128 v[172:175], v22 offset:1216
    s_add_u32 s29, s29, 0x400000
    v_mfma_f32_16x16x32_bf16 v[44:47], v[60:63], v[104:107], v[44:47]
    ds_read2_b32 v[144:145], v21 offset0:48 offset1:49
    v_lshlrev_b32 v11, 9, v2
    v_mfma_f32_16x16x32_bf16 v[44:47], v[72:75], v[92:95], v[44:47]
    ds_read2_b32 v[146:147], v21 offset0:50 offset1:51
    v_lshrrev_b32 v10, 2, v2
    v_mfma_f32_16x16x32_bf16 v[48:51], v[64:67], v[104:107], v[48:51]
    ds_read_b128 v[176:179], v22 offset:704
    v_lshl_add_u32 v11, v10, 26, v11
    v_mfma_f32_16x16x32_bf16 v[48:51], v[72:75], v[96:99], v[48:51]
    ds_read2_b32 v[148:149], v21 offset0:176 offset1:177
    v_mov_b32 v254, s51
    v_mfma_f32_16x16x32_bf16 v[52:55], v[68:71], v[104:107], v[52:55]
    ds_read2_b32 v[150:151], v21 offset0:178 offset1:179
    v_mfma_f32_16x16x32_bf16 v[52:55], v[72:75], v[100:103], v[52:55]
    ds_read_b128 v[180:183], v22 offset:192
    v_mfma_f32_16x16x32_bf16 v[44:47], v[56:59], v[108:111], v[44:47]
    v_mfma_f32_16x16x32_bf16 v[44:47], v[76:79], v[88:91], v[44:47]
    v_mfma_f32_16x16x32_bf16 v[48:51], v[60:63], v[108:111], v[48:51]
    v_mfma_f32_16x16x32_bf16 v[48:51], v[76:79], v[92:95], v[48:51]
    v_mfma_f32_16x16x32_bf16 v[52:55], v[64:67], v[108:111], v[52:55]
    v_mfma_f32_16x16x32_bf16 v[52:55], v[76:79], v[96:99], v[52:55]
    v_mfma_f32_16x16x32_bf16 v[48:51], v[56:59], v[112:115], v[48:51]
    v_mfma_f32_16x16x32_bf16 v[48:51], v[80:83], v[88:91], v[48:51]
    v_mfma_f32_16x16x32_bf16 v[52:55], v[60:63], v[112:115], v[52:55]
    v_mfma_f32_16x16x32_bf16 v[52:55], v[80:83], v[92:95], v[52:55]
    v_mfma_f32_16x16x32_bf16 v[52:55], v[56:59], v[116:119], v[52:55]
    v_mfma_f32_16x16x32_bf16 v[52:55], v[84:87], v[88:91], v[52:55]
    s_waitcnt lgkmcnt(12)
    v_mfma_f32_16x16x32_bf16 v[24:27], v[120:123], v[152:155], v[24:27]
    ds_read2_b32 v[56:57], v18 offset0:64 offset1:65
    v_mfma_f32_16x16x32_bf16 v[28:31], v[120:123], v[156:159], v[28:31]
    ds_read2_b32 v[58:59], v18 offset0:66 offset1:67
    v_mfma_f32_16x16x32_bf16 v[28:31], v[124:127], v[152:155], v[28:31]
    ds_read_b128 v[88:91], v22 offset:3840
    v_mfma_f32_16x16x32_bf16 v[32:35], v[124:127], v[156:159], v[32:35]
    ds_read2_b32 v[60:61], v18 offset0:192 offset1:193
    v_mfma_f32_16x16x32_bf16 v[32:35], v[120:123], v[160:163], v[32:35]
    ds_read2_b32 v[62:63], v18 offset0:194 offset1:195
    v_mfma_f32_16x16x32_bf16 v[32:35], v[128:131], v[152:155], v[32:35]
    ds_read_b128 v[92:95], v22 offset:3328
    v_mfma_f32_16x16x32_bf16 v[36:39], v[124:127], v[160:163], v[36:39]
    ds_read2_b32 v[64:65], v19 offset0:64 offset1:65
    v_mfma_f32_16x16x32_bf16 v[36:39], v[128:131], v[156:159], v[36:39]
    ds_read2_b32 v[66:67], v19 offset0:66 offset1:67
    v_mfma_f32_16x16x32_bf16 v[40:43], v[128:131], v[160:163], v[40:43]
    ds_read_b128 v[96:99], v22 offset:2816
    v_mfma_f32_16x16x32_bf16 v[36:39], v[120:123], v[164:167], v[36:39]
    ds_read2_b32 v[68:69], v19 offset0:192 offset1:193
    v_mfma_f32_16x16x32_bf16 v[36:39], v[132:135], v[152:155], v[36:39]
    ds_read2_b32 v[70:71], v19 offset0:194 offset1:195
    v_mfma_f32_16x16x32_bf16 v[40:43], v[124:127], v[164:167], v[40:43]
    ds_read_b128 v[100:103], v22 offset:2304
    v_mfma_f32_16x16x32_bf16 v[40:43], v[132:135], v[156:159], v[40:43]
    ds_read2_b32 v[72:73], v20 offset0:64 offset1:65
    v_mfma_f32_16x16x32_bf16 v[44:47], v[128:131], v[164:167], v[44:47]
    ds_read2_b32 v[74:75], v20 offset0:66 offset1:67
    v_mfma_f32_16x16x32_bf16 v[44:47], v[132:135], v[160:163], v[44:47]
    ds_read_b128 v[104:107], v22 offset:1792
    v_mfma_f32_16x16x32_bf16 v[48:51], v[132:135], v[164:167], v[48:51]
    ds_read2_b32 v[76:77], v20 offset0:192 offset1:193
    s_waitcnt lgkmcnt(15)
    v_mfma_f32_16x16x32_bf16 v[40:43], v[120:123], v[168:171], v[40:43]
    ds_read2_b32 v[78:79], v20 offset0:194 offset1:195
    v_mfma_f32_16x16x32_bf16 v[40:43], v[136:139], v[152:155], v[40:43]
    ds_read_b128 v[108:111], v22 offset:1280
    v_mfma_f32_16x16x32_bf16 v[44:47], v[124:127], v[168:171], v[44:47]
    ds_read2_b32 v[80:81], v21 offset0:64 offset1:65
    v_mfma_f32_16x16x32_bf16 v[44:47], v[136:139], v[156:159], v[44:47]
    ds_read2_b32 v[82:83], v21 offset0:66 offset1:67
    v_mfma_f32_16x16x32_bf16 v[48:51], v[128:131], v[168:171], v[48:51]
    ds_read_b128 v[112:115], v22 offset:768
    v_mfma_f32_16x16x32_bf16 v[48:51], v[136:139], v[160:163], v[48:51]
    ds_read2_b32 v[84:85], v21 offset0:192 offset1:193
    v_mfma_f32_16x16x32_bf16 v[52:55], v[132:135], v[168:171], v[52:55]
    ds_read2_b32 v[86:87], v21 offset0:194 offset1:195
    v_mfma_f32_16x16x32_bf16 v[52:55], v[136:139], v[164:167], v[52:55]
    ds_read_b128 v[116:119], v22 offset:256
    v_mfma_f32_16x16x32_bf16 v[44:47], v[120:123], v[172:175], v[44:47]
    v_mfma_f32_16x16x32_bf16 v[44:47], v[140:143], v[152:155], v[44:47]
    v_mfma_f32_16x16x32_bf16 v[48:51], v[124:127], v[172:175], v[48:51]
    v_mfma_f32_16x16x32_bf16 v[48:51], v[140:143], v[156:159], v[48:51]
    v_mfma_f32_16x16x32_bf16 v[52:55], v[128:131], v[172:175], v[52:55]
    v_mfma_f32_16x16x32_bf16 v[52:55], v[140:143], v[160:163], v[52:55]
    v_mfma_f32_16x16x32_bf16 v[48:51], v[120:123], v[176:179], v[48:51]
    v_mfma_f32_16x16x32_bf16 v[48:51], v[144:147], v[152:155], v[48:51]
    v_mfma_f32_16x16x32_bf16 v[52:55], v[124:127], v[176:179], v[52:55]
    v_mfma_f32_16x16x32_bf16 v[52:55], v[144:147], v[156:159], v[52:55]
    v_mfma_f32_16x16x32_bf16 v[52:55], v[120:123], v[180:183], v[52:55]
    v_mfma_f32_16x16x32_bf16 v[52:55], v[148:151], v[152:155], v[52:55]
    s_waitcnt lgkmcnt(12)
    v_mfma_f32_16x16x32_bf16 v[24:27], v[56:59], v[88:91], v[24:27]
    ds_read2_b32 v[120:121], v18 offset0:80 offset1:81
    v_mfma_f32_16x16x32_bf16 v[28:31], v[56:59], v[92:95], v[28:31]
    ds_read2_b32 v[122:123], v18 offset0:82 offset1:83
    v_mfma_f32_16x16x32_bf16 v[28:31], v[60:63], v[88:91], v[28:31]
    ds_read_b128 v[152:155], v22 offset:3904
    v_mfma_f32_16x16x32_bf16 v[32:35], v[60:63], v[92:95], v[32:35]
    ds_read2_b32 v[124:125], v18 offset0:208 offset1:209
    v_mfma_f32_16x16x32_bf16 v[32:35], v[56:59], v[96:99], v[32:35]
    ds_read2_b32 v[126:127], v18 offset0:210 offset1:211
    v_mfma_f32_16x16x32_bf16 v[32:35], v[64:67], v[88:91], v[32:35]
    ds_read_b128 v[156:159], v22 offset:3392
    v_mfma_f32_16x16x32_bf16 v[36:39], v[60:63], v[96:99], v[36:39]
    ds_read2_b32 v[128:129], v19 offset0:80 offset1:81
    v_mfma_f32_16x16x32_bf16 v[36:39], v[64:67], v[92:95], v[36:39]
    ds_read2_b32 v[130:131], v19 offset0:82 offset1:83
    v_mfma_f32_16x16x32_bf16 v[40:43], v[64:67], v[96:99], v[40:43]
    ds_read_b128 v[160:163], v22 offset:2880
    v_mfma_f32_16x16x32_bf16 v[36:39], v[56:59], v[100:103], v[36:39]
    ds_read2_b32 v[132:133], v19 offset0:208 offset1:209
    v_mfma_f32_16x16x32_bf16 v[36:39], v[68:71], v[88:91], v[36:39]
    ds_read2_b32 v[134:135], v19 offset0:210 offset1:211
    v_mfma_f32_16x16x32_bf16 v[40:43], v[60:63], v[100:103], v[40:43]
    ds_read_b128 v[164:167], v22 offset:2368
    v_mfma_f32_16x16x32_bf16 v[40:43], v[68:71], v[92:95], v[40:43]
    ds_read2_b32 v[136:137], v20 offset0:80 offset1:81
    v_mfma_f32_16x16x32_bf16 v[44:47], v[64:67], v[100:103], v[44:47]
    ds_read2_b32 v[138:139], v20 offset0:82 offset1:83
    v_mfma_f32_16x16x32_bf16 v[44:47], v[68:71], v[96:99], v[44:47]
    ds_read_b128 v[168:171], v22 offset:1856
    v_mfma_f32_16x16x32_bf16 v[48:51], v[68:71], v[100:103], v[48:51]
    ds_read2_b32 v[140:141], v20 offset0:208 offset1:209
    s_waitcnt lgkmcnt(15)
    v_mfma_f32_16x16x32_bf16 v[40:43], v[56:59], v[104:107], v[40:43]
    ds_read2_b32 v[142:143], v20 offset0:210 offset1:211
    v_mfma_f32_16x16x32_bf16 v[40:43], v[72:75], v[88:91], v[40:43]
    ds_read_b128 v[172:175], v22 offset:1344
    v_mfma_f32_16x16x32_bf16 v[44:47], v[60:63], v[104:107], v[44:47]
    ds_read2_b32 v[144:145], v21 offset0:80 offset1:81
    v_mfma_f32_16x16x32_bf16 v[44:47], v[72:75], v[92:95], v[44:47]
    ds_read2_b32 v[146:147], v21 offset0:82 offset1:83
    v_mfma_f32_16x16x32_bf16 v[48:51], v[64:67], v[104:107], v[48:51]
    ds_read_b128 v[176:179], v22 offset:832
    v_mfma_f32_16x16x32_bf16 v[48:51], v[72:75], v[96:99], v[48:51]
    ds_read2_b32 v[148:149], v21 offset0:208 offset1:209
    v_mfma_f32_16x16x32_bf16 v[52:55], v[68:71], v[104:107], v[52:55]
    ds_read2_b32 v[150:151], v21 offset0:210 offset1:211
    v_mfma_f32_16x16x32_bf16 v[52:55], v[72:75], v[100:103], v[52:55]
    ds_read_b128 v[180:183], v22 offset:320
    v_mfma_f32_16x16x32_bf16 v[44:47], v[56:59], v[108:111], v[44:47]
    v_mfma_f32_16x16x32_bf16 v[44:47], v[76:79], v[88:91], v[44:47]
    v_mfma_f32_16x16x32_bf16 v[48:51], v[60:63], v[108:111], v[48:51]
    v_mfma_f32_16x16x32_bf16 v[48:51], v[76:79], v[92:95], v[48:51]
    v_mfma_f32_16x16x32_bf16 v[52:55], v[64:67], v[108:111], v[52:55]
    v_mfma_f32_16x16x32_bf16 v[52:55], v[76:79], v[96:99], v[52:55]
    v_mfma_f32_16x16x32_bf16 v[48:51], v[56:59], v[112:115], v[48:51]
    v_mfma_f32_16x16x32_bf16 v[48:51], v[80:83], v[88:91], v[48:51]
    v_mfma_f32_16x16x32_bf16 v[52:55], v[60:63], v[112:115], v[52:55]
    v_mfma_f32_16x16x32_bf16 v[52:55], v[80:83], v[92:95], v[52:55]
    v_mfma_f32_16x16x32_bf16 v[52:55], v[56:59], v[116:119], v[52:55]
    v_mfma_f32_16x16x32_bf16 v[52:55], v[84:87], v[88:91], v[52:55]
    s_waitcnt lgkmcnt(12)
    v_mfma_f32_16x16x32_bf16 v[24:27], v[120:123], v[152:155], v[24:27]
    ds_read2_b32 v[56:57], v18 offset0:96 offset1:97
    v_mfma_f32_16x16x32_bf16 v[28:31], v[120:123], v[156:159], v[28:31]
    ds_read2_b32 v[58:59], v18 offset0:98 offset1:99
    v_mfma_f32_16x16x32_bf16 v[28:31], v[124:127], v[152:155], v[28:31]
    ds_read_b128 v[88:91], v22 offset:3968
    v_mfma_f32_16x16x32_bf16 v[32:35], v[124:127], v[156:159], v[32:35]
    ds_read2_b32 v[60:61], v18 offset0:224 offset1:225
    v_mfma_f32_16x16x32_bf16 v[32:35], v[120:123], v[160:163], v[32:35]
    ds_read2_b32 v[62:63], v18 offset0:226 offset1:227
    v_mfma_f32_16x16x32_bf16 v[32:35], v[128:131], v[152:155], v[32:35]
    ds_read_b128 v[92:95], v22 offset:3456
    v_mfma_f32_16x16x32_bf16 v[36:39], v[124:127], v[160:163], v[36:39]
    ds_read2_b32 v[64:65], v19 offset0:96 offset1:97
    v_mfma_f32_16x16x32_bf16 v[36:39], v[128:131], v[156:159], v[36:39]
    ds_read2_b32 v[66:67], v19 offset0:98 offset1:99
    v_mfma_f32_16x16x32_bf16 v[40:43], v[128:131], v[160:163], v[40:43]
    ds_read_b128 v[96:99], v22 offset:2944
    v_mfma_f32_16x16x32_bf16 v[36:39], v[120:123], v[164:167], v[36:39]
    ds_read2_b32 v[68:69], v19 offset0:224 offset1:225
    v_mfma_f32_16x16x32_bf16 v[36:39], v[132:135], v[152:155], v[36:39]
    ds_read2_b32 v[70:71], v19 offset0:226 offset1:227
    v_mfma_f32_16x16x32_bf16 v[40:43], v[124:127], v[164:167], v[40:43]
    ds_read_b128 v[100:103], v22 offset:2432
    v_mfma_f32_16x16x32_bf16 v[40:43], v[132:135], v[156:159], v[40:43]
    ds_read2_b32 v[72:73], v20 offset0:96 offset1:97
    v_mfma_f32_16x16x32_bf16 v[44:47], v[128:131], v[164:167], v[44:47]
    ds_read2_b32 v[74:75], v20 offset0:98 offset1:99
    v_mfma_f32_16x16x32_bf16 v[44:47], v[132:135], v[160:163], v[44:47]
    ds_read_b128 v[104:107], v22 offset:1920
    v_mfma_f32_16x16x32_bf16 v[48:51], v[132:135], v[164:167], v[48:51]
    ds_read2_b32 v[76:77], v20 offset0:224 offset1:225
    s_waitcnt lgkmcnt(15)
    v_mfma_f32_16x16x32_bf16 v[40:43], v[120:123], v[168:171], v[40:43]
    ds_read2_b32 v[78:79], v20 offset0:226 offset1:227
    v_mfma_f32_16x16x32_bf16 v[40:43], v[136:139], v[152:155], v[40:43]
    ds_read_b128 v[108:111], v22 offset:1408
    v_mfma_f32_16x16x32_bf16 v[44:47], v[124:127], v[168:171], v[44:47]
    ds_read2_b32 v[80:81], v21 offset0:96 offset1:97
    v_mfma_f32_16x16x32_bf16 v[44:47], v[136:139], v[156:159], v[44:47]
    ds_read2_b32 v[82:83], v21 offset0:98 offset1:99
    v_mfma_f32_16x16x32_bf16 v[48:51], v[128:131], v[168:171], v[48:51]
    ds_read_b128 v[112:115], v22 offset:896
    v_mfma_f32_16x16x32_bf16 v[48:51], v[136:139], v[160:163], v[48:51]
    ds_read2_b32 v[84:85], v21 offset0:224 offset1:225
    v_mfma_f32_16x16x32_bf16 v[52:55], v[132:135], v[168:171], v[52:55]
    ds_read2_b32 v[86:87], v21 offset0:226 offset1:227
    v_mfma_f32_16x16x32_bf16 v[52:55], v[136:139], v[164:167], v[52:55]
    ds_read_b128 v[116:119], v22 offset:384
    v_mfma_f32_16x16x32_bf16 v[44:47], v[120:123], v[172:175], v[44:47]
    v_mfma_f32_16x16x32_bf16 v[44:47], v[140:143], v[152:155], v[44:47]
    v_mfma_f32_16x16x32_bf16 v[48:51], v[124:127], v[172:175], v[48:51]
    v_mfma_f32_16x16x32_bf16 v[48:51], v[140:143], v[156:159], v[48:51]
    v_mfma_f32_16x16x32_bf16 v[52:55], v[128:131], v[172:175], v[52:55]
    v_mfma_f32_16x16x32_bf16 v[52:55], v[140:143], v[160:163], v[52:55]
    v_mfma_f32_16x16x32_bf16 v[48:51], v[120:123], v[176:179], v[48:51]
    v_mfma_f32_16x16x32_bf16 v[48:51], v[144:147], v[152:155], v[48:51]
    v_mfma_f32_16x16x32_bf16 v[52:55], v[124:127], v[176:179], v[52:55]
    v_mfma_f32_16x16x32_bf16 v[52:55], v[144:147], v[156:159], v[52:55]
    v_mfma_f32_16x16x32_bf16 v[52:55], v[120:123], v[180:183], v[52:55]
    v_mfma_f32_16x16x32_bf16 v[52:55], v[148:151], v[152:155], v[52:55]
    s_waitcnt lgkmcnt(12)
    v_mfma_f32_16x16x32_bf16 v[24:27], v[56:59], v[88:91], v[24:27]
    ds_read2_b32 v[120:121], v18 offset0:112 offset1:113
    v_mfma_f32_16x16x32_bf16 v[28:31], v[56:59], v[92:95], v[28:31]
    ds_read2_b32 v[122:123], v18 offset0:114 offset1:115
    v_mfma_f32_16x16x32_bf16 v[28:31], v[60:63], v[88:91], v[28:31]
    ds_read_b128 v[152:155], v22 offset:4032
    v_mfma_f32_16x16x32_bf16 v[32:35], v[60:63], v[92:95], v[32:35]
    ds_read2_b32 v[124:125], v18 offset0:240 offset1:241
    v_mfma_f32_16x16x32_bf16 v[32:35], v[56:59], v[96:99], v[32:35]
    ds_read2_b32 v[126:127], v18 offset0:242 offset1:243
    v_mfma_f32_16x16x32_bf16 v[32:35], v[64:67], v[88:91], v[32:35]
    ds_read_b128 v[156:159], v22 offset:3520
    v_mfma_f32_16x16x32_bf16 v[36:39], v[60:63], v[96:99], v[36:39]
    ds_read2_b32 v[128:129], v19 offset0:112 offset1:113
    v_mfma_f32_16x16x32_bf16 v[36:39], v[64:67], v[92:95], v[36:39]
    ds_read2_b32 v[130:131], v19 offset0:114 offset1:115
    v_mfma_f32_16x16x32_bf16 v[40:43], v[64:67], v[96:99], v[40:43]
    ds_read_b128 v[160:163], v22 offset:3008
    v_mfma_f32_16x16x32_bf16 v[36:39], v[56:59], v[100:103], v[36:39]
    ds_read2_b32 v[132:133], v19 offset0:240 offset1:241
    v_mfma_f32_16x16x32_bf16 v[36:39], v[68:71], v[88:91], v[36:39]
    ds_read2_b32 v[134:135], v19 offset0:242 offset1:243
    v_mfma_f32_16x16x32_bf16 v[40:43], v[60:63], v[100:103], v[40:43]
    ds_read_b128 v[164:167], v22 offset:2496
    v_mfma_f32_16x16x32_bf16 v[40:43], v[68:71], v[92:95], v[40:43]
    ds_read2_b32 v[136:137], v20 offset0:112 offset1:113
    v_mfma_f32_16x16x32_bf16 v[44:47], v[64:67], v[100:103], v[44:47]
    ds_read2_b32 v[138:139], v20 offset0:114 offset1:115
    v_mfma_f32_16x16x32_bf16 v[44:47], v[68:71], v[96:99], v[44:47]
    ds_read_b128 v[168:171], v22 offset:1984
    v_mfma_f32_16x16x32_bf16 v[48:51], v[68:71], v[100:103], v[48:51]
    ds_read2_b32 v[140:141], v20 offset0:240 offset1:241
    s_waitcnt lgkmcnt(15)
    v_mfma_f32_16x16x32_bf16 v[40:43], v[56:59], v[104:107], v[40:43]
    ds_read2_b32 v[142:143], v20 offset0:242 offset1:243
    v_mfma_f32_16x16x32_bf16 v[40:43], v[72:75], v[88:91], v[40:43]
    ds_read_b128 v[172:175], v22 offset:1472
    v_mfma_f32_16x16x32_bf16 v[44:47], v[60:63], v[104:107], v[44:47]
    ds_read2_b32 v[144:145], v21 offset0:112 offset1:113
    v_mfma_f32_16x16x32_bf16 v[44:47], v[72:75], v[92:95], v[44:47]
    ds_read2_b32 v[146:147], v21 offset0:114 offset1:115
    v_mfma_f32_16x16x32_bf16 v[48:51], v[64:67], v[104:107], v[48:51]
    ds_read_b128 v[176:179], v22 offset:960
    v_mfma_f32_16x16x32_bf16 v[48:51], v[72:75], v[96:99], v[48:51]
    ds_read2_b32 v[148:149], v21 offset0:240 offset1:241
    v_mfma_f32_16x16x32_bf16 v[52:55], v[68:71], v[104:107], v[52:55]
    ds_read2_b32 v[150:151], v21 offset0:242 offset1:243
    v_mfma_f32_16x16x32_bf16 v[52:55], v[72:75], v[100:103], v[52:55]
    ds_read_b128 v[180:183], v22 offset:448
    v_mfma_f32_16x16x32_bf16 v[44:47], v[56:59], v[108:111], v[44:47]
    v_mfma_f32_16x16x32_bf16 v[44:47], v[76:79], v[88:91], v[44:47]
    v_mfma_f32_16x16x32_bf16 v[48:51], v[60:63], v[108:111], v[48:51]
    v_mfma_f32_16x16x32_bf16 v[48:51], v[76:79], v[92:95], v[48:51]
    v_mfma_f32_16x16x32_bf16 v[52:55], v[64:67], v[108:111], v[52:55]
    v_mfma_f32_16x16x32_bf16 v[52:55], v[76:79], v[96:99], v[52:55]
    v_mfma_f32_16x16x32_bf16 v[48:51], v[56:59], v[112:115], v[48:51]
    v_mfma_f32_16x16x32_bf16 v[48:51], v[80:83], v[88:91], v[48:51]
    v_mfma_f32_16x16x32_bf16 v[52:55], v[60:63], v[112:115], v[52:55]
    v_mfma_f32_16x16x32_bf16 v[52:55], v[80:83], v[92:95], v[52:55]
    v_mfma_f32_16x16x32_bf16 v[52:55], v[56:59], v[116:119], v[52:55]
    v_mfma_f32_16x16x32_bf16 v[52:55], v[84:87], v[88:91], v[52:55]
    s_waitcnt lgkmcnt(12)
    v_mfma_f32_16x16x32_bf16 v[24:27], v[120:123], v[152:155], v[24:27]
    v_mfma_f32_16x16x32_bf16 v[28:31], v[120:123], v[156:159], v[28:31]
    v_mfma_f32_16x16x32_bf16 v[28:31], v[124:127], v[152:155], v[28:31]
    v_mfma_f32_16x16x32_bf16 v[32:35], v[124:127], v[156:159], v[32:35]
    v_mfma_f32_16x16x32_bf16 v[32:35], v[120:123], v[160:163], v[32:35]
    v_mfma_f32_16x16x32_bf16 v[32:35], v[128:131], v[152:155], v[32:35]
    v_mfma_f32_16x16x32_bf16 v[36:39], v[124:127], v[160:163], v[36:39]
    v_mfma_f32_16x16x32_bf16 v[36:39], v[128:131], v[156:159], v[36:39]
    v_mfma_f32_16x16x32_bf16 v[36:39], v[120:123], v[164:167], v[36:39]
    v_mfma_f32_16x16x32_bf16 v[36:39], v[132:135], v[152:155], v[36:39]
    v_mfma_f32_16x16x32_bf16 v[40:43], v[128:131], v[160:163], v[40:43]
    v_mfma_f32_16x16x32_bf16 v[40:43], v[124:127], v[164:167], v[40:43]
    v_mfma_f32_16x16x32_bf16 v[40:43], v[132:135], v[156:159], v[40:43]
    s_waitcnt lgkmcnt(0)
    v_mfma_f32_16x16x32_bf16 v[40:43], v[120:123], v[168:171], v[40:43]
    v_mfma_f32_16x16x32_bf16 v[40:43], v[136:139], v[152:155], v[40:43]
    v_mfma_f32_16x16x32_bf16 v[44:47], v[128:131], v[164:167], v[44:47]
    v_mfma_f32_16x16x32_bf16 v[44:47], v[132:135], v[160:163], v[44:47]
    v_mfma_f32_16x16x32_bf16 v[44:47], v[124:127], v[168:171], v[44:47]
    v_mfma_f32_16x16x32_bf16 v[44:47], v[136:139], v[156:159], v[44:47]
    v_mfma_f32_16x16x32_bf16 v[44:47], v[120:123], v[172:175], v[44:47]
    v_mfma_f32_16x16x32_bf16 v[44:47], v[140:143], v[152:155], v[44:47]
    v_mfma_f32_16x16x32_bf16 v[48:51], v[132:135], v[164:167], v[48:51]
    v_mfma_f32_16x16x32_bf16 v[48:51], v[128:131], v[168:171], v[48:51]
    v_mfma_f32_16x16x32_bf16 v[48:51], v[136:139], v[160:163], v[48:51]
    v_mfma_f32_16x16x32_bf16 v[48:51], v[124:127], v[172:175], v[48:51]
    v_mfma_f32_16x16x32_bf16 v[48:51], v[140:143], v[156:159], v[48:51]
    v_mfma_f32_16x16x32_bf16 v[48:51], v[120:123], v[176:179], v[48:51]
    v_mfma_f32_16x16x32_bf16 v[48:51], v[144:147], v[152:155], v[48:51]
    v_mfma_f32_16x16x32_bf16 v[52:55], v[132:135], v[168:171], v[52:55]
    v_mfma_f32_16x16x32_bf16 v[52:55], v[136:139], v[164:167], v[52:55]
    v_mfma_f32_16x16x32_bf16 v[52:55], v[128:131], v[172:175], v[52:55]
    v_mfma_f32_16x16x32_bf16 v[52:55], v[140:143], v[160:163], v[52:55]
    v_mfma_f32_16x16x32_bf16 v[52:55], v[124:127], v[176:179], v[52:55]
    v_mfma_f32_16x16x32_bf16 v[52:55], v[144:147], v[156:159], v[52:55]
    v_mfma_f32_16x16x32_bf16 v[52:55], v[120:123], v[180:183], v[52:55]
    v_mfma_f32_16x16x32_bf16 v[52:55], v[148:151], v[152:155], v[52:55]
    s_mul_i32 s24, s18, 12928
    s_add_u32 s24, s24, 114688
    v_add_u32 v223, s24, v223
    v_cvt_pk_bf16_f32 v184, v24, v184
    v_cvt_pk_bf16_f32 v185, v25, v185
    v_cvt_pk_bf16_f32 v186, v26, v186
    v_cvt_pk_bf16_f32 v187, v27, v187
    v_cvt_pk_bf16_f32 v188, v28, v188
    v_cvt_pk_bf16_f32 v189, v29, v189
    v_cvt_pk_bf16_f32 v190, v30, v190
    v_cvt_pk_bf16_f32 v191, v31, v191
    v_cvt_pk_bf16_f32 v192, v32, v192
    v_cvt_pk_bf16_f32 v193, v33, v193
    v_cvt_pk_bf16_f32 v194, v34, v194
    v_cvt_pk_bf16_f32 v195, v35, v195
    v_cvt_pk_bf16_f32 v196, v36, v196
    v_cvt_pk_bf16_f32 v197, v37, v197
    v_cvt_pk_bf16_f32 v198, v38, v198
    v_cvt_pk_bf16_f32 v199, v39, v199
    v_dot2_f32_bf16 v184, v184, v7, 0
    v_dot2_f32_bf16 v185, v185, v7, 0
    v_dot2_f32_bf16 v186, v186, v7, 0
    v_dot2_f32_bf16 v187, v187, v7, 0
    v_dot2_f32_bf16 v188, v188, v7, 0
    v_dot2_f32_bf16 v189, v189, v7, 0
    v_dot2_f32_bf16 v190, v190, v7, 0
    v_dot2_f32_bf16 v191, v191, v7, 0
    v_dot2_f32_bf16 v192, v192, v7, 0
    v_dot2_f32_bf16 v193, v193, v7, 0
    v_dot2_f32_bf16 v194, v194, v7, 0
    v_dot2_f32_bf16 v195, v195, v7, 0
    v_dot2_f32_bf16 v196, v196, v7, 0
    v_dot2_f32_bf16 v197, v197, v7, 0
    v_dot2_f32_bf16 v198, v198, v7, 0
    v_dot2_f32_bf16 v199, v199, v7, 0
    s_nop 1
    v_cvt_pk_bf16_f32 v56, v184, v185
    v_cvt_pk_bf16_f32 v57, v186, v187
    buffer_store_dwordx2 v[56:57], v8, s[52:55], s29 offen offset:0 sc0 sc1
    v_cvt_pk_bf16_f32 v58, v188, v189
    v_cvt_pk_bf16_f32 v59, v190, v191
    buffer_store_dwordx2 v[58:59], v8, s[52:55], s29 offen offset:512 sc0 sc1
    v_cvt_pk_bf16_f32 v60, v192, v193
    v_cvt_pk_bf16_f32 v61, v194, v195
    buffer_store_dwordx2 v[60:61], v8, s[52:55], s29 offen offset:1024 sc0 sc1
    v_cvt_pk_bf16_f32 v62, v196, v197
    v_cvt_pk_bf16_f32 v63, v198, v199
    buffer_store_dwordx2 v[62:63], v8, s[52:55], s29 offen offset:1536 sc0 sc1
    v_cvt_pk_bf16_f32 v200, v40, v200
    v_cvt_pk_bf16_f32 v201, v41, v201
    v_cvt_pk_bf16_f32 v202, v42, v202
    v_cvt_pk_bf16_f32 v203, v43, v203
    v_cvt_pk_bf16_f32 v204, v44, v204
    v_cvt_pk_bf16_f32 v205, v45, v205
    v_cvt_pk_bf16_f32 v206, v46, v206
    v_cvt_pk_bf16_f32 v207, v47, v207
    v_cvt_pk_bf16_f32 v208, v48, v208
    v_cvt_pk_bf16_f32 v209, v49, v209
    v_cvt_pk_bf16_f32 v210, v50, v210
    v_cvt_pk_bf16_f32 v211, v51, v211
    v_cvt_pk_bf16_f32 v212, v52, v212
    v_cvt_pk_bf16_f32 v213, v53, v213
    v_cvt_pk_bf16_f32 v214, v54, v214
    v_cvt_pk_bf16_f32 v215, v55, v215
    v_dot2_f32_bf16 v200, v200, v7, 0
    v_dot2_f32_bf16 v201, v201, v7, 0
    v_dot2_f32_bf16 v202, v202, v7, 0
    v_dot2_f32_bf16 v203, v203, v7, 0
    v_dot2_f32_bf16 v204, v204, v7, 0
    v_dot2_f32_bf16 v205, v205, v7, 0
    v_dot2_f32_bf16 v206, v206, v7, 0
    v_dot2_f32_bf16 v207, v207, v7, 0
    v_dot2_f32_bf16 v208, v208, v7, 0
    v_dot2_f32_bf16 v209, v209, v7, 0
    v_dot2_f32_bf16 v210, v210, v7, 0
    v_dot2_f32_bf16 v211, v211, v7, 0
    v_dot2_f32_bf16 v212, v212, v7, 0
    v_dot2_f32_bf16 v213, v213, v7, 0
    v_dot2_f32_bf16 v214, v214, v7, 0
    v_dot2_f32_bf16 v215, v215, v7, 0
    s_nop 1
    v_cvt_pk_bf16_f32 v64, v200, v201
    v_cvt_pk_bf16_f32 v65, v202, v203
    buffer_store_dwordx2 v[64:65], v8, s[52:55], s29 offen offset:2048 sc0 sc1
    v_cvt_pk_bf16_f32 v66, v204, v205
    v_cvt_pk_bf16_f32 v67, v206, v207
    buffer_store_dwordx2 v[66:67], v8, s[52:55], s29 offen offset:2560 sc0 sc1
    v_cvt_pk_bf16_f32 v68, v208, v209
    v_cvt_pk_bf16_f32 v69, v210, v211
    buffer_store_dwordx2 v[68:69], v8, s[52:55], s29 offen offset:3072 sc0 sc1
    v_cvt_pk_bf16_f32 v70, v212, v213
    v_cvt_pk_bf16_f32 v71, v214, v215
    buffer_store_dwordx2 v[70:71], v8, s[52:55], s29 offen offset:3584 sc0 sc1
    s_add_u32 m0, s24, 0
    s_nop 0
    buffer_load_dwordx4 v220, s[84:87], s76 offen lds
    s_add_u32 s76, s76, 8192
    s_add_u32 m0, s24, 1024
    s_nop 0
    buffer_load_dwordx4 v220, s[84:87], s76 offen lds
    s_add_u32 s76, s76, 8192
    s_add_u32 m0, s24, 2048
    s_nop 0
    buffer_load_dwordx4 v220, s[84:87], s76 offen lds
    s_add_u32 s76, s76, 8192
    s_add_u32 m0, s24, 3072
    s_nop 0
    buffer_load_dwordx4 v220, s[84:87], s76 offen lds
    s_add_u32 s76, s76, 8192
    s_add_u32 m0, s24, 4096
    s_nop 0
    buffer_load_dwordx4 v220, s[84:87], s76 offen lds
    s_add_u32 s76, s76, 8192
    s_add_u32 m0, s24, 5120
    s_nop 0
    buffer_load_dwordx4 v220, s[84:87], s76 offen lds
    s_add_u32 s76, s76, 8192
    s_add_u32 m0, s24, 6144
    s_nop 0
    buffer_load_dwordx4 v220, s[84:87], s76 offen lds
    s_add_u32 s76, s76, 8192
    s_add_u32 m0, s24, 7168
    s_nop 0
    buffer_load_dwordx4 v220, s[84:87], s76 offen lds
    s_add_u32 s76, s76, 8192
    s_add_u32 m0, s24, 8192
    s_nop 0
    buffer_load_dwordx4 v220, s[84:87], s76 offen lds
    s_add_u32 s76, s76, 8192
    s_add_u32 m0, s24, 9216
    s_nop 0
    buffer_load_dwordx4 v220, s[84:87], s76 offen lds
    s_add_u32 s76, s76, 8192
    s_add_u32 m0, s24, 10240
    s_nop 0
    buffer_load_dwordx4 v220, s[84:87], s76 offen lds
    s_add_u32 s76, s76, 8192
    s_add_u32 m0, s24, 11264
    s_nop 0
    buffer_load_dwordx4 v220, s[84:87], s76 offen lds
    s_add_u32 s76, s76, 8192
    s_waitcnt vmcnt(12)
    buffer_store_dwordx2 v[254:255], v11, s[52:55], s30 offen sc0 sc1
    v_mov_b32 v218, 1
    v_lshlrev_b32 v29, 7, v2
    s_mov_b32 s64, s82
    s_and_b32 s65, s83, 0xffff
    s_mov_b32 s66, 0xe00
    v_and_b32 v10, 12, v3
    v_add_u32 v10, v10, v3
    v_lshlrev_b32 v10, 1, v10
    v_lshlrev_b32 v11, 1, v3
    s_mul_i32 s26, s17, 224
    buffer_load_ushort v204, v10, s[64:67], s26 offen offset:0
    buffer_load_ushort v205, v10, s[64:67], s26 offen offset:8
    buffer_load_ushort v206, v10, s[64:67], s26 offen offset:64
    buffer_load_ushort v207, v10, s[64:67], s26 offen offset:72
    buffer_load_ushort v208, v10, s[64:67], s26 offen offset:128
    buffer_load_ushort v209, v10, s[64:67], s26 offen offset:136
    buffer_load_ushort v210, v11, s[64:67], s26 offen offset:192
    v_mov_b32 v19, v9
    v_lshlrev_b32 v0, 9, v4
    v_lshl_add_u32 v0, v3, 4, v0
    v_lshrrev_b32 v1, 1, v4
    v_lshlrev_b32 v1, 9, v1
    v_lshl_add_u32 v1, v3, 4, v1
    v_and_b32 v18, 1, v4
    v_lshl_add_u32 v1, v18, 3, v1
    v_lshlrev_b32 v8, 2, v3
    v_lshl_add_u32 v8, v4, 28, v8
    v_lshlrev_b32 v18, 2, v3
    v_add_u32 v18, 159744, v18
    v_cmp_eq_u32 s[34:35], 0, v4
    v_lshlrev_b32 v3, 6, v3
    v_lshl_add_u32 v4, v4, 4, v3
    v_mov_b32 v3, v16
    v_mov_b32 v5, v230
    v_mov_b32 v9, v222
    v_mov_b32 v11, v231
    v_add_u32 v6, 57344, v3
    v_lshrrev_b32 v20, 3, v2
    v_and_b32 v21, 7, v2
    v_lshlrev_b32 v12, 8, v21
    v_lshl_add_u32 v12, v20, 4, v12
    v_mul_u32_u24 v10, 544, v21
    v_lshl_add_u32 v10, v20, 4, v10
    s_lshl_b32 s26, s18, 7
    s_add_u32 s26, s26, 114688
    v_add_u32 v10, s26, v10
    s_mul_i32 s26, s18, 8704
    s_add_u32 s26, s26, 114688
    v_and_b32 v2, 32, v2
    v_add3_u32 v2, v2, v3, s26
    s_mov_b32 s44, s46
    buffer_load_dwordx2 v[92:93], v5, s[52:55], s7 offen offset:0 sc1
    buffer_load_dwordx2 v[120:121], v5, s[52:55], s7 offen offset:1024 sc1
    v_accvgpr_read_b32 v90, a224
    v_lshlrev_b32 v72, 16, v90
    v_and_b32 v73, 0xffff0000, v90
    v_accvgpr_read_b32 v90, a225
    v_lshlrev_b32 v74, 16, v90
    v_and_b32 v75, 0xffff0000, v90
    v_accvgpr_read_b32 v90, a226
    v_lshlrev_b32 v76, 16, v90
    v_and_b32 v77, 0xffff0000, v90
    v_accvgpr_read_b32 v90, a227
    s_waitcnt vmcnt(19)
    ds_read_b64_tr_b16 a[0:1], v223 offset:0
    ds_read_b64_tr_b16 a[2:3], v223 offset:512
    ds_read_b64_tr_b16 a[4:5], v223 offset:64
    ds_read_b64_tr_b16 a[6:7], v223 offset:576
    v_lshlrev_b32 v78, 16, v90
    v_and_b32 v79, 0xffff0000, v90
    v_accvgpr_read_b32 v118, a228
    v_lshlrev_b32 v100, 16, v118
    v_and_b32 v101, 0xffff0000, v118
    v_accvgpr_read_b32 v118, a229
    v_lshlrev_b32 v102, 16, v118
    v_and_b32 v103, 0xffff0000, v118
    v_accvgpr_read_b32 v118, a230
    v_lshlrev_b32 v104, 16, v118
    s_waitcnt vmcnt(17)
    ds_read_b64_tr_b16 a[8:9], v223 offset:2048
    ds_read_b64_tr_b16 a[10:11], v223 offset:2560
    ds_read_b64_tr_b16 a[12:13], v223 offset:2112
    ds_read_b64_tr_b16 a[14:15], v223 offset:2624
    s_waitcnt lgkmcnt(4)
    s_add_u32 m0, s24, 0
    s_nop 0
    buffer_load_dwordx4 v220, s[84:87], s76 offen lds
    s_add_u32 s76, s76, 8192
    s_add_u32 m0, s24, 1024
    s_nop 0
    buffer_load_dwordx4 v220, s[84:87], s76 offen lds
    s_add_u32 s76, s76, 8192
    v_and_b32 v105, 0xffff0000, v118
    v_accvgpr_read_b32 v118, a231
    v_lshlrev_b32 v106, 16, v118
    v_and_b32 v107, 0xffff0000, v118
    s_waitcnt vmcnt(3)
    v_cmp_gt_i32 vcc, 0, v93
    s_cbranch_vccnz SWAIT_13
SOK_12:
    s_nop 0
    v_add_f32_dpp v92, v92, v92 quad_perm:[1,0,3,2] row_mask:0xf bank_mask:0xf
    v_add_f32_dpp v93, v93, v93 quad_perm:[1,0,3,2] row_mask:0xf bank_mask:0xf
    s_nop 0
    v_add_f32_dpp v92, v92, v92 quad_perm:[2,3,0,1] row_mask:0xf bank_mask:0xf
    ds_read_b64_tr_b16 a[16:17], v223 offset:4096
    ds_read_b64_tr_b16 a[18:19], v223 offset:4608
    ds_read_b64_tr_b16 a[20:21], v223 offset:4160
    ds_read_b64_tr_b16 a[22:23], v223 offset:4672
    s_waitcnt lgkmcnt(4)
    s_add_u32 m0, s24, 2048
    s_nop 0
    buffer_load_dwordx4 v220, s[84:87], s76 offen lds
    s_add_u32 s76, s76, 8192
    s_add_u32 m0, s24, 3072
    s_nop 0
    buffer_load_dwordx4 v220, s[84:87], s76 offen lds
    s_add_u32 s76, s76, 8192
    v_add_f32_dpp v93, v93, v93 quad_perm:[2,3,0,1] row_mask:0xf bank_mask:0xf
    s_nop 0
    v_add_f32_dpp v92, v92, v92 row_half_mirror row_mask:0xf bank_mask:0xf
    v_add_f32_dpp v93, v93, v93 row_half_mirror row_mask:0xf bank_mask:0xf
    v_mul_f32 v92, 0x3b000000, v92
    v_mul_f32 v94, 0x3b000000, v93
    v_fma_f32 v94, -v92, v92, v94
    v_max_f32 v94, 0, v94
    v_cvt_pk_bf16_f32 v90, v92, v94
    v_lshlrev_b32 v92, 16, v90
    ds_read_b64_tr_b16 a[24:25], v223 offset:6144
    ds_read_b64_tr_b16 a[26:27], v223 offset:6656
    ds_read_b64_tr_b16 a[28:29], v223 offset:6208
    ds_read_b64_tr_b16 a[30:31], v223 offset:6720
    s_waitcnt lgkmcnt(4)
    s_add_u32 m0, s24, 4096
    s_nop 0
    buffer_load_dwordx4 v220, s[84:87], s76 offen lds
    s_add_u32 s76, s76, 8192
    s_add_u32 m0, s24, 5120
    s_nop 0
    buffer_load_dwordx4 v220, s[84:87], s76 offen lds
    s_add_u32 s76, s76, 8192
    v_and_b32 v94, 0xffff0000, v90
    v_add_f32 v94, 0x3727c5ac, v94
    v_cvt_pk_bf16_f32 v90, v94, v94
    v_lshlrev_b32 v94, 16, v90
    v_sqrt_f32 v94, v94
    s_nop 0
    v_cvt_pk_bf16_f32 v90, v94, v94
    v_lshlrev_b32 v94, 16, v90
    v_rcp_f32 v94, v94
    s_nop 0
    ds_read_b64_tr_b16 a[32:33], v223 offset:8192
    ds_read_b64_tr_b16 a[34:35], v223 offset:8704
    ds_read_b64_tr_b16 a[36:37], v223 offset:8256
    ds_read_b64_tr_b16 a[38:39], v223 offset:8768
    s_waitcnt lgkmcnt(4)
    s_add_u32 m0, s24, 6144
    s_nop 0
    buffer_load_dwordx4 v220, s[84:87], s76 offen lds
    s_add_u32 s76, s76, 8192
    s_add_u32 m0, s24, 7168
    s_nop 0
    buffer_load_dwordx4 v220, s[84:87], s76 offen lds
    s_add_u32 s76, s76, 8192
    v_pk_add_f32 v[80:81], v[72:73], v[92:93] op_sel_hi:[1,0] neg_lo:[0,1] neg_hi:[0,1]
    v_pk_add_f32 v[82:83], v[74:75], v[92:93] op_sel_hi:[1,0] neg_lo:[0,1] neg_hi:[0,1]
    v_pk_add_f32 v[84:85], v[76:77], v[92:93] op_sel_hi:[1,0] neg_lo:[0,1] neg_hi:[0,1]
    v_pk_add_f32 v[86:87], v[78:79], v[92:93] op_sel_hi:[1,0] neg_lo:[0,1] neg_hi:[0,1]
    v_cvt_pk_bf16_f32 v96, v80, v84
    v_cvt_pk_bf16_f32 v97, v81, v85
    v_cvt_pk_bf16_f32 v98, v82, v86
    v_cvt_pk_bf16_f32 v99, v83, v87
    v_lshlrev_b32 v80, 16, v96
    v_and_b32 v84, 0xffff0000, v96
    ds_read_b64_tr_b16 a[40:41], v223 offset:10240
    ds_read_b64_tr_b16 a[42:43], v223 offset:10752
    ds_read_b64_tr_b16 a[44:45], v223 offset:10304
    ds_read_b64_tr_b16 a[46:47], v223 offset:10816
    s_waitcnt lgkmcnt(4)
    s_add_u32 m0, s24, 8192
    s_nop 0
    buffer_load_dwordx4 v220, s[84:87], s76 offen lds
    s_add_u32 s76, s76, 8192
    s_add_u32 m0, s24, 9216
    s_nop 0
    buffer_load_dwordx4 v220, s[84:87], s76 offen lds
    s_add_u32 s76, s76, 8192
    v_lshlrev_b32 v81, 16, v97
    v_and_b32 v85, 0xffff0000, v97
    v_lshlrev_b32 v82, 16, v98
    v_and_b32 v86, 0xffff0000, v98
    v_lshlrev_b32 v83, 16, v99
    v_and_b32 v87, 0xffff0000, v99
    v_pk_mul_f32 v[80:81], v[80:81], v[94:95] op_sel_hi:[1,0]
    v_pk_mul_f32 v[82:83], v[82:83], v[94:95] op_sel_hi:[1,0]
    v_pk_mul_f32 v[84:85], v[84:85], v[94:95] op_sel_hi:[1,0]
    v_pk_mul_f32 v[86:87], v[86:87], v[94:95] op_sel_hi:[1,0]
    s_waitcnt vmcnt(8)
    ds_read_b64_tr_b16 a[48:49], v223 offset:0
    ds_read_b64_tr_b16 a[50:51], v223 offset:512
    ds_read_b64_tr_b16 a[52:53], v223 offset:64
    ds_read_b64_tr_b16 a[54:55], v223 offset:576
    s_waitcnt lgkmcnt(4)
    s_add_u32 m0, s24, 10240
    s_nop 0
    buffer_load_dwordx4 v220, s[84:87], s76 offen lds
    s_add_u32 s76, s76, 8192
    s_add_u32 m0, s24, 11264
    s_nop 0
    buffer_load_dwordx4 v220, s[84:87], s76 offen lds
    s_add_u32 s76, s76, 8192
    v_cvt_pk_bf16_f32 v96, v80, v84
    v_cvt_pk_bf16_f32 v97, v81, v85
    v_cvt_pk_bf16_f32 v98, v82, v86
    v_cvt_pk_bf16_f32 v99, v83, v87
    v_lshlrev_b32 v80, 16, v96
    v_and_b32 v84, 0xffff0000, v96
    v_lshlrev_b32 v81, 16, v97
    v_and_b32 v85, 0xffff0000, v97
    v_lshlrev_b32 v82, 16, v98
    v_and_b32 v86, 0xffff0000, v98
    s_waitcnt vmcnt(8)
    ds_read_b64_tr_b16 a[56:57], v223 offset:2048
    ds_read_b64_tr_b16 a[58:59], v223 offset:2560
    ds_read_b64_tr_b16 a[60:61], v223 offset:2112
    ds_read_b64_tr_b16 a[62:63], v223 offset:2624
    s_waitcnt lgkmcnt(4)
    s_add_u32 m0, s24, 0
    s_nop 0
    buffer_load_dwordx4 v220, s[84:87], s76 offen lds
    s_add_u32 s76, s76, 8192
    s_add_u32 m0, s24, 1024
    s_nop 0
    buffer_load_dwordx4 v220, s[84:87], s76 offen lds
    s_add_u32 s76, s76, 8192
    v_lshlrev_b32 v83, 16, v99
    v_and_b32 v87, 0xffff0000, v99
    v_cmp_gt_i32 vcc, 0, v121
    s_cbranch_vccnz SWAIT_16
SOK_15:
    s_nop 0
    v_add_f32_dpp v120, v120, v120 quad_perm:[1,0,3,2] row_mask:0xf bank_mask:0xf
    v_add_f32_dpp v121, v121, v121 quad_perm:[1,0,3,2] row_mask:0xf bank_mask:0xf
    s_nop 0
    ds_write_b32 v219, v218 offset:16
    v_add_f32_dpp v120, v120, v120 quad_perm:[2,3,0,1] row_mask:0xf bank_mask:0xf
    v_add_f32_dpp v121, v121, v121 quad_perm:[2,3,0,1] row_mask:0xf bank_mask:0xf
    s_waitcnt vmcnt(8)
    ds_read_b64_tr_b16 a[64:65], v223 offset:4096
    ds_read_b64_tr_b16 a[66:67], v223 offset:4608
    ds_read_b64_tr_b16 a[68:69], v223 offset:4160
    ds_read_b64_tr_b16 a[70:71], v223 offset:4672
    s_waitcnt lgkmcnt(5)
    s_add_u32 m0, s24, 2048
    s_nop 0
    buffer_load_dwordx4 v220, s[84:87], s76 offen lds
    s_add_u32 s76, s76, 8192
    s_add_u32 m0, s24, 3072
    s_nop 0
    buffer_load_dwordx4 v220, s[84:87], s76 offen lds
    s_add_u32 s76, s76, 8192
    s_nop 0
    v_add_f32_dpp v120, v120, v120 row_half_mirror row_mask:0xf bank_mask:0xf
    v_add_f32_dpp v121, v121, v121 row_half_mirror row_mask:0xf bank_mask:0xf
    v_mul_f32 v120, 0x3b000000, v120
    v_mul_f32 v122, 0x3b000000, v121
    v_fma_f32 v122, -v120, v120, v122
    v_max_f32 v122, 0, v122
    v_cvt_pk_bf16_f32 v118, v120, v122
    v_lshlrev_b32 v120, 16, v118
    v_and_b32 v122, 0xffff0000, v118
    s_waitcnt vmcnt(8)
    ds_read_b64_tr_b16 a[72:73], v223 offset:6144
    ds_read_b64_tr_b16 a[74:75], v223 offset:6656
    ds_read_b64_tr_b16 a[76:77], v223 offset:6208
    ds_read_b64_tr_b16 a[78:79], v223 offset:6720
    s_waitcnt lgkmcnt(4)
    s_add_u32 m0, s24, 4096
    s_nop 0
    buffer_load_dwordx4 v220, s[84:87], s76 offen lds
    s_add_u32 s76, s76, 8192
    s_add_u32 m0, s24, 5120
    s_nop 0
    buffer_load_dwordx4 v220, s[84:87], s76 offen lds
    s_add_u32 s76, s76, 8192
    v_add_f32 v122, 0x3727c5ac, v122
    v_cvt_pk_bf16_f32 v118, v122, v122
    v_lshlrev_b32 v122, 16, v118
    v_sqrt_f32 v122, v122
    s_nop 0
    v_cvt_pk_bf16_f32 v118, v122, v122
    v_lshlrev_b32 v122, 16, v118
    v_rcp_f32 v122, v122
    s_nop 0
    v_pk_add_f32 v[108:109], v[100:101], v[120:121] op_sel_hi:[1,0] neg_lo:[0,1] neg_hi:[0,1]
    s_waitcnt vmcnt(8)
    ds_read_b64_tr_b16 a[80:81], v223 offset:8192
    ds_read_b64_tr_b16 a[82:83], v223 offset:8704
    ds_read_b64_tr_b16 a[84:85], v223 offset:8256
    ds_read_b64_tr_b16 a[86:87], v223 offset:8768
    s_waitcnt lgkmcnt(4)
    s_add_u32 m0, s24, 6144
    s_nop 0
    buffer_load_dwordx4 v220, s[84:87], s76 offen lds
    s_add_u32 s76, s76, 8192
    s_add_u32 m0, s24, 7168
    s_nop 0
    buffer_load_dwordx4 v220, s[84:87], s76 offen lds
    s_add_u32 s76, s76, 8192
    v_pk_add_f32 v[110:111], v[102:103], v[120:121] op_sel_hi:[1,0] neg_lo:[0,1] neg_hi:[0,1]
    v_pk_add_f32 v[112:113], v[104:105], v[120:121] op_sel_hi:[1,0] neg_lo:[0,1] neg_hi:[0,1]
    v_pk_add_f32 v[114:115], v[106:107], v[120:121] op_sel_hi:[1,0] neg_lo:[0,1] neg_hi:[0,1]
    v_cvt_pk_bf16_f32 v124, v108, v112
    v_cvt_pk_bf16_f32 v125, v109, v113
    v_cvt_pk_bf16_f32 v126, v110, v114
    v_cvt_pk_bf16_f32 v127, v111, v115
    v_lshlrev_b32 v108, 16, v124
    v_and_b32 v112, 0xffff0000, v124
    v_lshlrev_b32 v109, 16, v125
    s_waitcnt vmcnt(8)
    ds_read_b64_tr_b16 a[88:89], v223 offset:10240
    ds_read_b64_tr_b16 a[90:91], v223 offset:10752
    ds_read_b64_tr_b16 a[92:93], v223 offset:10304
    ds_read_b64_tr_b16 a[94:95], v223 offset:10816
    v_and_b32 v113, 0xffff0000, v125
    v_lshlrev_b32 v110, 16, v126
    v_and_b32 v114, 0xffff0000, v126
    v_lshlrev_b32 v111, 16, v127
    v_and_b32 v115, 0xffff0000, v127
    v_pk_mul_f32 v[108:109], v[108:109], v[122:123] op_sel_hi:[1,0]
    v_pk_mul_f32 v[110:111], v[110:111], v[122:123] op_sel_hi:[1,0]
    v_pk_mul_f32 v[112:113], v[112:113], v[122:123] op_sel_hi:[1,0]
    v_pk_mul_f32 v[114:115], v[114:115], v[122:123] op_sel_hi:[1,0]
    v_cvt_pk_bf16_f32 v124, v108, v112
    s_waitcnt vmcnt(6)
    ds_read_b64_tr_b16 a[96:97], v223 offset:0
    ds_read_b64_tr_b16 a[98:99], v223 offset:512
    ds_read_b64_tr_b16 a[100:101], v223 offset:64
    ds_read_b64_tr_b16 a[102:103], v223 offset:576
    v_cvt_pk_bf16_f32 v125, v109, v113
    v_cvt_pk_bf16_f32 v126, v110, v114
    v_cvt_pk_bf16_f32 v127, v111, v115
    v_lshlrev_b32 v108, 16, v124
    v_and_b32 v112, 0xffff0000, v124
    v_lshlrev_b32 v109, 16, v125
    v_and_b32 v113, 0xffff0000, v125
    v_lshlrev_b32 v110, 16, v126
    v_and_b32 v114, 0xffff0000, v126
    v_lshlrev_b32 v111, 16, v127
    s_waitcnt vmcnt(4)
    ds_read_b64_tr_b16 a[104:105], v223 offset:2048
    ds_read_b64_tr_b16 a[106:107], v223 offset:2560
    ds_read_b64_tr_b16 a[108:109], v223 offset:2112
    ds_read_b64_tr_b16 a[110:111], v223 offset:2624
    v_and_b32 v115, 0xffff0000, v127
    s_add_u32 s7, s7, 0x20000
    s_lshl_b32 s46, s12, 15
    s_lshl_b32 s47, s20, 7
    s_lshl_b32 s77, s20, 18
    s_add_u32 s77, s77, 0x400000
    s_waitcnt vmcnt(2)
    ds_read_b64_tr_b16 a[112:113], v223 offset:4096
    ds_read_b64_tr_b16 a[114:115], v223 offset:4608
    ds_read_b64_tr_b16 a[116:117], v223 offset:4160
    ds_read_b64_tr_b16 a[118:119], v223 offset:4672
    s_waitcnt vmcnt(0)
    ds_read_b64_tr_b16 a[120:121], v223 offset:6144
    ds_read_b64_tr_b16 a[122:123], v223 offset:6656
    ds_read_b64_tr_b16 a[124:125], v223 offset:6208
    ds_read_b64_tr_b16 a[126:127], v223 offset:6720
    s_waitcnt lgkmcnt(0)
    s_add_u32 m0, s24, 0
    s_nop 0
    buffer_load_dwordx4 v220, s[84:87], s76 offen lds
    s_add_u32 s76, s76, 8192
    s_add_u32 m0, s24, 1024
    s_nop 0
    buffer_load_dwordx4 v220, s[84:87], s76 offen lds
    s_add_u32 s76, s76, 8192
    s_add_u32 m0, s24, 2048
    s_nop 0
    buffer_load_dwordx4 v220, s[84:87], s76 offen lds
    s_add_u32 s76, s76, 8192
    s_add_u32 m0, s24, 3072
    s_nop 0
    buffer_load_dwordx4 v220, s[84:87], s76 offen lds
    s_add_u32 s76, s76, 8192
    s_add_u32 m0, s24, 4096
    s_nop 0
    buffer_load_dwordx4 v220, s[84:87], s76 offen lds
    s_add_u32 s76, s76, 8192
    s_add_u32 m0, s24, 5120
    s_nop 0
    buffer_load_dwordx4 v220, s[84:87], s76 offen lds
    s_add_u32 s76, s76, 8192
    s_add_u32 m0, s24, 6144
    s_nop 0
    buffer_load_dwordx4 v220, s[84:87], s76 offen lds
    s_add_u32 s76, s76, 8192
    s_add_u32 m0, s24, 7168
    s_nop 0
    buffer_load_dwordx4 v220, s[84:87], s76 offen lds
    s_add_u32 s76, s76, 8192
    s_branch K_JOIN
K_ROLEB:
    s_lshl_b32 s26, s27, 1
    s_add_u32 s36, s26, s23
    s_and_b32 s26, s36, 15
    s_lshl_b32 s26, s26, 21
    buffer_load_dword v228, v17, s[52:55], s26 offen offset:2048
    s_lshl_b32 s26, s2, 1
    s_add_u32 s26, s26, s23
    s_mul_i32 s26, s26, 3584
    v_min_u32 v5, 27, v2
    v_lshlrev_b32 v5, 7, v5
    v_mov_b32 v5, 0
    s_mov_b32 s64, s98
    s_and_b32 s65, s99, 0xffff
    s_mov_b32 s66, 0x1c0000
    buffer_load_dword v227, v5, s[64:67], s26 offen
    s_mov_b32 s64, s94
    s_and_b32 s65, s95, 0xffff
    s_mov_b32 s66, 0x1c0000
    buffer_load_dword v227, v5, s[64:67], s26 offen
    s_mov_b32 s64, s88
    s_and_b32 s65, s89, 0xffff
    s_mov_b32 s66, 0x200000
    s_lshl_b32 s26, s23, 12
    s_add_u32 s26, s26, s45
    v_subrev_u32 v7, 4, v16
    buffer_load_dwordx4 v[164:167], v16, s[64:67], s26 offen offset:0 nt
    buffer_load_dword v180, v7, s[64:67], s26 offen nt
    buffer_load_dwordx4 v[168:171], v16, s[64:67], s26 offen offset:1024 nt
    buffer_load_dword v181, v16, s[64:67], s26 offen offset:1020 nt
    buffer_load_dwordx4 v[172:175], v16, s[64:67], s26 offen offset:2048 nt
    buffer_load_dword v182, v16, s[64:67], s26 offen offset:2044 nt
    buffer_load_dwordx4 v[176:179], v16, s[64:67], s26 offen offset:3072 nt
    buffer_load_dword v183, v16, s[64:67], s26 offen offset:3068 nt
    s_mov_b32 s64, s96
    s_and_b32 s65, s97, 0xffff
    s_mov_b32 s66, 0xe00
    v_lshlrev_b32 v5, 6, v2
    buffer_load_dword v227, v5, s[64:67], 0 offen
    s_mov_b32 s64, s90
    s_and_b32 s65, s91, 0xffff
    s_mov_b32 s66, 0x400
    buffer_load_dword v227, v5, s[64:67], 0 offen
    s_lshl_b32 s26, s6, 5
    s_lshl_b32 s32, s23, 4
    s_add_u32 s26, s26, s32
    v_lshl_add_u32 v9, v11, 1, s26
    v_lshlrev_b32 v5, 10, v9
    v_lshl_add_u32 v5, v10, 4, v5
    v_accvgpr_write_b32 a255, v5
    s_mov_b32 s64, s80
    s_and_b32 s65, s81, 0xffff
    s_mov_b32 s66, 0x200000
    s_lshl_b32 s26, s20, 7
    buffer_load_dwordx4 a[224:227], v5, s[64:67], s26 offen offset:0 nt
    buffer_load_dwordx4 a[228:231], v5, s[64:67], s26 offen offset:1024 nt
    v_lshlrev_b32 v5, 15, v10
    v_lshl_add_u32 v9, v9, 1, v5
    s_and_b32 s57, s57, 0xffff
    s_mov_b32 s58, 0x200000
    s_mov_b32 s59, 0x20000
    s_and_b32 s61, s61, 0xffff
    s_mov_b32 s62, 0x400
    s_mov_b32 s63, 0x20000
    s_lshl_b32 s30, s21, 7
    s_add_u32 s30, s30, s27
    s_lshl_b32 s30, s30, 1
    s_add_u32 s30, s30, s23
    s_lshl_b32 s30, s30, 3
    s_add_u32 s30, s30, 0x800000
    v_lshlrev_b32 v8, 5, v3
    v_lshl_add_u32 v8, v4, 3, v8
    s_mov_b32 s78, 0x05040100
    s_mov_b32 s79, 0x07060302
    v_and_b32 v5, 1, v3
    v_cmp_eq_u32 vcc, 1, v5
    v_mov_b32 v6, 123508
    v_mov_b32 v7, 119346
    v_cndmask_b32 v5, v6, v7, vcc
    v_lshl_add_u32 v5, v3, 1, v5
    v_lshlrev_b32 v6, 4, v4
    v_sub_u32 v5, v5, v6
    s_mul_i32 s26, s23, 12928
    v_add_u32 v18, s26, v5
    v_add_u32 v19, 1024, v18
    v_add_u32 v20, 2048, v18
    v_add_u32 v21, 3072, v18
    s_mul_i32 s26, s23, 12928
    s_add_u32 s26, s26, 115216
    v_lshlrev_b32 v22, 5, v3
    v_lshl_add_u32 v22, v4, 4, v22
    v_sub_u32 v22, s26, v22
    v_cmp_eq_u32 vcc, 0, v2
    v_lshlrev_b32 v230, 3, v2
    v_and_b32 v229, 56, v230
    v_cndmask_b32 v222, v14, 0, vcc
    v_and_b32 v231, 0xf8, v230
    s_lshl_b32 s47, s21, 8
    s_add_u32 s47, s47, 0x80e400
    buffer_load_dword v227, v17, s[60:63], 0 offen
    buffer_load_dword v228, v17, s[56:59], 0 offen
    v_lshrrev_b32 v24, 2, v2
    v_mul_u32_u24 v24, 3584, v24
    v_and_b32 v5, 3, v2
    v_lshl_add_u32 v24, v5, 4, v24
    v_lshrrev_b32 v25, 1, v2
    v_mul_u32_u24 v25, 3584, v25
    v_and_b32 v6, 1, v2
    v_lshl_add_u32 v25, v6, 4, v25
    s_mul_i32 s25, s23, 57344
    v_bfe_u32 v30, v2, 2, 2
    v_lshrrev_b32 v31, 4, v2
    v_lshl_add_u32 v30, v31, 3, v30
    v_and_b32 v31, 3, v2
    v_lshrrev_b32 v30, 4, v2
    v_mul_u32_u24 v30, 1792, v30
    v_add_u32 v30, s25, v30
    v_and_b32 v31, 15, v2
    v_lshl_add_u32 v26, v31, 4, v30
    v_lshl_add_u32 v27, v31, 3, v30
    v_add_u32 v28, s25, v16
    v_mov_b32 v32, 0x3f803f80
    v_mov_b32 v33, 0x3f803f80
    v_mov_b32 v34, 0x3f803f80
    v_mov_b32 v35, 0x3f803f80
    s_mul_i32 s31, s23, 917504
    s_mul_i32 s26, s17, 224
    s_add_u32 s31, s31, s26
    s_mov_b32 s64, s94
    s_and_b32 s65, s95, 0xffff
    s_mov_b32 s66, 0x1c0000
    v_add_u32 v5, 0, v2
    v_mul_u32_u24 v6, 1171, v5
    v_lshrrev_b32 v6, 16, v6
    v_mul_u32_u24 v7, 56, v6
    v_sub_u32 v5, v5, v7
    v_cmp_gt_u32 vcc, 48, v5
    v_bfe_u32 v7, v5, 2, 2
    v_bfe_u32 v24, v5, 1, 2
    v_cndmask_b32 v7, v24, v7, vcc
    v_and_b32 v24, 3, v5
    v_and_b32 v25, 1, v5
    v_cndmask_b32 v24, v25, v24, vcc
    v_lshrrev_b32 v5, 4, v5
    v_lshl_add_u32 v24, v5, 2, v24
    v_lshl_add_u32 v6, v6, 2, v7
    v_mul_u32_u24 v6, 3584, v6
    v_lshl_add_u32 v96, v24, 4, v6
    v_add_u32 v5, 64, v2
    v_mul_u32_u24 v6, 1171, v5
    v_lshrrev_b32 v6, 16, v6
    v_mul_u32_u24 v7, 56, v6
    v_sub_u32 v5, v5, v7
    v_cmp_gt_u32 vcc, 48, v5
    v_bfe_u32 v7, v5, 2, 2
    v_bfe_u32 v24, v5, 1, 2
    v_cndmask_b32 v7, v24, v7, vcc
    v_and_b32 v24, 3, v5
    v_and_b32 v25, 1, v5
    v_cndmask_b32 v24, v25, v24, vcc
    v_lshrrev_b32 v5, 4, v5
    v_lshl_add_u32 v24, v5, 2, v24
    v_lshl_add_u32 v6, v6, 2, v7
    v_mul_u32_u24 v6, 3584, v6
    v_lshl_add_u32 v97, v24, 4, v6
    v_add_u32 v5, 128, v2
    v_mul_u32_u24 v6, 1171, v5
    v_lshrrev_b32 v6, 16, v6
    v_mul_u32_u24 v7, 56, v6
    v_sub_u32 v5, v5, v7
    v_cmp_gt_u32 vcc, 48, v5
    v_bfe_u32 v7, v5, 2, 2
    v_bfe_u32 v24, v5, 1, 2
    v_cndmask_b32 v7, v24, v7, vcc
    v_and_b32 v24, 3, v5
    v_and_b32 v25, 1, v5
    v_cndmask_b32 v24, v25, v24, vcc
    v_lshrrev_b32 v5, 4, v5
    v_lshl_add_u32 v24, v5, 2, v24
    v_lshl_add_u32 v6, v6, 2, v7
    v_mul_u32_u24 v6, 3584, v6
    v_lshl_add_u32 v98, v24, 4, v6
    v_add_u32 v5, 192, v2
    v_mul_u32_u24 v6, 1171, v5
    v_lshrrev_b32 v6, 16, v6
    v_mul_u32_u24 v7, 56, v6
    v_sub_u32 v5, v5, v7
    v_cmp_gt_u32 vcc, 48, v5
    v_bfe_u32 v7, v5, 2, 2
    v_bfe_u32 v24, v5, 1, 2
    v_cndmask_b32 v7, v24, v7, vcc
    v_and_b32 v24, 3, v5
    v_and_b32 v25, 1, v5
    v_cndmask_b32 v24, v25, v24, vcc
    v_lshrrev_b32 v5, 4, v5
    v_lshl_add_u32 v24, v5, 2, v24
    v_lshl_add_u32 v6, v6, 2, v7
    v_mul_u32_u24 v6, 3584, v6
    v_lshl_add_u32 v99, v24, 4, v6
    v_add_u32 v5, 256, v2
    v_mul_u32_u24 v6, 1171, v5
    v_lshrrev_b32 v6, 16, v6
    v_mul_u32_u24 v7, 56, v6
    v_sub_u32 v5, v5, v7
    v_cmp_gt_u32 vcc, 48, v5
    v_bfe_u32 v7, v5, 2, 2
    v_bfe_u32 v24, v5, 1, 2
    v_cndmask_b32 v7, v24, v7, vcc
    v_and_b32 v24, 3, v5
    v_and_b32 v25, 1, v5
    v_cndmask_b32 v24, v25, v24, vcc
    v_lshrrev_b32 v5, 4, v5
    v_lshl_add_u32 v24, v5, 2, v24
    v_lshl_add_u32 v6, v6, 2, v7
    v_mul_u32_u24 v6, 3584, v6
    v_lshl_add_u32 v100, v24, 4, v6
    v_add_u32 v5, 320, v2
    v_mul_u32_u24 v6, 1171, v5
    v_lshrrev_b32 v6, 16, v6
    v_mul_u32_u24 v7, 56, v6
    v_sub_u32 v5, v5, v7
    v_cmp_gt_u32 vcc, 48, v5
    v_bfe_u32 v7, v5, 2, 2
    v_bfe_u32 v24, v5, 1, 2
    v_cndmask_b32 v7, v24, v7, vcc
    v_and_b32 v24, 3, v5
    v_and_b32 v25, 1, v5
    v_cndmask_b32 v24, v25, v24, vcc
    v_lshrrev_b32 v5, 4, v5
    v_lshl_add_u32 v24, v5, 2, v24
    v_lshl_add_u32 v6, v6, 2, v7
    v_mul_u32_u24 v6, 3584, v6
    v_lshl_add_u32 v101, v24, 4, v6
    v_add_u32 v5, 384, v2
    v_mul_u32_u24 v6, 1171, v5
    v_lshrrev_b32 v6, 16, v6
    v_mul_u32_u24 v7, 56, v6
    v_sub_u32 v5, v5, v7
    v_cmp_gt_u32 vcc, 48, v5
    v_bfe_u32 v7, v5, 2, 2
    v_bfe_u32 v24, v5, 1, 2
    v_cndmask_b32 v7, v24, v7, vcc
    v_and_b32 v24, 3, v5
    v_and_b32 v25, 1, v5
    v_cndmask_b32 v24, v25, v24, vcc
    v_lshrrev_b32 v5, 4, v5
    v_lshl_add_u32 v24, v5, 2, v24
    v_lshl_add_u32 v6, v6, 2, v7
    v_mul_u32_u24 v6, 3584, v6
    v_lshl_add_u32 v102, v24, 4, v6
    s_waitcnt lgkmcnt(0)
    s_add_u32 s48, s48, 16
    s_add_u32 s49, s49, 1
    s_add_u32 s50, s48, 2
    s_add_u32 s51, s48, 3
    v_mov_b32 v255, s49
    s_lshl_b32 s26, s27, 3
    s_add_u32 s26, s26, s47
    s_add_u32 s29, s48, s42
    v_mov_b32 v254, s29
    s_lshl_b32 s29, s23, 30
    v_or_b32 v6, s29, v222
    buffer_store_dwordx2 v[254:255], v6, s[52:55], s26 offen sc0 sc1
    s_add_u32 m0, s25, 0
    s_add_u32 s26, s31, 0
    buffer_load_dwordx4 v96, s[64:67], s26 offen lds
    s_add_u32 m0, s25, 1024
    s_add_u32 s26, s31, 0
    buffer_load_dwordx4 v97, s[64:67], s26 offen lds
    s_add_u32 m0, s25, 2048
    s_add_u32 s26, s31, 0
    buffer_load_dwordx4 v98, s[64:67], s26 offen lds
    s_add_u32 m0, s25, 3072
    s_add_u32 s26, s31, 0
    buffer_load_dwordx4 v99, s[64:67], s26 offen lds
    s_add_u32 m0, s25, 4096
    s_add_u32 s26, s31, 0
    buffer_load_dwordx4 v100, s[64:67], s26 offen lds
    s_add_u32 m0, s25, 5120
    s_add_u32 s26, s31, 0
    buffer_load_dwordx4 v101, s[64:67], s26 offen lds
    s_add_u32 m0, s25, 6144
    s_add_u32 s26, s31, 0
    buffer_load_dwordx4 v102, s[64:67], s26 offen lds
    v_mov_b32 v108, 0
    v_mov_b32 v109, 0
    v_mov_b32 v110, 0
    v_mov_b32 v111, 0
    s_mul_i32 s26, s23, 12928
    s_add_u32 s26, s26, 119296
    v_add_u32 v13, s26, v16
    v_and_b32 v12, 16, v16
    v_add_u32 v12, s26, v12
    ds_write_b128 v12, v[108:111]
    ds_write_b128 v12, v[108:111] offset:4160
    s_waitcnt vmcnt(14)
    ds_write_b128 v13, v[164:167] offset:32
    v_alignbit_b32 v112, v164, v180, 16
    v_alignbit_b32 v113, v165, v164, 16
    v_alignbit_b32 v114, v166, v165, 16
    v_alignbit_b32 v115, v167, v166, 16
    ds_write_b128 v13, v[112:115] offset:4192
    ds_write_b128 v13, v[168:171] offset:1056
    v_alignbit_b32 v116, v168, v181, 16
    v_alignbit_b32 v117, v169, v168, 16
    v_alignbit_b32 v118, v170, v169, 16
    v_alignbit_b32 v119, v171, v170, 16
    ds_write_b128 v13, v[116:119] offset:5216
    ds_write_b128 v13, v[172:175] offset:2080
    v_alignbit_b32 v120, v172, v182, 16
    v_alignbit_b32 v121, v173, v172, 16
    v_alignbit_b32 v122, v174, v173, 16
    v_alignbit_b32 v123, v175, v174, 16
    ds_write_b128 v13, v[120:123] offset:6240
    ds_write_b128 v13, v[176:179] offset:3104
    v_alignbit_b32 v124, v176, v183, 16
    v_alignbit_b32 v125, v177, v176, 16
    v_alignbit_b32 v126, v178, v177, 16
    v_alignbit_b32 v127, v179, v178, 16
    ds_write_b128 v13, v[124:127] offset:7264
    s_lshl_b32 s26, s23, 2
    s_add_u32 s26, s26, 162304
    v_mov_b32 v219, s26
    v_mov_b32 v218, 1
    s_waitcnt lgkmcnt(0)
    ds_write_b32 v219, v218
    s_add_u32 m0, s25, 7168
    s_add_u32 s26, s31, 114688
    buffer_load_dwordx4 v96, s[64:67], s26 offen lds
    s_add_u32 m0, s25, 8192
    s_add_u32 s26, s31, 114688
    buffer_load_dwordx4 v97, s[64:67], s26 offen lds
    s_add_u32 m0, s25, 9216
    s_add_u32 s26, s31, 114688
    buffer_load_dwordx4 v98, s[64:67], s26 offen lds
    s_add_u32 m0, s25, 10240
    s_add_u32 s26, s31, 114688
    buffer_load_dwordx4 v99, s[64:67], s26 offen lds
    s_add_u32 m0, s25, 11264
    s_add_u32 s26, s31, 114688
    buffer_load_dwordx4 v100, s[64:67], s26 offen lds
    s_add_u32 m0, s25, 12288
    s_add_u32 s26, s31, 114688
    buffer_load_dwordx4 v101, s[64:67], s26 offen lds
    s_add_u32 m0, s25, 13312
    s_add_u32 s26, s31, 114688
    buffer_load_dwordx4 v102, s[64:67], s26 offen lds
    s_add_u32 m0, s25, 14336
    s_add_u32 s26, s31, 229376
    buffer_load_dwordx4 v96, s[64:67], s26 offen lds
    s_add_u32 m0, s25, 15360
    s_add_u32 s26, s31, 229376
    buffer_load_dwordx4 v97, s[64:67], s26 offen lds
    s_add_u32 m0, s25, 16384
    s_add_u32 s26, s31, 229376
    buffer_load_dwordx4 v98, s[64:67], s26 offen lds
    s_add_u32 m0, s25, 17408
    s_add_u32 s26, s31, 229376
    buffer_load_dwordx4 v99, s[64:67], s26 offen lds
    s_add_u32 m0, s25, 18432
    s_add_u32 s26, s31, 229376
    buffer_load_dwordx4 v100, s[64:67], s26 offen lds
    s_add_u32 m0, s25, 19456
    s_add_u32 s26, s31, 229376
    buffer_load_dwordx4 v101, s[64:67], s26 offen lds
    s_add_u32 m0, s25, 20480
    s_add_u32 s26, s31, 229376
    buffer_load_dwordx4 v102, s[64:67], s26 offen lds
    buffer_load_dwordx2 v[232:233], v231, s[52:55], s47 offen sc1
    s_waitcnt vmcnt(15)
    ds_read_b64_tr_b16 v[36:37], v26 offset:0
    ds_read_b64_tr_b16 v[38:39], v26 offset:896
    ds_read_b64_tr_b16 v[40:41], v26 offset:8
    ds_read_b64_tr_b16 v[42:43], v26 offset:904
    ds_read_b64_tr_b16 v[44:45], v26 offset:256
    ds_read_b64_tr_b16 v[46:47], v26 offset:1152
    ds_read_b64_tr_b16 v[48:49], v26 offset:264
    ds_read_b64_tr_b16 v[50:51], v26 offset:1160
    ds_read_b64_tr_b16 v[52:53], v26 offset:512
    ds_read_b64_tr_b16 v[54:55], v26 offset:1408
    ds_read_b64_tr_b16 v[56:57], v26 offset:520
    ds_read_b64_tr_b16 v[58:59], v26 offset:1416
    ds_read_b64_tr_b16 v[60:61], v27 offset:768
    ds_read_b64_tr_b16 v[62:63], v27 offset:1664
    s_waitcnt lgkmcnt(0)
    ds_write_b128 v28, v[36:39] offset:0
    v_mfma_f32_16x16x32_bf16 v[136:139], v[32:35], v[36:39], 0
    ds_write_b128 v28, v[40:43] offset:1024
    v_mfma_f32_16x16x32_bf16 v[140:143], v[32:35], v[40:43], 0
    ds_write_b128 v28, v[44:47] offset:2048
    v_mfma_f32_16x16x32_bf16 v[144:147], v[32:35], v[44:47], 0
    ds_write_b128 v28, v[48:51] offset:3072
    v_mfma_f32_16x16x32_bf16 v[148:151], v[32:35], v[48:51], 0
    ds_write_b128 v28, v[52:55] offset:4096
    v_mfma_f32_16x16x32_bf16 v[152:155], v[32:35], v[52:55], 0
    ds_write_b128 v28, v[56:59] offset:5120
    v_mfma_f32_16x16x32_bf16 v[156:159], v[32:35], v[56:59], 0
    ds_write_b128 v28, v[60:63] offset:6144
    v_mfma_f32_16x16x32_bf16 v[160:163], v[32:35], v[60:63], 0
    s_add_u32 s29, s48, 1
    v_mov_b32 v254, s29
    s_waitcnt vmcnt(0)
    v_subrev_u32 v232, s48, v232
    v_xor_b32 v233, s49, v233
    v_lshrrev_b32 v235, 4, v232
    v_or_b32 v235, v235, v233
    v_cmp_ne_u32 vcc, 0, v235
    s_cbranch_vccz XTOK_18
    s_mov_b32 s40, 200000
POLL_21:
    buffer_load_dwordx2 v[232:233], v231, s[52:55], s47 offen offset:0 sc1
    s_sub_u32 s40, s40, 1
    s_cbranch_scc1 POLLX_22
    s_waitcnt vmcnt(0)
    v_subrev_u32 v232, s48, v232
    v_xor_b32 v233, s49, v233
    v_lshrrev_b32 v235, 4, v232
    v_or_b32 v235, v235, v233
    v_cmp_ne_u32 vcc, 0, v235
    s_cbranch_vccnz POLL_21
POLLX_22:
    s_waitcnt vmcnt(0)
XTOK_18:
    v_cmp_ne_u32 vcc, s42, v232
    s_mov_b32 s46, 0
    s_cbranch_vccnz FDN_20
    s_mov_b32 s46, 1
FDN_20:
    s_mov_b64 s[80:81], s[90:91]
    s_mov_b64 s[82:83], s[96:97]
    s_mov_b64 s[36:37], s[94:95]
    s_mov_b32 s84, s98
    s_and_b32 s85, s99, 0xffff
    s_mov_b32 s86, 1835008
    s_mov_b32 s87, 0x20000
    s_lshr_b32 s26, s12, 1
    s_mul_i32 s10, s26, 229376
    s_mul_i32 s32, s17, 7168
    s_add_u32 s10, s10, s32
    s_lshl_b32 s32, s23, 8
    s_add_u32 s10, s10, s32
    s_add_u32 s10, s10, 0x1000000
    s_add_u32 s11, s10, 4096
    s_add_u32 s4, s10, 114688
    s_add_u32 s5, s11, 114688
    s_lshl_b32 s13, s12, 4
    s_add_u32 s13, s13, s17
    s_lshl_b32 s13, s13, 7
    s_add_u32 s13, s13, 0x830000
    s_lshl_b32 s43, s6, 2
    s_add_u32 s43, s43, s18
    s_lshl_b32 s43, s43, 9
    s_lshl_b32 s32, s23, 5
    s_add_u32 s43, s43, s32
    s_add_u32 s43, s43, 0x830000
    s_mul_i32 s88, s3, 229376
    s_mul_i32 s32, s18, 28672
    s_add_u32 s88, s88, s32
    s_add_u32 s88, s88, 0x1000000
    s_add_u32 s95, s88, 114688
    s_add_u32 s89, s88, 4096
    s_add_u32 s96, s95, 4096
    s_add_u32 s90, s89, 4096
    s_add_u32 s97, s96, 4096
    s_add_u32 s91, s90, 4096
    s_add_u32 s98, s97, 4096
    s_add_u32 s92, s91, 4096
    s_add_u32 s99, s98, 4096
    s_add_u32 s93, s92, 4096
    s_add_u32 s100, s99, 4096
    s_add_u32 s94, s93, 4096
    s_add_u32 s101, s100, 4096
    s_lshl_b32 s75, s19, 2
    s_add_u32 s75, s75, s18
    s_lshl_b32 s75, s75, 5
    s_add_u32 s75, s75, s41
    s_lshl_b32 s69, s18, 6
    s_add_u32 s69, s69, s41
    s_add_u32 s9, s7, 0x40000
    s_lshl_b32 s8, s12, 11
    s_add_u32 s8, s8, 0x8c0000
    s_lshl_b32 s28, s6, 15
    s_lshl_b32 s32, s20, 11
    s_add_u32 s28, s28, s32
    s_lshl_b32 s32, s23, 7
    s_add_u32 s28, s28, s32
    s_add_u32 s33, s28, 16384
    s_mul_i32 s76, s18, 458752
    s_lshl_b32 s26, s20, 7
    s_add_u32 s76, s76, s26
    v_accvgpr_read_b32 v221, a224
    v_lshlrev_b32 v192, 16, v221
    v_and_b32 v193, 0xffff0000, v221
    v_accvgpr_read_b32 v221, a225
    v_lshlrev_b32 v194, 16, v221
    v_and_b32 v195, 0xffff0000, v221
    v_accvgpr_read_b32 v221, a226
    v_lshlrev_b32 v196, 16, v221
    v_and_b32 v197, 0xffff0000, v221
    v_accvgpr_read_b32 v221, a227
    v_lshlrev_b32 v198, 16, v221
    v_and_b32 v199, 0xffff0000, v221
    v_pk_add_f32 v[204:205], v[192:193], v[194:195]
    v_pk_mul_f32 v[206:207], v[192:193], v[192:193]
    v_pk_fma_f32 v[206:207], v[194:195], v[194:195], v[206:207]
    v_pk_add_f32 v[204:205], v[204:205], v[196:197]
    v_pk_fma_f32 v[206:207], v[196:197], v[196:197], v[206:207]
    v_pk_add_f32 v[204:205], v[204:205], v[198:199]
    v_pk_fma_f32 v[206:207], v[198:199], v[198:199], v[206:207]
    v_add_f32 v224, v204, v205
    v_add_f32 v225, v206, v207
    v_accvgpr_read_b32 v221, a228
    v_lshlrev_b32 v192, 16, v221
    v_and_b32 v193, 0xffff0000, v221
    v_accvgpr_read_b32 v221, a229
    v_lshlrev_b32 v194, 16, v221
    v_and_b32 v195, 0xffff0000, v221
    v_accvgpr_read_b32 v221, a230
    v_lshlrev_b32 v196, 16, v221
    v_and_b32 v197, 0xffff0000, v221
    v_accvgpr_read_b32 v221, a231
    v_lshlrev_b32 v198, 16, v221
    v_and_b32 v199, 0xffff0000, v221
    v_pk_add_f32 v[204:205], v[192:193], v[194:195]
    v_pk_mul_f32 v[206:207], v[192:193], v[192:193]
    v_pk_fma_f32 v[206:207], v[194:195], v[194:195], v[206:207]
    v_pk_add_f32 v[204:205], v[204:205], v[196:197]
    v_pk_fma_f32 v[206:207], v[196:197], v[196:197], v[206:207]
    v_pk_add_f32 v[204:205], v[204:205], v[198:199]
    v_pk_fma_f32 v[206:207], v[198:199], v[198:199], v[206:207]
    v_add_f32 v226, v204, v205
    v_add_f32 v227, v206, v207
    s_nop 1
    v_add_f32_dpp v224, v224, v224 quad_perm:[1,0,3,2] row_mask:0xf bank_mask:0xf
    v_add_f32_dpp v225, v225, v225 quad_perm:[1,0,3,2] row_mask:0xf bank_mask:0xf
    v_add_f32_dpp v226, v226, v226 quad_perm:[1,0,3,2] row_mask:0xf bank_mask:0xf
    v_add_f32_dpp v227, v227, v227 quad_perm:[1,0,3,2] row_mask:0xf bank_mask:0xf
    v_add_f32_dpp v224, v224, v224 quad_perm:[2,3,0,1] row_mask:0xf bank_mask:0xf
    v_add_f32_dpp v225, v225, v225 quad_perm:[2,3,0,1] row_mask:0xf bank_mask:0xf
    v_add_f32_dpp v226, v226, v226 quad_perm:[2,3,0,1] row_mask:0xf bank_mask:0xf
    v_add_f32_dpp v227, v227, v227 quad_perm:[2,3,0,1] row_mask:0xf bank_mask:0xf
    v_add_f32_dpp v224, v224, v224 row_half_mirror row_mask:0xf bank_mask:0xf
    v_add_f32_dpp v225, v225, v225 row_half_mirror row_mask:0xf bank_mask:0xf
    v_add_f32_dpp v226, v226, v226 row_half_mirror row_mask:0xf bank_mask:0xf
    v_add_f32_dpp v227, v227, v227 row_half_mirror row_mask:0xf bank_mask:0xf
    v_and_b32 v225, 0x7fffffff, v225
    v_and_b32 v227, 0x7fffffff, v227
    s_and_b32 s37, s37, 0xffff
    s_mov_b32 s38, 1835008
    s_mov_b32 s39, 0x20000
    v_lshrrev_b32 v223, 5, v2
    v_lshlrev_b32 v223, 3, v223
    v_bfe_u32 v221, v2, 2, 2
    v_add_u32 v223, v223, v221
    v_lshlrev_b32 v223, 7, v223
    v_and_b32 v221, 1, v4
    v_lshl_add_u32 v223, v221, 5, v223
    v_and_b32 v221, 1, v2
    v_lshl_add_u32 v223, v221, 4, v223
    v_bfe_u32 v221, v2, 1, 1
    v_lshl_add_u32 v223, v221, 3, v223
    v_lshrrev_b32 v220, 3, v2
    v_lshlrev_b32 v220, 10, v220
    v_and_b32 v221, 0x70, v16
    v_add_u32 v220, v220, v221
    v_and_b32 v231, 0x1c0, v230
    v_and_b32 v5, 7, v2
    v_lshl_add_u32 v231, v5, 28, v231
    s_lshl_b32 s26, s20, 3
    v_add_u32 v231, s26, v231
    s_mul_i32 s24, s23, 8192
    s_add_u32 s24, s24, 140800
    v_add_u32 v223, s24, v223
    ds_read_b64_tr_b16 v[64:65], v26 offset:7168
    ds_read_b64_tr_b16 v[66:67], v26 offset:8064
    ds_read_b64_tr_b16 v[68:69], v26 offset:7176
    ds_read_b64_tr_b16 v[70:71], v26 offset:8072
    ds_read_b64_tr_b16 v[72:73], v26 offset:7424
    ds_read_b64_tr_b16 v[74:75], v26 offset:8320
    ds_read_b64_tr_b16 v[76:77], v26 offset:7432
    ds_read_b64_tr_b16 v[78:79], v26 offset:8328
    ds_read_b64_tr_b16 v[80:81], v26 offset:7680
    ds_read_b64_tr_b16 v[82:83], v26 offset:8576
    ds_read_b64_tr_b16 v[84:85], v26 offset:7688
    ds_read_b64_tr_b16 v[86:87], v26 offset:8584
    ds_read_b64_tr_b16 v[88:89], v27 offset:7936
    ds_read_b64_tr_b16 v[90:91], v27 offset:8832
    s_waitcnt lgkmcnt(0)
    ds_write_b128 v28, v[64:67] offset:7168
    v_mfma_f32_16x16x32_bf16 v[136:139], v[32:35], v[64:67], v[136:139]
    ds_write_b128 v28, v[68:71] offset:8192
    v_mfma_f32_16x16x32_bf16 v[140:143], v[32:35], v[68:71], v[140:143]
    ds_write_b128 v28, v[72:75] offset:9216
    v_mfma_f32_16x16x32_bf16 v[144:147], v[32:35], v[72:75], v[144:147]
    ds_write_b128 v28, v[76:79] offset:10240
    v_mfma_f32_16x16x32_bf16 v[148:151], v[32:35], v[76:79], v[148:151]
    ds_write_b128 v28, v[80:83] offset:11264
    v_mfma_f32_16x16x32_bf16 v[152:155], v[32:35], v[80:83], v[152:155]
    ds_write_b128 v28, v[84:87] offset:12288
    v_mfma_f32_16x16x32_bf16 v[156:159], v[32:35], v[84:87], v[156:159]
    ds_write_b128 v28, v[88:91] offset:13312
    v_mfma_f32_16x16x32_bf16 v[160:163], v[32:35], v[88:91], v[160:163]
    ds_read_b64_tr_b16 v[36:37], v26 offset:14336
    ds_read_b64_tr_b16 v[38:39], v26 offset:15232
    ds_read_b64_tr_b16 v[40:41], v26 offset:14344
    ds_read_b64_tr_b16 v[42:43], v26 offset:15240
    ds_read_b64_tr_b16 v[44:45], v26 offset:14592
    ds_read_b64_tr_b16 v[46:47], v26 offset:15488
    ds_read_b64_tr_b16 v[48:49], v26 offset:14600
    ds_read_b64_tr_b16 v[50:51], v26 offset:15496
    ds_read_b64_tr_b16 v[52:53], v26 offset:14848
    ds_read_b64_tr_b16 v[54:55], v26 offset:15744
    ds_read_b64_tr_b16 v[56:57], v26 offset:14856
    ds_read_b64_tr_b16 v[58:59], v26 offset:15752
    ds_read_b64_tr_b16 v[60:61], v27 offset:15104
    ds_read_b64_tr_b16 v[62:63], v27 offset:16000
    s_waitcnt lgkmcnt(0)
    ds_write_b128 v28, v[36:39] offset:14336
    v_mfma_f32_16x16x32_bf16 v[136:139], v[32:35], v[36:39], v[136:139]
    ds_write_b128 v28, v[40:43] offset:15360
    v_mfma_f32_16x16x32_bf16 v[140:143], v[32:35], v[40:43], v[140:143]
    ds_write_b128 v28, v[44:47] offset:16384
    v_mfma_f32_16x16x32_bf16 v[144:147], v[32:35], v[44:47], v[144:147]
    ds_write_b128 v28, v[48:51] offset:17408
    v_mfma_f32_16x16x32_bf16 v[148:151], v[32:35], v[48:51], v[148:151]
    ds_write_b128 v28, v[52:55] offset:18432
    v_mfma_f32_16x16x32_bf16 v[152:155], v[32:35], v[52:55], v[152:155]
    ds_write_b128 v28, v[56:59] offset:19456
    v_mfma_f32_16x16x32_bf16 v[156:159], v[32:35], v[56:59], v[156:159]
    ds_write_b128 v28, v[60:63] offset:20480
    v_mfma_f32_16x16x32_bf16 v[160:163], v[32:35], v[60:63], v[160:163]
    s_mov_b32 s40, 1600000
LW_23:
    ds_read_b32 v218, v219 offset:8
    s_sub_u32 s40, s40, 1
    s_cbranch_scc1 LWX_24
    s_waitcnt lgkmcnt(0)
    v_cmp_gt_u32 vcc, 2, v218
    s_cbranch_vccz LWX_24
    s_sleep 1
    s_branch LW_23
LWX_24:
    s_waitcnt lgkmcnt(0)
    s_add_u32 m0, s25, 21504
    s_add_u32 s26, s31, 344064
    buffer_load_dwordx4 v96, s[64:67], s26 offen lds
    s_add_u32 m0, s25, 22528
    s_add_u32 s26, s31, 344064
    buffer_load_dwordx4 v97, s[64:67], s26 offen lds
    s_add_u32 m0, s25, 23552
    s_add_u32 s26, s31, 344064
    buffer_load_dwordx4 v98, s[64:67], s26 offen lds
    s_add_u32 m0, s25, 24576
    s_add_u32 s26, s31, 344064
    buffer_load_dwordx4 v99, s[64:67], s26 offen lds
    s_add_u32 m0, s25, 25600
    s_add_u32 s26, s31, 344064
    buffer_load_dwordx4 v100, s[64:67], s26 offen lds
    s_add_u32 m0, s25, 26624
    s_add_u32 s26, s31, 344064
    buffer_load_dwordx4 v101, s[64:67], s26 offen lds
    s_add_u32 m0, s25, 27648
    s_add_u32 s26, s31, 344064
    buffer_load_dwordx4 v102, s[64:67], s26 offen lds
    s_add_u32 m0, s25, 28672
    s_add_u32 s26, s31, 458752
    buffer_load_dwordx4 v96, s[64:67], s26 offen lds
    s_add_u32 m0, s25, 29696
    s_add_u32 s26, s31, 458752
    buffer_load_dwordx4 v97, s[64:67], s26 offen lds
    s_add_u32 m0, s25, 30720
    s_add_u32 s26, s31, 458752
    buffer_load_dwordx4 v98, s[64:67], s26 offen lds
    s_add_u32 m0, s25, 31744
    s_add_u32 s26, s31, 458752
    buffer_load_dwordx4 v99, s[64:67], s26 offen lds
    s_add_u32 m0, s25, 32768
    s_add_u32 s26, s31, 458752
    buffer_load_dwordx4 v100, s[64:67], s26 offen lds
    s_add_u32 m0, s25, 33792
    s_add_u32 s26, s31, 458752
    buffer_load_dwordx4 v101, s[64:67], s26 offen lds
    s_add_u32 m0, s25, 34816
    s_add_u32 s26, s31, 458752
    buffer_load_dwordx4 v102, s[64:67], s26 offen lds
    s_add_u32 m0, s25, 35840
    s_add_u32 s26, s31, 573440
    buffer_load_dwordx4 v96, s[64:67], s26 offen lds
    s_add_u32 m0, s25, 36864
    s_add_u32 s26, s31, 573440
    buffer_load_dwordx4 v97, s[64:67], s26 offen lds
    s_add_u32 m0, s25, 37888
    s_add_u32 s26, s31, 573440
    buffer_load_dwordx4 v98, s[64:67], s26 offen lds
    s_add_u32 m0, s25, 38912
    s_add_u32 s26, s31, 573440
    buffer_load_dwordx4 v99, s[64:67], s26 offen lds
    s_add_u32 m0, s25, 39936
    s_add_u32 s26, s31, 573440
    buffer_load_dwordx4 v100, s[64:67], s26 offen lds
    s_add_u32 m0, s25, 40960
    s_add_u32 s26, s31, 573440
    buffer_load_dwordx4 v101, s[64:67], s26 offen lds
    s_add_u32 m0, s25, 41984
    s_add_u32 s26, s31, 573440
    buffer_load_dwordx4 v102, s[64:67], s26 offen lds
    s_add_u32 m0, s25, 43008
    s_add_u32 s26, s31, 688128
    buffer_load_dwordx4 v96, s[64:67], s26 offen lds
    s_add_u32 m0, s25, 44032
    s_add_u32 s26, s31, 688128
    buffer_load_dwordx4 v97, s[64:67], s26 offen lds
    s_add_u32 m0, s25, 45056
    s_add_u32 s26, s31, 688128
    buffer_load_dwordx4 v98, s[64:67], s26 offen lds
    s_add_u32 m0, s25, 46080
    s_add_u32 s26, s31, 688128
    buffer_load_dwordx4 v99, s[64:67], s26 offen lds
    s_add_u32 m0, s25, 47104
    s_add_u32 s26, s31, 688128
    buffer_load_dwordx4 v100, s[64:67], s26 offen lds
    s_add_u32 m0, s25, 48128
    s_add_u32 s26, s31, 688128
    buffer_load_dwordx4 v101, s[64:67], s26 offen lds
    s_add_u32 m0, s25, 49152
    s_add_u32 s26, s31, 688128
    buffer_load_dwordx4 v102, s[64:67], s26 offen lds
    s_add_u32 m0, s25, 50176
    s_add_u32 s26, s31, 802816
    buffer_load_dwordx4 v96, s[64:67], s26 offen lds
    s_add_u32 m0, s25, 51200
    s_add_u32 s26, s31, 802816
    buffer_load_dwordx4 v97, s[64:67], s26 offen lds
    s_add_u32 m0, s25, 52224
    s_add_u32 s26, s31, 802816
    buffer_load_dwordx4 v98, s[64:67], s26 offen lds
    s_add_u32 m0, s25, 53248
    s_add_u32 s26, s31, 802816
    buffer_load_dwordx4 v99, s[64:67], s26 offen lds
    s_add_u32 m0, s25, 54272
    s_add_u32 s26, s31, 802816
    buffer_load_dwordx4 v100, s[64:67], s26 offen lds
    s_add_u32 m0, s25, 55296
    s_add_u32 s26, s31, 802816
    buffer_load_dwordx4 v101, s[64:67], s26 offen lds
    s_add_u32 m0, s25, 56320
    s_add_u32 s26, s31, 802816
    buffer_load_dwordx4 v102, s[64:67], s26 offen lds
    s_cmp_eq_u32 s46, 0
    s_cbranch_scc1 S0S_25
    buffer_store_dwordx2 v[224:225], v231, s[52:55], s7 offen offset:0
    buffer_store_dwordx2 v[226:227], v231, s[52:55], s7 offen offset:1024
    s_branch S0D_26
S0S_25:
    buffer_store_dwordx2 v[224:225], v231, s[52:55], s7 offen offset:0 sc0 sc1
    buffer_store_dwordx2 v[226:227], v231, s[52:55], s7 offen offset:1024 sc0 sc1
S0D_26:
    v_lshlrev_b32 v6, 7, v2
    s_lshl_b32 s26, s27, 1
    s_add_u32 s26, s26, s23
    s_lshl_b32 s29, s21, 3
    s_add_u32 s26, s26, s29
    s_and_b32 s26, s26, 63
    s_mul_i32 s26, s26, 14336
    s_add_u32 s26, s26, 917504
    buffer_load_dword v228, v6, s[84:87], s26 offen
    s_add_u32 s26, s26, 6144
    buffer_load_dword v228, v6, s[84:87], s26 offen
    s_add_u32 s26, s26, 6144
    v_lshlrev_b32 v6, 7, v2
    s_lshl_b32 s26, s27, 1
    s_add_u32 s26, s26, s23
    s_lshl_b32 s29, s21, 3
    s_add_u32 s26, s26, s29
    s_and_b32 s26, s26, 63
    s_mul_i32 s26, s26, 14336
    buffer_load_dword v228, v6, s[84:87], s26 offen
    s_add_u32 s26, s26, 6144
    buffer_load_dword v228, v6, s[84:87], s26 offen
    s_add_u32 s26, s26, 6144
    s_waitcnt vmcnt(32)
    ds_read_b64_tr_b16 v[64:65], v26 offset:21504
    ds_read_b64_tr_b16 v[66:67], v26 offset:22400
    ds_read_b64_tr_b16 v[68:69], v26 offset:21512
    ds_read_b64_tr_b16 v[70:71], v26 offset:22408
    ds_read_b64_tr_b16 v[72:73], v26 offset:21760
    ds_read_b64_tr_b16 v[74:75], v26 offset:22656
    ds_read_b64_tr_b16 v[76:77], v26 offset:21768
    ds_read_b64_tr_b16 v[78:79], v26 offset:22664
    ds_read_b64_tr_b16 v[80:81], v26 offset:22016
    ds_read_b64_tr_b16 v[82:83], v26 offset:22912
    ds_read_b64_tr_b16 v[84:85], v26 offset:22024
    ds_read_b64_tr_b16 v[86:87], v26 offset:22920
    ds_read_b64_tr_b16 v[88:89], v27 offset:22272
    ds_read_b64_tr_b16 v[90:91], v27 offset:23168
    s_waitcnt lgkmcnt(0)
    ds_write_b128 v28, v[64:67] offset:21504
    v_mfma_f32_16x16x32_bf16 v[136:139], v[32:35], v[64:67], v[136:139]
    ds_write_b128 v28, v[68:71] offset:22528
    v_mfma_f32_16x16x32_bf16 v[140:143], v[32:35], v[68:71], v[140:143]
    ds_write_b128 v28, v[72:75] offset:23552
    v_mfma_f32_16x16x32_bf16 v[144:147], v[32:35], v[72:75], v[144:147]
    ds_write_b128 v28, v[76:79] offset:24576
    v_mfma_f32_16x16x32_bf16 v[148:151], v[32:35], v[76:79], v[148:151]
    ds_write_b128 v28, v[80:83] offset:25600
    v_mfma_f32_16x16x32_bf16 v[152:155], v[32:35], v[80:83], v[152:155]
    ds_write_b128 v28, v[84:87] offset:26624
    v_mfma_f32_16x16x32_bf16 v[156:159], v[32:35], v[84:87], v[156:159]
    ds_write_b128 v28, v[88:91] offset:27648
    v_mfma_f32_16x16x32_bf16 v[160:163], v[32:35], v[88:91], v[160:163]
    s_waitcnt vmcnt(25)
    ds_read_b64_tr_b16 v[36:37], v26 offset:28672
    ds_read_b64_tr_b16 v[38:39], v26 offset:29568
    ds_read_b64_tr_b16 v[40:41], v26 offset:28680
    ds_read_b64_tr_b16 v[42:43], v26 offset:29576
    ds_read_b64_tr_b16 v[44:45], v26 offset:28928
    ds_read_b64_tr_b16 v[46:47], v26 offset:29824
    ds_read_b64_tr_b16 v[48:49], v26 offset:28936
    ds_read_b64_tr_b16 v[50:51], v26 offset:29832
    ds_read_b64_tr_b16 v[52:53], v26 offset:29184
    ds_read_b64_tr_b16 v[54:55], v26 offset:30080
    ds_read_b64_tr_b16 v[56:57], v26 offset:29192
    ds_read_b64_tr_b16 v[58:59], v26 offset:30088
    ds_read_b64_tr_b16 v[60:61], v27 offset:29440
    ds_read_b64_tr_b16 v[62:63], v27 offset:30336
    s_waitcnt lgkmcnt(0)
    ds_write_b128 v28, v[36:39] offset:28672
    v_mfma_f32_16x16x32_bf16 v[136:139], v[32:35], v[36:39], v[136:139]
    ds_write_b128 v28, v[40:43] offset:29696
    v_mfma_f32_16x16x32_bf16 v[140:143], v[32:35], v[40:43], v[140:143]
    ds_write_b128 v28, v[44:47] offset:30720
    v_mfma_f32_16x16x32_bf16 v[144:147], v[32:35], v[44:47], v[144:147]
    ds_write_b128 v28, v[48:51] offset:31744
    v_mfma_f32_16x16x32_bf16 v[148:151], v[32:35], v[48:51], v[148:151]
    ds_write_b128 v28, v[52:55] offset:32768
    v_mfma_f32_16x16x32_bf16 v[152:155], v[32:35], v[52:55], v[152:155]
    ds_write_b128 v28, v[56:59] offset:33792
    v_mfma_f32_16x16x32_bf16 v[156:159], v[32:35], v[56:59], v[156:159]
    ds_write_b128 v28, v[60:63] offset:34816
    v_mfma_f32_16x16x32_bf16 v[160:163], v[32:35], v[60:63], v[160:163]
    s_waitcnt vmcnt(18)
    ds_read_b64_tr_b16 v[64:65], v26 offset:35840
    ds_read_b64_tr_b16 v[66:67], v26 offset:36736
    ds_read_b64_tr_b16 v[68:69], v26 offset:35848
    ds_read_b64_tr_b16 v[70:71], v26 offset:36744
    ds_read_b64_tr_b16 v[72:73], v26 offset:36096
    ds_read_b64_tr_b16 v[74:75], v26 offset:36992
    ds_read_b64_tr_b16 v[76:77], v26 offset:36104
    ds_read_b64_tr_b16 v[78:79], v26 offset:37000
    ds_read_b64_tr_b16 v[80:81], v26 offset:36352
    ds_read_b64_tr_b16 v[82:83], v26 offset:37248
    ds_read_b64_tr_b16 v[84:85], v26 offset:36360
    ds_read_b64_tr_b16 v[86:87], v26 offset:37256
    ds_read_b64_tr_b16 v[88:89], v27 offset:36608
    ds_read_b64_tr_b16 v[90:91], v27 offset:37504
    s_waitcnt lgkmcnt(0)
    ds_write_b128 v28, v[64:67] offset:35840
    v_mfma_f32_16x16x32_bf16 v[136:139], v[32:35], v[64:67], v[136:139]
    ds_write_b128 v28, v[68:71] offset:36864
    v_mfma_f32_16x16x32_bf16 v[140:143], v[32:35], v[68:71], v[140:143]
    ds_write_b128 v28, v[72:75] offset:37888
    v_mfma_f32_16x16x32_bf16 v[144:147], v[32:35], v[72:75], v[144:147]
    ds_write_b128 v28, v[76:79] offset:38912
    v_mfma_f32_16x16x32_bf16 v[148:151], v[32:35], v[76:79], v[148:151]
    ds_write_b128 v28, v[80:83] offset:39936
    v_mfma_f32_16x16x32_bf16 v[152:155], v[32:35], v[80:83], v[152:155]
    ds_write_b128 v28, v[84:87] offset:40960
    v_mfma_f32_16x16x32_bf16 v[156:159], v[32:35], v[84:87], v[156:159]
    ds_write_b128 v28, v[88:91] offset:41984
    v_mfma_f32_16x16x32_bf16 v[160:163], v[32:35], v[88:91], v[160:163]
    s_waitcnt vmcnt(11)
    ds_read_b64_tr_b16 v[36:37], v26 offset:43008
    ds_read_b64_tr_b16 v[38:39], v26 offset:43904
    ds_read_b64_tr_b16 v[40:41], v26 offset:43016
    ds_read_b64_tr_b16 v[42:43], v26 offset:43912
    ds_read_b64_tr_b16 v[44:45], v26 offset:43264
    ds_read_b64_tr_b16 v[46:47], v26 offset:44160
    ds_read_b64_tr_b16 v[48:49], v26 offset:43272
    ds_read_b64_tr_b16 v[50:51], v26 offset:44168
    ds_read_b64_tr_b16 v[52:53], v26 offset:43520
    ds_read_b64_tr_b16 v[54:55], v26 offset:44416
    ds_read_b64_tr_b16 v[56:57], v26 offset:43528
    ds_read_b64_tr_b16 v[58:59], v26 offset:44424
    ds_read_b64_tr_b16 v[60:61], v27 offset:43776
    ds_read_b64_tr_b16 v[62:63], v27 offset:44672
    s_waitcnt lgkmcnt(0)
    ds_write_b128 v28, v[36:39] offset:43008
    v_mfma_f32_16x16x32_bf16 v[136:139], v[32:35], v[36:39], v[136:139]
    ds_write_b128 v28, v[40:43] offset:44032
    v_mfma_f32_16x16x32_bf16 v[140:143], v[32:35], v[40:43], v[140:143]
    ds_write_b128 v28, v[44:47] offset:45056
    v_mfma_f32_16x16x32_bf16 v[144:147], v[32:35], v[44:47], v[144:147]
    ds_write_b128 v28, v[48:51] offset:46080
    v_mfma_f32_16x16x32_bf16 v[148:151], v[32:35], v[48:51], v[148:151]
    ds_write_b128 v28, v[52:55] offset:47104
    v_mfma_f32_16x16x32_bf16 v[152:155], v[32:35], v[52:55], v[152:155]
    ds_write_b128 v28, v[56:59] offset:48128
    v_mfma_f32_16x16x32_bf16 v[156:159], v[32:35], v[56:59], v[156:159]
    ds_write_b128 v28, v[60:63] offset:49152
    v_mfma_f32_16x16x32_bf16 v[160:163], v[32:35], v[60:63], v[160:163]
    s_waitcnt vmcnt(4)
    ds_read_b64_tr_b16 v[64:65], v26 offset:50176
    ds_read_b64_tr_b16 v[66:67], v26 offset:51072
    ds_read_b64_tr_b16 v[68:69], v26 offset:50184
    ds_read_b64_tr_b16 v[70:71], v26 offset:51080
    ds_read_b64_tr_b16 v[72:73], v26 offset:50432
    ds_read_b64_tr_b16 v[74:75], v26 offset:51328
    ds_read_b64_tr_b16 v[76:77], v26 offset:50440
    ds_read_b64_tr_b16 v[78:79], v26 offset:51336
    ds_read_b64_tr_b16 v[80:81], v26 offset:50688
    ds_read_b64_tr_b16 v[82:83], v26 offset:51584
    ds_read_b64_tr_b16 v[84:85], v26 offset:50696
    ds_read_b64_tr_b16 v[86:87], v26 offset:51592
    ds_read_b64_tr_b16 v[88:89], v27 offset:50944
    ds_read_b64_tr_b16 v[90:91], v27 offset:51840
    s_waitcnt lgkmcnt(0)
    ds_write_b128 v28, v[64:67] offset:50176
    v_mfma_f32_16x16x32_bf16 v[136:139], v[32:35], v[64:67], v[136:139]
    ds_write_b128 v28, v[68:71] offset:51200
    v_mfma_f32_16x16x32_bf16 v[140:143], v[32:35], v[68:71], v[140:143]
    ds_write_b128 v28, v[72:75] offset:52224
    v_mfma_f32_16x16x32_bf16 v[144:147], v[32:35], v[72:75], v[144:147]
    ds_write_b128 v28, v[76:79] offset:53248
    v_mfma_f32_16x16x32_bf16 v[148:151], v[32:35], v[76:79], v[148:151]
    ds_write_b128 v28, v[80:83] offset:54272
    v_mfma_f32_16x16x32_bf16 v[152:155], v[32:35], v[80:83], v[152:155]
    ds_write_b128 v28, v[84:87] offset:55296
    v_mfma_f32_16x16x32_bf16 v[156:159], v[32:35], v[84:87], v[156:159]
    ds_write_b128 v28, v[88:91] offset:56320
    v_mfma_f32_16x16x32_bf16 v[160:163], v[32:35], v[88:91], v[160:163]
    s_mul_i32 s26, s23, 448
    s_add_u32 s26, s26, 159744
    v_lshl_add_u32 v5, v3, 2, s26
    s_nop 5
    ds_write_b32 v5, v136 offset:0
    ds_write_b32 v5, v140 offset:64
    ds_write_b32 v5, v144 offset:128
    ds_write_b32 v5, v148 offset:192
    ds_write_b32 v5, v152 offset:256
    ds_write_b32 v5, v156 offset:320
    ds_write_b32 v5, v160 offset:384
    s_waitcnt vmcnt(2)
    s_add_u32 m0, s24, 0
    s_nop 0
    buffer_load_dwordx4 v220, s[84:87], s76 offen lds
    s_add_u32 s76, s76, 8192
    s_add_u32 m0, s24, 1024
    s_nop 0
    buffer_load_dwordx4 v220, s[84:87], s76 offen lds
    s_add_u32 s76, s76, 8192
    s_add_u32 m0, s24, 2048
    s_nop 0
    buffer_load_dwordx4 v220, s[84:87], s76 offen lds
    s_add_u32 s76, s76, 8192
    s_add_u32 m0, s24, 3072
    s_nop 0
    buffer_load_dwordx4 v220, s[84:87], s76 offen lds
    s_add_u32 s76, s76, 8192
    s_add_u32 m0, s24, 4096
    s_nop 0
    buffer_load_dwordx4 v220, s[84:87], s76 offen lds
    s_add_u32 s76, s76, 8192
    s_add_u32 m0, s24, 5120
    s_nop 0
    buffer_load_dwordx4 v220, s[84:87], s76 offen lds
    s_add_u32 s76, s76, 8192
    s_add_u32 m0, s24, 6144
    s_nop 0
    buffer_load_dwordx4 v220, s[84:87], s76 offen lds
    s_add_u32 s76, s76, 8192
    s_add_u32 m0, s24, 7168
    s_nop 0
    buffer_load_dwordx4 v220, s[84:87], s76 offen lds
    s_add_u32 s76, s76, 8192
    s_waitcnt vmcnt(6)
    ds_read_b64_tr_b16 a[0:1], v223 offset:0
    ds_read_b64_tr_b16 a[2:3], v223 offset:512
    ds_read_b64_tr_b16 a[4:5], v223 offset:64
    ds_read_b64_tr_b16 a[6:7], v223 offset:576
    s_waitcnt vmcnt(4)
    ds_read_b64_tr_b16 a[8:9], v223 offset:2048
    ds_read_b64_tr_b16 a[10:11], v223 offset:2560
    ds_read_b64_tr_b16 a[12:13], v223 offset:2112
    ds_read_b64_tr_b16 a[14:15], v223 offset:2624
    s_waitcnt lgkmcnt(4)
    s_add_u32 m0, s24, 0
    s_nop 0
    buffer_load_dwordx4 v220, s[84:87], s76 offen lds
    s_add_u32 s76, s76, 8192
    s_add_u32 m0, s24, 1024
    s_nop 0
    buffer_load_dwordx4 v220, s[84:87], s76 offen lds
    s_add_u32 s76, s76, 8192
    v_lshlrev_b32 v29, 7, v2
    s_mov_b32 s64, s82
    s_and_b32 s65, s83, 0xffff
    s_mov_b32 s66, 0xe00
    v_and_b32 v10, 12, v3
    v_add_u32 v10, v10, v3
    v_lshlrev_b32 v10, 1, v10
    v_lshlrev_b32 v11, 1, v3
    s_mul_i32 s26, s17, 224
    buffer_load_ushort v204, v10, s[64:67], s26 offen offset:0
    buffer_load_ushort v205, v10, s[64:67], s26 offen offset:8
    buffer_load_ushort v206, v10, s[64:67], s26 offen offset:64
    buffer_load_ushort v207, v10, s[64:67], s26 offen offset:72
    buffer_load_ushort v208, v10, s[64:67], s26 offen offset:128
    buffer_load_ushort v209, v10, s[64:67], s26 offen offset:136
    buffer_load_ushort v210, v11, s[64:67], s26 offen offset:192
    v_mov_b32 v19, v9
    v_lshlrev_b32 v0, 9, v4
    v_lshl_add_u32 v0, v3, 4, v0
    v_lshrrev_b32 v1, 1, v4
    v_lshlrev_b32 v1, 9, v1
    v_lshl_add_u32 v1, v3, 4, v1
    v_and_b32 v18, 1, v4
    v_lshl_add_u32 v1, v18, 3, v1
    v_lshlrev_b32 v8, 2, v3
    v_lshl_add_u32 v8, v4, 28, v8
    v_lshlrev_b32 v18, 2, v3
    v_add_u32 v18, 159744, v18
    v_cmp_eq_u32 s[34:35], 0, v4
    v_lshlrev_b32 v3, 6, v3
    v_lshl_add_u32 v4, v4, 4, v3
    v_mov_b32 v3, v16
    v_mov_b32 v5, v230
    v_mov_b32 v9, v222
    v_mov_b32 v11, v231
    v_add_u32 v6, 57344, v3
    v_lshrrev_b32 v20, 3, v2
    v_and_b32 v21, 7, v2
    v_lshlrev_b32 v12, 8, v21
    v_lshl_add_u32 v12, v20, 4, v12
    v_mul_u32_u24 v10, 544, v21
    v_lshl_add_u32 v10, v20, 4, v10
    s_lshl_b32 s26, s18, 7
    s_add_u32 s26, s26, 114688
    v_add_u32 v10, s26, v10
    s_mul_i32 s26, s18, 8704
    s_add_u32 s26, s26, 114688
    v_and_b32 v2, 32, v2
    v_add3_u32 v2, v2, v3, s26
    s_mov_b32 s44, s46
    buffer_load_dwordx2 v[92:93], v5, s[52:55], s7 offen offset:0 sc1
    buffer_load_dwordx2 v[120:121], v5, s[52:55], s7 offen offset:1024 sc1
    s_waitcnt vmcnt(13)
    ds_read_b64_tr_b16 a[16:17], v223 offset:4096
    ds_read_b64_tr_b16 a[18:19], v223 offset:4608
    ds_read_b64_tr_b16 a[20:21], v223 offset:4160
    ds_read_b64_tr_b16 a[22:23], v223 offset:4672
    s_waitcnt lgkmcnt(4)
    s_add_u32 m0, s24, 2048
    s_nop 0
    buffer_load_dwordx4 v220, s[84:87], s76 offen lds
    s_add_u32 s76, s76, 8192
    s_add_u32 m0, s24, 3072
    s_nop 0
    buffer_load_dwordx4 v220, s[84:87], s76 offen lds
    s_add_u32 s76, s76, 8192
    s_waitcnt vmcnt(13)
    ds_read_b64_tr_b16 a[24:25], v223 offset:6144
    ds_read_b64_tr_b16 a[26:27], v223 offset:6656
    ds_read_b64_tr_b16 a[28:29], v223 offset:6208
    ds_read_b64_tr_b16 a[30:31], v223 offset:6720
    s_waitcnt lgkmcnt(4)
    s_add_u32 m0, s24, 4096
    s_nop 0
    buffer_load_dwordx4 v220, s[84:87], s76 offen lds
    s_add_u32 s76, s76, 8192
    s_add_u32 m0, s24, 5120
    s_nop 0
    buffer_load_dwordx4 v220, s[84:87], s76 offen lds
    s_add_u32 s76, s76, 8192
    s_waitcnt vmcnt(13)
    ds_read_b64_tr_b16 a[32:33], v223 offset:0
    ds_read_b64_tr_b16 a[34:35], v223 offset:512
    ds_read_b64_tr_b16 a[36:37], v223 offset:64
    ds_read_b64_tr_b16 a[38:39], v223 offset:576
    s_waitcnt lgkmcnt(4)
    s_add_u32 m0, s24, 6144
    s_nop 0
    buffer_load_dwordx4 v220, s[84:87], s76 offen lds
    s_add_u32 s76, s76, 8192
    s_add_u32 m0, s24, 7168
    s_nop 0
    buffer_load_dwordx4 v220, s[84:87], s76 offen lds
    s_add_u32 s76, s76, 8192
    v_accvgpr_read_b32 v90, a224
    v_lshlrev_b32 v72, 16, v90
    v_and_b32 v73, 0xffff0000, v90
    v_accvgpr_read_b32 v90, a225
    v_lshlrev_b32 v74, 16, v90
    v_and_b32 v75, 0xffff0000, v90
    v_accvgpr_read_b32 v90, a226
    v_lshlrev_b32 v76, 16, v90
    v_and_b32 v77, 0xffff0000, v90
    v_accvgpr_read_b32 v90, a227
    v_lshlrev_b32 v78, 16, v90
    v_and_b32 v79, 0xffff0000, v90
    v_accvgpr_read_b32 v118, a228
    s_waitcnt vmcnt(4)
    ds_read_b64_tr_b16 a[40:41], v223 offset:2048
    ds_read_b64_tr_b16 a[42:43], v223 offset:2560
    ds_read_b64_tr_b16 a[44:45], v223 offset:2112
    ds_read_b64_tr_b16 a[46:47], v223 offset:2624
    s_waitcnt lgkmcnt(4)
    s_add_u32 m0, s24, 0
    s_nop 0
    buffer_load_dwordx4 v220, s[84:87], s76 offen lds
    s_add_u32 s76, s76, 8192
    s_add_u32 m0, s24, 1024
    s_nop 0
    buffer_load_dwordx4 v220, s[84:87], s76 offen lds
    s_add_u32 s76, s76, 8192
    v_lshlrev_b32 v100, 16, v118
    v_and_b32 v101, 0xffff0000, v118
    v_accvgpr_read_b32 v118, a229
    v_lshlrev_b32 v102, 16, v118
    v_and_b32 v103, 0xffff0000, v118
    v_accvgpr_read_b32 v118, a230
    v_lshlrev_b32 v104, 16, v118
    v_and_b32 v105, 0xffff0000, v118
    v_accvgpr_read_b32 v118, a231
    v_lshlrev_b32 v106, 16, v118
    v_and_b32 v107, 0xffff0000, v118
    v_cmp_gt_i32 vcc, 0, v93
    s_cbranch_vccnz SWAIT_28
SOK_27:
    s_nop 0
    v_add_f32_dpp v92, v92, v92 quad_perm:[1,0,3,2] row_mask:0xf bank_mask:0xf
    s_waitcnt vmcnt(4)
    ds_read_b64_tr_b16 a[48:49], v223 offset:4096
    ds_read_b64_tr_b16 a[50:51], v223 offset:4608
    ds_read_b64_tr_b16 a[52:53], v223 offset:4160
    ds_read_b64_tr_b16 a[54:55], v223 offset:4672
    s_waitcnt lgkmcnt(4)
    s_add_u32 m0, s24, 2048
    s_nop 0
    buffer_load_dwordx4 v220, s[84:87], s76 offen lds
    s_add_u32 s76, s76, 8192
    s_add_u32 m0, s24, 3072
    s_nop 0
    buffer_load_dwordx4 v220, s[84:87], s76 offen lds
    s_add_u32 s76, s76, 8192
    v_add_f32_dpp v93, v93, v93 quad_perm:[1,0,3,2] row_mask:0xf bank_mask:0xf
    s_nop 0
    v_add_f32_dpp v92, v92, v92 quad_perm:[2,3,0,1] row_mask:0xf bank_mask:0xf
    v_add_f32_dpp v93, v93, v93 quad_perm:[2,3,0,1] row_mask:0xf bank_mask:0xf
    s_nop 0
    v_add_f32_dpp v92, v92, v92 row_half_mirror row_mask:0xf bank_mask:0xf
    v_add_f32_dpp v93, v93, v93 row_half_mirror row_mask:0xf bank_mask:0xf
    v_mul_f32 v92, 0x3b000000, v92
    v_mul_f32 v94, 0x3b000000, v93
    v_fma_f32 v94, -v92, v92, v94
    v_max_f32 v94, 0, v94
    v_cvt_pk_bf16_f32 v90, v92, v94
    v_lshlrev_b32 v92, 16, v90
    v_and_b32 v94, 0xffff0000, v90
    s_waitcnt vmcnt(4)
    ds_read_b64_tr_b16 a[56:57], v223 offset:6144
    ds_read_b64_tr_b16 a[58:59], v223 offset:6656
    ds_read_b64_tr_b16 a[60:61], v223 offset:6208
    ds_read_b64_tr_b16 a[62:63], v223 offset:6720
    s_waitcnt lgkmcnt(4)
    s_add_u32 m0, s24, 4096
    s_nop 0
    buffer_load_dwordx4 v220, s[84:87], s76 offen lds
    s_add_u32 s76, s76, 8192
    s_add_u32 m0, s24, 5120
    s_nop 0
    buffer_load_dwordx4 v220, s[84:87], s76 offen lds
    s_add_u32 s76, s76, 8192
    v_add_f32 v94, 0x3727c5ac, v94
    v_cvt_pk_bf16_f32 v90, v94, v94
    v_lshlrev_b32 v94, 16, v90
    v_sqrt_f32 v94, v94
    s_nop 0
    v_cvt_pk_bf16_f32 v90, v94, v94
    v_lshlrev_b32 v94, 16, v90
    v_rcp_f32 v94, v94
    s_nop 0
    v_pk_add_f32 v[80:81], v[72:73], v[92:93] op_sel_hi:[1,0] neg_lo:[0,1] neg_hi:[0,1]
    v_pk_add_f32 v[82:83], v[74:75], v[92:93] op_sel_hi:[1,0] neg_lo:[0,1] neg_hi:[0,1]
    v_pk_add_f32 v[84:85], v[76:77], v[92:93] op_sel_hi:[1,0] neg_lo:[0,1] neg_hi:[0,1]
    v_pk_add_f32 v[86:87], v[78:79], v[92:93] op_sel_hi:[1,0] neg_lo:[0,1] neg_hi:[0,1]
    v_cvt_pk_bf16_f32 v96, v80, v84
    s_waitcnt vmcnt(4)
    ds_read_b64_tr_b16 a[64:65], v223 offset:0
    ds_read_b64_tr_b16 a[66:67], v223 offset:512
    ds_read_b64_tr_b16 a[68:69], v223 offset:64
    ds_read_b64_tr_b16 a[70:71], v223 offset:576
    s_waitcnt lgkmcnt(4)
    s_add_u32 m0, s24, 6144
    s_nop 0
    buffer_load_dwordx4 v220, s[84:87], s76 offen lds
    s_add_u32 s76, s76, 8192
    s_add_u32 m0, s24, 7168
    s_nop 0
    buffer_load_dwordx4 v220, s[84:87], s76 offen lds
    s_add_u32 s76, s76, 8192
    v_cvt_pk_bf16_f32 v97, v81, v85
    v_cvt_pk_bf16_f32 v98, v82, v86
    v_cvt_pk_bf16_f32 v99, v83, v87
    v_lshlrev_b32 v80, 16, v96
    v_and_b32 v84, 0xffff0000, v96
    v_lshlrev_b32 v81, 16, v97
    v_and_b32 v85, 0xffff0000, v97
    v_lshlrev_b32 v82, 16, v98
    v_and_b32 v86, 0xffff0000, v98
    v_lshlrev_b32 v83, 16, v99
    v_and_b32 v87, 0xffff0000, v99
    v_pk_mul_f32 v[80:81], v[80:81], v[94:95] op_sel_hi:[1,0]
    v_pk_mul_f32 v[82:83], v[82:83], v[94:95] op_sel_hi:[1,0]
    v_pk_mul_f32 v[84:85], v[84:85], v[94:95] op_sel_hi:[1,0]
    s_waitcnt vmcnt(4)
    ds_read_b64_tr_b16 a[72:73], v223 offset:2048
    ds_read_b64_tr_b16 a[74:75], v223 offset:2560
    ds_read_b64_tr_b16 a[76:77], v223 offset:2112
    ds_read_b64_tr_b16 a[78:79], v223 offset:2624
    s_waitcnt lgkmcnt(4)
    s_add_u32 m0, s24, 0
    s_nop 0
    buffer_load_dwordx4 v220, s[84:87], s76 offen lds
    s_add_u32 s76, s76, 8192
    s_add_u32 m0, s24, 1024
    s_nop 0
    buffer_load_dwordx4 v220, s[84:87], s76 offen lds
    s_add_u32 s76, s76, 8192
    v_pk_mul_f32 v[86:87], v[86:87], v[94:95] op_sel_hi:[1,0]
    v_cvt_pk_bf16_f32 v96, v80, v84
    v_cvt_pk_bf16_f32 v97, v81, v85
    v_cvt_pk_bf16_f32 v98, v82, v86
    v_cvt_pk_bf16_f32 v99, v83, v87
    v_lshlrev_b32 v80, 16, v96
    v_and_b32 v84, 0xffff0000, v96
    v_lshlrev_b32 v81, 16, v97
    v_and_b32 v85, 0xffff0000, v97
    v_lshlrev_b32 v82, 16, v98
    v_and_b32 v86, 0xffff0000, v98
    v_lshlrev_b32 v83, 16, v99
    v_and_b32 v87, 0xffff0000, v99
    v_cmp_gt_i32 vcc, 0, v121
    s_cbranch_vccnz SWAIT_31
SOK_30:
    s_waitcnt vmcnt(4)
    ds_read_b64_tr_b16 a[80:81], v223 offset:4096
    ds_read_b64_tr_b16 a[82:83], v223 offset:4608
    ds_read_b64_tr_b16 a[84:85], v223 offset:4160
    ds_read_b64_tr_b16 a[86:87], v223 offset:4672
    s_waitcnt lgkmcnt(4)
    s_add_u32 m0, s24, 2048
    s_nop 0
    buffer_load_dwordx4 v220, s[84:87], s76 offen lds
    s_add_u32 s76, s76, 8192
    s_add_u32 m0, s24, 3072
    s_nop 0
    buffer_load_dwordx4 v220, s[84:87], s76 offen lds
    s_add_u32 s76, s76, 8192
    s_nop 0
    v_add_f32_dpp v120, v120, v120 quad_perm:[1,0,3,2] row_mask:0xf bank_mask:0xf
    v_add_f32_dpp v121, v121, v121 quad_perm:[1,0,3,2] row_mask:0xf bank_mask:0xf
    s_nop 0
    v_add_f32_dpp v120, v120, v120 quad_perm:[2,3,0,1] row_mask:0xf bank_mask:0xf
    v_add_f32_dpp v121, v121, v121 quad_perm:[2,3,0,1] row_mask:0xf bank_mask:0xf
    s_nop 0
    v_add_f32_dpp v120, v120, v120 row_half_mirror row_mask:0xf bank_mask:0xf
    v_add_f32_dpp v121, v121, v121 row_half_mirror row_mask:0xf bank_mask:0xf
    v_mul_f32 v120, 0x3b000000, v120
    v_mul_f32 v122, 0x3b000000, v121
    v_fma_f32 v122, -v120, v120, v122
    v_max_f32 v122, 0, v122
    v_cvt_pk_bf16_f32 v118, v120, v122
    s_waitcnt vmcnt(4)
    ds_read_b64_tr_b16 a[88:89], v223 offset:6144
    ds_read_b64_tr_b16 a[90:91], v223 offset:6656
    ds_read_b64_tr_b16 a[92:93], v223 offset:6208
    ds_read_b64_tr_b16 a[94:95], v223 offset:6720
    s_waitcnt lgkmcnt(4)
    s_add_u32 m0, s24, 4096
    s_nop 0
    buffer_load_dwordx4 v220, s[84:87], s76 offen lds
    s_add_u32 s76, s76, 8192
    s_add_u32 m0, s24, 5120
    s_nop 0
    buffer_load_dwordx4 v220, s[84:87], s76 offen lds
    s_add_u32 s76, s76, 8192
    v_lshlrev_b32 v120, 16, v118
    v_and_b32 v122, 0xffff0000, v118
    v_add_f32 v122, 0x3727c5ac, v122
    v_cvt_pk_bf16_f32 v118, v122, v122
    v_lshlrev_b32 v122, 16, v118
    v_sqrt_f32 v122, v122
    s_nop 0
    v_cvt_pk_bf16_f32 v118, v122, v122
    v_lshlrev_b32 v122, 16, v118
    v_rcp_f32 v122, v122
    s_nop 0
    v_pk_add_f32 v[108:109], v[100:101], v[120:121] op_sel_hi:[1,0] neg_lo:[0,1] neg_hi:[0,1]
    v_pk_add_f32 v[110:111], v[102:103], v[120:121] op_sel_hi:[1,0] neg_lo:[0,1] neg_hi:[0,1]
    v_pk_add_f32 v[112:113], v[104:105], v[120:121] op_sel_hi:[1,0] neg_lo:[0,1] neg_hi:[0,1]
    s_waitcnt vmcnt(4)
    ds_read_b64_tr_b16 a[96:97], v223 offset:0
    ds_read_b64_tr_b16 a[98:99], v223 offset:512
    ds_read_b64_tr_b16 a[100:101], v223 offset:64
    ds_read_b64_tr_b16 a[102:103], v223 offset:576
    s_waitcnt lgkmcnt(4)
    s_add_u32 m0, s24, 6144
    s_nop 0
    buffer_load_dwordx4 v220, s[84:87], s76 offen lds
    s_add_u32 s76, s76, 8192
    s_add_u32 m0, s24, 7168
    s_nop 0
    buffer_load_dwordx4 v220, s[84:87], s76 offen lds
    s_add_u32 s76, s76, 8192
    v_pk_add_f32 v[114:115], v[106:107], v[120:121] op_sel_hi:[1,0] neg_lo:[0,1] neg_hi:[0,1]
    v_cvt_pk_bf16_f32 v124, v108, v112
    v_cvt_pk_bf16_f32 v125, v109, v113
    v_cvt_pk_bf16_f32 v126, v110, v114
    v_cvt_pk_bf16_f32 v127, v111, v115
    v_lshlrev_b32 v108, 16, v124
    v_and_b32 v112, 0xffff0000, v124
    v_lshlrev_b32 v109, 16, v125
    v_and_b32 v113, 0xffff0000, v125
    v_lshlrev_b32 v110, 16, v126
    v_and_b32 v114, 0xffff0000, v126
    v_lshlrev_b32 v111, 16, v127
    v_and_b32 v115, 0xffff0000, v127
    v_pk_mul_f32 v[108:109], v[108:109], v[122:123] op_sel_hi:[1,0]
    s_waitcnt vmcnt(4)
    ds_read_b64_tr_b16 a[104:105], v223 offset:2048
    ds_read_b64_tr_b16 a[106:107], v223 offset:2560
    ds_read_b64_tr_b16 a[108:109], v223 offset:2112
    ds_read_b64_tr_b16 a[110:111], v223 offset:2624
    v_pk_mul_f32 v[110:111], v[110:111], v[122:123] op_sel_hi:[1,0]
    v_pk_mul_f32 v[112:113], v[112:113], v[122:123] op_sel_hi:[1,0]
    v_pk_mul_f32 v[114:115], v[114:115], v[122:123] op_sel_hi:[1,0]
    v_cvt_pk_bf16_f32 v124, v108, v112
    v_cvt_pk_bf16_f32 v125, v109, v113
    v_cvt_pk_bf16_f32 v126, v110, v114
    v_cvt_pk_bf16_f32 v127, v111, v115
    v_lshlrev_b32 v108, 16, v124
    v_and_b32 v112, 0xffff0000, v124
    v_lshlrev_b32 v109, 16, v125
    v_and_b32 v113, 0xffff0000, v125
    v_lshlrev_b32 v110, 16, v126
    v_and_b32 v114, 0xffff0000, v126
    v_lshlrev_b32 v111, 16, v127
    s_waitcnt vmcnt(2)
    ds_read_b64_tr_b16 a[112:113], v223 offset:4096
    ds_read_b64_tr_b16 a[114:115], v223 offset:4608
    ds_read_b64_tr_b16 a[116:117], v223 offset:4160
    ds_read_b64_tr_b16 a[118:119], v223 offset:4672
    v_and_b32 v115, 0xffff0000, v127
    s_add_u32 s7, s7, 0x20000
    s_lshl_b32 s46, s12, 15
    s_lshl_b32 s47, s20, 7
    s_lshl_b32 s77, s20, 18
    s_add_u32 s77, s77, 0x400000
    s_waitcnt vmcnt(0)
    ds_read_b64_tr_b16 a[120:121], v223 offset:6144
    ds_read_b64_tr_b16 a[122:123], v223 offset:6656
    ds_read_b64_tr_b16 a[124:125], v223 offset:6208
    ds_read_b64_tr_b16 a[126:127], v223 offset:6720
    s_waitcnt lgkmcnt(0)
    s_add_u32 m0, s24, 0
    s_nop 0
    buffer_load_dwordx4 v220, s[84:87], s76 offen lds
    s_add_u32 s76, s76, 8192
    s_add_u32 m0, s24, 1024
    s_nop 0
    buffer_load_dwordx4 v220, s[84:87], s76 offen lds
    s_add_u32 s76, s76, 8192
    s_add_u32 m0, s24, 2048
    s_nop 0
    buffer_load_dwordx4 v220, s[84:87], s76 offen lds
    s_add_u32 s76, s76, 8192
    s_add_u32 m0, s24, 3072
    s_nop 0
    buffer_load_dwordx4 v220, s[84:87], s76 offen lds
    s_add_u32 s76, s76, 8192
    s_add_u32 m0, s24, 4096
    s_nop 0
    buffer_load_dwordx4 v220, s[84:87], s76 offen lds
    s_add_u32 s76, s76, 8192
    s_add_u32 m0, s24, 5120
    s_nop 0
    buffer_load_dwordx4 v220, s[84:87], s76 offen lds
    s_add_u32 s76, s76, 8192
    s_add_u32 m0, s24, 6144
    s_nop 0
    buffer_load_dwordx4 v220, s[84:87], s76 offen lds
    s_add_u32 s76, s76, 8192
    s_add_u32 m0, s24, 7168
    s_nop 0
    buffer_load_dwordx4 v220, s[84:87], s76 offen lds
    s_add_u32 s76, s76, 8192
    s_lshl_b32 s29, s20, 2
    s_and_b32 s26, s16, 3
    s_add_u32 s29, s29, s26
    s_lshl_b32 s29, s29, 9
    s_add_u32 s29, s29, 0x800000
    s_cmp_lg_u32 s18, 2
    s_cbranch_scc1 K_JOIN
    s_mov_b32 s40, 1600000
LW_33:
    ds_read_b32 v218, v219 offset:16
    s_sub_u32 s40, s40, 1
    s_cbranch_scc1 LWX_34
    s_waitcnt lgkmcnt(0)
    v_cmp_gt_u32 vcc, 1, v218
    s_cbranch_vccz LWX_34
    s_sleep 1
    s_branch LW_33
LWX_34:
    s_waitcnt lgkmcnt(0)
    s_mov_b32 s40, 200000
POLL_35:
    buffer_load_dwordx2 v[232:233], v5, s[52:55], s29 offen offset:0 sc1
    s_sub_u32 s40, s40, 1
    s_cbranch_scc1 POLLX_36
    s_waitcnt vmcnt(0)
    v_xor_b32 v232, s51, v232
    v_xor_b32 v233, s49, v233
    v_or_b32 v232, v232, v233
    v_cmp_ne_u32 vcc, 0, v232
    s_cbranch_vccnz POLL_35
POLLX_36:
    s_waitcnt vmcnt(0)
K_JOIN:
    v_lshrrev_b32 v13, 2, v3
    v_and_b32 v13, 60, v13
    s_waitcnt lgkmcnt(0)
    s_barrier
    buffer_load_dword v164, v19, s[52:55], s77 offen sc1
    s_add_u32 s77, s77, 4096
    buffer_load_dword v165, v19, s[52:55], s77 offen sc1
    s_add_u32 s77, s77, 4096
    buffer_load_dword v166, v19, s[52:55], s77 offen sc1
    s_add_u32 s77, s77, 4096
    buffer_load_dword v167, v19, s[52:55], s77 offen sc1
    s_add_u32 s77, s77, 4096
    buffer_load_dword v168, v19, s[52:55], s77 offen sc1
    s_add_u32 s77, s77, 4096
    buffer_load_dword v169, v19, s[52:55], s77 offen sc1
    s_add_u32 s77, s77, 4096
    buffer_load_dword v170, v19, s[52:55], s77 offen sc1
    s_add_u32 s77, s77, 4096
    buffer_load_dword v171, v19, s[52:55], s77 offen sc1
    s_waitcnt vmcnt(8)
    ds_read_b64_tr_b16 a[128:129], v223 offset:0
    ds_read_b64_tr_b16 a[130:131], v223 offset:512
    ds_read_b64_tr_b16 a[132:133], v223 offset:64
    ds_read_b64_tr_b16 a[134:135], v223 offset:576
    ds_read_b64_tr_b16 a[136:137], v223 offset:2048
    ds_read_b64_tr_b16 a[138:139], v223 offset:2560
    ds_read_b64_tr_b16 a[140:141], v223 offset:2112
    ds_read_b64_tr_b16 a[142:143], v223 offset:2624
    ds_read_b64_tr_b16 a[144:145], v223 offset:4096
    ds_read_b64_tr_b16 a[146:147], v223 offset:4608
    ds_read_b64_tr_b16 a[148:149], v223 offset:4160
    ds_read_b64_tr_b16 a[150:151], v223 offset:4672
    ds_read_b64_tr_b16 a[152:153], v223 offset:6144
    ds_read_b64_tr_b16 a[154:155], v223 offset:6656
    ds_read_b64_tr_b16 a[156:157], v223 offset:6208
    ds_read_b64_tr_b16 a[158:159], v223 offset:6720
    s_waitcnt lgkmcnt(0)
    s_add_u32 m0, s24, 0
    s_nop 0
    buffer_load_dwordx4 v220, s[84:87], s76 offen lds
    s_add_u32 s76, s76, 8192
    s_add_u32 m0, s24, 1024
    s_nop 0
    buffer_load_dwordx4 v220, s[84:87], s76 offen lds
    s_add_u32 s76, s76, 8192
    s_add_u32 m0, s24, 2048
    s_nop 0
    buffer_load_dwordx4 v220, s[84:87], s76 offen lds
    s_add_u32 s76, s76, 8192
    s_add_u32 m0, s24, 3072
    s_nop 0
    buffer_load_dwordx4 v220, s[84:87], s76 offen lds
    s_add_u32 s76, s76, 8192
    s_add_u32 m0, s24, 4096
    s_nop 0
    buffer_load_dwordx4 v220, s[84:87], s76 offen lds
    s_add_u32 s76, s76, 8192
    s_add_u32 m0, s24, 5120
    s_nop 0
    buffer_load_dwordx4 v220, s[84:87], s76 offen lds
    s_add_u32 s76, s76, 8192
    s_add_u32 m0, s24, 6144
    s_nop 0
    buffer_load_dwordx4 v220, s[84:87], s76 offen lds
    s_add_u32 s76, s76, 8192
    s_add_u32 m0, s24, 7168
    s_nop 0
    buffer_load_dwordx4 v220, s[84:87], s76 offen lds
    s_add_u32 s76, s76, 8192
    ds_read2_b32 v[224:225], v18 offset0:0 offset1:112
    ds_read2_b32 v[228:229], v18 offset0:16 offset1:128
    ds_read2_b32 v[232:233], v18 offset0:32 offset1:144
    ds_read2_b32 v[236:237], v18 offset0:48 offset1:160
    ds_read2_b32 v[240:241], v18 offset0:64 offset1:176
    ds_read2_b32 v[244:245], v18 offset0:80 offset1:192
    ds_read2_b32 v[248:249], v18 offset0:96 offset1:208
    s_waitcnt lgkmcnt(0)
    v_add_f32 v224, v224, v225
    v_cvt_pk_bf16_f32 v225, v224, v224
    v_and_b32 v226, 0xffff0000, v225
    v_sub_f32 v224, v224, v226
    v_cvt_pk_bf16_f32 v225, v226, v224
    v_and_b32 v226, 0xffff0000, v225
    v_sub_f32 v224, v224, v226
    v_lshlrev_b32 v227, 16, v204
    v_cvt_pk_bf16_f32 v226, v224, v227
    v_accvgpr_write_b32 a240, v225
    v_accvgpr_write_b32 a241, v226
    v_add_f32 v228, v228, v229
    v_cvt_pk_bf16_f32 v229, v228, v228
    v_and_b32 v230, 0xffff0000, v229
    v_sub_f32 v228, v228, v230
    v_cvt_pk_bf16_f32 v229, v230, v228
    v_and_b32 v230, 0xffff0000, v229
    v_sub_f32 v228, v228, v230
    v_lshlrev_b32 v231, 16, v205
    v_cvt_pk_bf16_f32 v230, v228, v231
    v_accvgpr_write_b32 a242, v229
    v_accvgpr_write_b32 a243, v230
    v_add_f32 v232, v232, v233
    v_cvt_pk_bf16_f32 v233, v232, v232
    v_and_b32 v234, 0xffff0000, v233
    v_sub_f32 v232, v232, v234
    v_cvt_pk_bf16_f32 v233, v234, v232
    v_and_b32 v234, 0xffff0000, v233
    v_sub_f32 v232, v232, v234
    v_lshlrev_b32 v235, 16, v206
    v_cvt_pk_bf16_f32 v234, v232, v235
    v_accvgpr_write_b32 a244, v233
    v_accvgpr_write_b32 a245, v234
    v_add_f32 v236, v236, v237
    v_cvt_pk_bf16_f32 v237, v236, v236
    v_and_b32 v238, 0xffff0000, v237
    v_sub_f32 v236, v236, v238
    v_cvt_pk_bf16_f32 v237, v238, v236
    v_and_b32 v238, 0xffff0000, v237
    v_sub_f32 v236, v236, v238
    v_lshlrev_b32 v239, 16, v207
    v_cvt_pk_bf16_f32 v238, v236, v239
    v_accvgpr_write_b32 a246, v237
    v_accvgpr_write_b32 a247, v238
    v_add_f32 v240, v240, v241
    v_cvt_pk_bf16_f32 v241, v240, v240
    v_and_b32 v242, 0xffff0000, v241
    v_sub_f32 v240, v240, v242
    v_cvt_pk_bf16_f32 v241, v242, v240
    v_and_b32 v242, 0xffff0000, v241
    v_sub_f32 v240, v240, v242
    v_lshlrev_b32 v243, 16, v208
    v_cvt_pk_bf16_f32 v242, v240, v243
    v_accvgpr_write_b32 a248, v241
    v_accvgpr_write_b32 a249, v242
    v_add_f32 v244, v244, v245
    v_cvt_pk_bf16_f32 v245, v244, v244
    v_and_b32 v246, 0xffff0000, v245
    v_sub_f32 v244, v244, v246
    v_cvt_pk_bf16_f32 v245, v246, v244
    v_and_b32 v246, 0xffff0000, v245
    v_sub_f32 v244, v244, v246
    v_lshlrev_b32 v247, 16, v209
    v_cvt_pk_bf16_f32 v246, v244, v247
    v_accvgpr_write_b32 a250, v245
    v_accvgpr_write_b32 a251, v246
    v_add_f32 v248, v248, v249
    v_cvt_pk_bf16_f32 v249, v248, v248
    v_and_b32 v250, 0xffff0000, v249
    v_sub_f32 v248, v248, v250
    v_cvt_pk_bf16_f32 v249, v250, v248
    v_and_b32 v250, 0xffff0000, v249
    v_sub_f32 v248, v248, v250
    v_lshlrev_b32 v251, 16, v210
    v_cvt_pk_bf16_f32 v250, v248, v251
    v_accvgpr_write_b32 a252, v249
    v_accvgpr_write_b32 a253, v250
    s_waitcnt vmcnt(8)
    v_lshlrev_b32 v64, 16, v164
    v_lshlrev_b32 v65, 16, v165
    v_lshlrev_b32 v66, 16, v166
    v_lshlrev_b32 v67, 16, v167
    v_lshlrev_b32 v68, 16, v168
    v_lshlrev_b32 v69, 16, v169
    v_lshlrev_b32 v70, 16, v170
    v_lshlrev_b32 v71, 16, v171
    v_pk_mul_f32 v[64:65], v[64:65], v[80:81]
    v_pk_mul_f32 v[66:67], v[66:67], v[82:83]
    v_pk_mul_f32 v[68:69], v[68:69], v[84:85]
    v_pk_mul_f32 v[70:71], v[70:71], v[86:87]
    v_cvt_pk_bf16_f32 v96, v64, v68
    v_cvt_pk_bf16_f32 v97, v65, v69
    v_cvt_pk_bf16_f32 v98, v66, v70
    v_cvt_pk_bf16_f32 v99, v67, v71
    v_lshlrev_b32 v64, 16, v96
    v_and_b32 v68, 0xffff0000, v96
    v_lshlrev_b32 v65, 16, v97
    v_and_b32 v69, 0xffff0000, v97
    v_lshlrev_b32 v66, 16, v98
    v_and_b32 v70, 0xffff0000, v98
    v_lshlrev_b32 v67, 16, v99
    v_and_b32 v71, 0xffff0000, v99
    v_pk_add_f32 v[72:73], v[72:73], v[64:65]
    v_pk_add_f32 v[74:75], v[74:75], v[66:67]
    v_pk_add_f32 v[76:77], v[76:77], v[68:69]
    v_pk_add_f32 v[78:79], v[78:79], v[70:71]
    v_cvt_pk_bf16_f32 v96, v72, v73
    v_cvt_pk_bf16_f32 v97, v74, v75
    v_cvt_pk_bf16_f32 v98, v76, v77
    v_cvt_pk_bf16_f32 v99, v78, v79
    v_and_b32 v64, 0xffff0000, v164
    v_and_b32 v65, 0xffff0000, v165
    v_and_b32 v66, 0xffff0000, v166
    v_and_b32 v67, 0xffff0000, v167
    v_and_b32 v68, 0xffff0000, v168
    v_and_b32 v69, 0xffff0000, v169
    v_and_b32 v70, 0xffff0000, v170
    v_and_b32 v71, 0xffff0000, v171
    v_pk_mul_f32 v[64:65], v[64:65], v[108:109]
    v_pk_mul_f32 v[66:67], v[66:67], v[110:111]
    v_pk_mul_f32 v[68:69], v[68:69], v[112:113]
    v_pk_mul_f32 v[70:71], v[70:71], v[114:115]
    v_cvt_pk_bf16_f32 v124, v64, v68
    v_cvt_pk_bf16_f32 v125, v65, v69
    v_cvt_pk_bf16_f32 v126, v66, v70
    v_cvt_pk_bf16_f32 v127, v67, v71
    v_lshlrev_b32 v64, 16, v124
    v_and_b32 v68, 0xffff0000, v124
    v_lshlrev_b32 v65, 16, v125
    v_and_b32 v69, 0xffff0000, v125
    v_lshlrev_b32 v66, 16, v126
    v_and_b32 v70, 0xffff0000, v126
    v_lshlrev_b32 v67, 16, v127
    v_and_b32 v71, 0xffff0000, v127
    v_pk_add_f32 v[100:101], v[100:101], v[64:65]
    v_pk_add_f32 v[102:103], v[102:103], v[66:67]
    v_pk_add_f32 v[104:105], v[104:105], v[68:69]
    v_pk_add_f32 v[106:107], v[106:107], v[70:71]
    v_cvt_pk_bf16_f32 v124, v100, v101
    v_cvt_pk_bf16_f32 v125, v102, v103
    v_cvt_pk_bf16_f32 v126, v104, v105
    v_cvt_pk_bf16_f32 v127, v106, v107
    s_cmp_eq_u32 s44, 0
    s_cbranch_scc1 K_SLOW
    buffer_store_dwordx4 v[96:99], v12, s[52:55], s28 offen
    buffer_store_dwordx4 v[124:127], v12, s[52:55], s33 offen
    v_lshlrev_b32 v72, 16, v96
    v_and_b32 v76, 0xffff0000, v96
    v_lshlrev_b32 v73, 16, v97
    v_and_b32 v77, 0xffff0000, v97
    v_lshlrev_b32 v74, 16, v98
    v_and_b32 v78, 0xffff0000, v98
    v_lshlrev_b32 v75, 16, v99
    v_and_b32 v79, 0xffff0000, v99
    v_pk_add_f32 v[92:93], v[72:73], v[74:75]
    v_pk_mul_f32 v[94:95], v[72:73], v[72:73]
    v_pk_fma_f32 v[94:95], v[74:75], v[74:75], v[94:95]
    v_pk_add_f32 v[92:93], v[92:93], v[76:77]
    v_pk_fma_f32 v[94:95], v[76:77], v[76:77], v[94:95]
    v_pk_add_f32 v[92:93], v[92:93], v[78:79]
    v_pk_fma_f32 v[94:95], v[78:79], v[78:79], v[94:95]
    v_add_f32 v90, v92, v93
    v_add_f32 v91, v94, v95
    s_nop 0
    v_add_f32_dpp v90, v90, v90 quad_perm:[1,0,3,2] row_mask:0xf bank_mask:0xf
    v_add_f32_dpp v91, v91, v91 quad_perm:[1,0,3,2] row_mask:0xf bank_mask:0xf
    s_nop 0
    v_add_f32_dpp v90, v90, v90 quad_perm:[2,3,0,1] row_mask:0xf bank_mask:0xf
    v_add_f32_dpp v91, v91, v91 quad_perm:[2,3,0,1] row_mask:0xf bank_mask:0xf
    s_nop 0
    v_add_f32_dpp v90, v90, v90 row_half_mirror row_mask:0xf bank_mask:0xf
    v_add_f32_dpp v91, v91, v91 row_half_mirror row_mask:0xf bank_mask:0xf
    v_and_b32 v91, 0x7fffffff, v91
    buffer_store_dwordx2 v[90:91], v11, s[52:55], s9 offen offset:0
    v_accvgpr_write_b32 a224, v96
    v_accvgpr_write_b32 a225, v97
    v_accvgpr_write_b32 a226, v98
    v_accvgpr_write_b32 a227, v99
    v_mov_b32 v7, 2
    s_waitcnt vmcnt(1)
    buffer_store_dword v7, v9, s[52:55], s68 offen offset:512
    buffer_load_dword v14, v13, s[52:55], s69 offen offset:512 sc1
    v_lshlrev_b32 v100, 16, v124
    v_and_b32 v104, 0xffff0000, v124
    v_lshlrev_b32 v101, 16, v125
    v_and_b32 v105, 0xffff0000, v125
    v_lshlrev_b32 v102, 16, v126
    v_and_b32 v106, 0xffff0000, v126
    v_lshlrev_b32 v103, 16, v127
    v_and_b32 v107, 0xffff0000, v127
    v_pk_add_f32 v[120:121], v[100:101], v[102:103]
    v_pk_mul_f32 v[122:123], v[100:101], v[100:101]
    v_pk_fma_f32 v[122:123], v[102:103], v[102:103], v[122:123]
    v_pk_add_f32 v[120:121], v[120:121], v[104:105]
    v_pk_fma_f32 v[122:123], v[104:105], v[104:105], v[122:123]
    v_pk_add_f32 v[120:121], v[120:121], v[106:107]
    v_pk_fma_f32 v[122:123], v[106:107], v[106:107], v[122:123]
    v_add_f32 v118, v120, v121
    v_add_f32 v119, v122, v123
    s_nop 0
    v_add_f32_dpp v118, v118, v118 quad_perm:[1,0,3,2] row_mask:0xf bank_mask:0xf
    v_add_f32_dpp v119, v119, v119 quad_perm:[1,0,3,2] row_mask:0xf bank_mask:0xf
    s_nop 0
    v_add_f32_dpp v118, v118, v118 quad_perm:[2,3,0,1] row_mask:0xf bank_mask:0xf
    v_add_f32_dpp v119, v119, v119 quad_perm:[2,3,0,1] row_mask:0xf bank_mask:0xf
    s_nop 0
    v_add_f32_dpp v118, v118, v118 row_half_mirror row_mask:0xf bank_mask:0xf
    v_add_f32_dpp v119, v119, v119 row_half_mirror row_mask:0xf bank_mask:0xf
    v_and_b32 v119, 0x7fffffff, v119
    buffer_store_dwordx2 v[118:119], v11, s[52:55], s9 offen offset:1024
    v_accvgpr_write_b32 a228, v124
    v_accvgpr_write_b32 a229, v125
    v_accvgpr_write_b32 a230, v126
    v_accvgpr_write_b32 a231, v127
    v_accvgpr_write_b32 a232, v164
    v_accvgpr_write_b32 a233, v165
    v_accvgpr_write_b32 a234, v166
    v_accvgpr_write_b32 a235, v167
    v_accvgpr_write_b32 a236, v168
    v_accvgpr_write_b32 a237, v169
    v_accvgpr_write_b32 a238, v170
    v_accvgpr_write_b32 a239, v171
    s_add_u32 s9, s9, 0x20000
    ds_read_b64_tr_b16 a[160:161], v223 offset:0
    ds_read_b64_tr_b16 a[162:163], v223 offset:512
    ds_read_b64_tr_b16 a[164:165], v223 offset:64
    ds_read_b64_tr_b16 a[166:167], v223 offset:576
    ds_read_b64_tr_b16 a[168:169], v223 offset:2048
    ds_read_b64_tr_b16 a[170:171], v223 offset:2560
    ds_read_b64_tr_b16 a[172:173], v223 offset:2112
    ds_read_b64_tr_b16 a[174:175], v223 offset:2624
    ds_read_b64_tr_b16 a[176:177], v223 offset:4096
    ds_read_b64_tr_b16 a[178:179], v223 offset:4608
    ds_read_b64_tr_b16 a[180:181], v223 offset:4160
    ds_read_b64_tr_b16 a[182:183], v223 offset:4672
    ds_read_b64_tr_b16 a[184:185], v223 offset:6144
    ds_read_b64_tr_b16 a[186:187], v223 offset:6656
    ds_read_b64_tr_b16 a[188:189], v223 offset:6208
    ds_read_b64_tr_b16 a[190:191], v223 offset:6720
    s_waitcnt lgkmcnt(0)
    s_add_u32 m0, s24, 0
    s_nop 0
    buffer_load_dwordx4 v220, s[84:87], s76 offen lds
    s_add_u32 s76, s76, 8192
    s_add_u32 m0, s24, 1024
    s_nop 0
    buffer_load_dwordx4 v220, s[84:87], s76 offen lds
    s_add_u32 s76, s76, 8192
    s_add_u32 m0, s24, 2048
    s_nop 0
    buffer_load_dwordx4 v220, s[84:87], s76 offen lds
    s_add_u32 s76, s76, 8192
    s_add_u32 m0, s24, 3072
    s_nop 0
    buffer_load_dwordx4 v220, s[84:87], s76 offen lds
    s_add_u32 s76, s76, 8192
    s_add_u32 m0, s24, 4096
    s_nop 0
    buffer_load_dwordx4 v220, s[84:87], s76 offen lds
    s_add_u32 s76, s76, 8192
    s_add_u32 m0, s24, 5120
    s_nop 0
    buffer_load_dwordx4 v220, s[84:87], s76 offen lds
    s_add_u32 s76, s76, 8192
    s_add_u32 m0, s24, 6144
    s_nop 0
    buffer_load_dwordx4 v220, s[84:87], s76 offen lds
    s_add_u32 s76, s76, 8192
    s_add_u32 m0, s24, 7168
    s_nop 0
    buffer_load_dwordx4 v220, s[84:87], s76 offen lds
    s_add_u32 s76, s76, 8192
    s_waitcnt vmcnt(0)
    ds_read_b64_tr_b16 a[192:193], v223 offset:0
    ds_read_b64_tr_b16 a[194:195], v223 offset:512
    ds_read_b64_tr_b16 a[196:197], v223 offset:64
    ds_read_b64_tr_b16 a[198:199], v223 offset:576
    ds_read_b64_tr_b16 a[200:201], v223 offset:2048
    ds_read_b64_tr_b16 a[202:203], v223 offset:2560
    ds_read_b64_tr_b16 a[204:205], v223 offset:2112
    ds_read_b64_tr_b16 a[206:207], v223 offset:2624
    ds_read_b64_tr_b16 a[208:209], v223 offset:4096
    ds_read_b64_tr_b16 a[210:211], v223 offset:4608
    ds_read_b64_tr_b16 a[212:213], v223 offset:4160
    ds_read_b64_tr_b16 a[214:215], v223 offset:4672
    ds_read_b64_tr_b16 a[216:217], v223 offset:6144
    ds_read_b64_tr_b16 a[218:219], v223 offset:6656
    ds_read_b64_tr_b16 a[220:221], v223 offset:6208
    ds_read_b64_tr_b16 a[222:223], v223 offset:6720
    v_cmp_gt_u32 vcc, 2, v14
    s_cbranch_vccnz FWAIT_38
FOK_37:
    s_add_u32 s26, s2, s18
    s_cmp_lg_u32 s26, 0
    s_cbranch_scc1 NOEP_39
    v_mov_b32 v254, s48
    s_mov_b32 s26, 0x80f000
    buffer_store_dwordx2 v[254:255], v9, s[52:55], s26 offen sc0 sc1
NOEP_39:
    s_add_u32 s30, s46, 0
    buffer_load_dwordx4 v[128:131], v3, s[52:55], s30 offen offset:0 sc1
    buffer_load_dwordx4 v[132:135], v3, s[52:55], s30 offen offset:1024 sc1
    buffer_load_dwordx4 v[136:139], v3, s[52:55], s30 offen offset:2048 sc1
    buffer_load_dwordx4 v[140:143], v3, s[52:55], s30 offen offset:3072 sc1
    ds_read_b128 v[16:19], v3 offset:0
    ds_read_b128 v[20:23], v3 offset:1024
    ds_read_b128 v[24:27], v3 offset:2048
    ds_read_b128 v[28:31], v3 offset:3072
    ds_read_b128 v[32:35], v3 offset:4096
    ds_read_b128 v[36:39], v3 offset:5120
    ds_read_b128 v[40:43], v3 offset:6144
    ds_read_b128 v[44:47], v3 offset:7168
    ds_read_b128 v[48:51], v3 offset:8192
    ds_read_b128 v[52:55], v3 offset:9216
    ds_read_b128 v[56:59], v3 offset:10240
    s_waitcnt vmcnt(3) lgkmcnt(7)
    v_mfma_f32_16x16x32_bf16 v[72:75], v[16:19], v[128:131], 0
    ds_read_b128 v[60:63], v3 offset:11264
    v_mfma_f32_16x16x32_bf16 v[76:79], v[20:23], v[128:131], 0
    ds_read_b128 v[16:19], v3 offset:12288
    s_add_u32 s30, s46, 4096
    buffer_load_dwordx4 v[144:147], v3, s[52:55], s30 offen offset:0 sc1
    v_mfma_f32_16x16x32_bf16 v[80:83], v[24:27], v[128:131], 0
    ds_read_b128 v[20:23], v3 offset:13312
    v_mfma_f32_16x16x32_bf16 v[84:87], v[28:31], v[128:131], 0
    ds_read_b128 v[24:27], v3 offset:14336
    s_waitcnt lgkmcnt(7)
    v_mfma_f32_16x16x32_bf16 v[88:91], v[32:35], v[128:131], 0
    ds_read_b128 v[28:31], v3 offset:15360
    buffer_load_dwordx4 v[148:151], v3, s[52:55], s30 offen offset:1024 sc1
    v_mfma_f32_16x16x32_bf16 v[92:95], v[36:39], v[128:131], 0
    ds_read_b128 v[32:35], v3 offset:16384
    v_mfma_f32_16x16x32_bf16 v[96:99], v[40:43], v[128:131], 0
    ds_read_b128 v[36:39], v3 offset:17408
    s_waitcnt vmcnt(4)
    v_mfma_f32_16x16x32_bf16 v[72:75], v[44:47], v[132:135], v[72:75]
    ds_read_b128 v[40:43], v3 offset:18432
    s_waitcnt lgkmcnt(7)
    v_mfma_f32_16x16x32_bf16 v[76:79], v[48:51], v[132:135], v[76:79]
    ds_read_b128 v[44:47], v3 offset:19456
    buffer_load_dwordx4 v[152:155], v3, s[52:55], s30 offen offset:2048 sc1
    v_mfma_f32_16x16x32_bf16 v[80:83], v[52:55], v[132:135], v[80:83]
    ds_read_b128 v[48:51], v3 offset:20480
    v_mfma_f32_16x16x32_bf16 v[84:87], v[56:59], v[132:135], v[84:87]
    ds_read_b128 v[52:55], v3 offset:21504
    v_mfma_f32_16x16x32_bf16 v[88:91], v[60:63], v[132:135], v[88:91]
    ds_read_b128 v[56:59], v3 offset:22528
    s_waitcnt lgkmcnt(7)
    v_mfma_f32_16x16x32_bf16 v[92:95], v[16:19], v[132:135], v[92:95]
    ds_read_b128 v[60:63], v3 offset:23552
    buffer_load_dwordx4 v[156:159], v3, s[52:55], s30 offen offset:3072 sc1
    v_mfma_f32_16x16x32_bf16 v[96:99], v[20:23], v[132:135], v[96:99]
    ds_read_b128 v[16:19], v3 offset:24576
    s_waitcnt vmcnt(5)
    v_mfma_f32_16x16x32_bf16 v[72:75], v[24:27], v[136:139], v[72:75]
    ds_read_b128 v[20:23], v3 offset:25600
    v_mfma_f32_16x16x32_bf16 v[76:79], v[28:31], v[136:139], v[76:79]
    ds_read_b128 v[24:27], v3 offset:26624
    s_waitcnt lgkmcnt(7)
    v_mfma_f32_16x16x32_bf16 v[80:83], v[32:35], v[136:139], v[80:83]
    ds_read_b128 v[28:31], v3 offset:27648
    s_add_u32 s30, s46, 8192
    buffer_load_dwordx4 v[160:163], v3, s[52:55], s30 offen offset:0 sc1
    v_mfma_f32_16x16x32_bf16 v[84:87], v[36:39], v[136:139], v[84:87]
    ds_read_b128 v[32:35], v3 offset:28672
    v_mfma_f32_16x16x32_bf16 v[88:91], v[40:43], v[136:139], v[88:91]
    ds_read_b128 v[36:39], v3 offset:29696
    v_mfma_f32_16x16x32_bf16 v[92:95], v[44:47], v[136:139], v[92:95]
    ds_read_b128 v[40:43], v3 offset:30720
    s_waitcnt lgkmcnt(7)
    v_mfma_f32_16x16x32_bf16 v[96:99], v[48:51], v[136:139], v[96:99]
    ds_read_b128 v[44:47], v3 offset:31744
    buffer_load_dwordx4 v[164:167], v3, s[52:55], s30 offen offset:1024 sc1
    s_waitcnt vmcnt(6)
    v_mfma_f32_16x16x32_bf16 v[72:75], v[52:55], v[140:143], v[72:75]
    ds_read_b128 v[48:51], v3 offset:32768
    v_mfma_f32_16x16x32_bf16 v[76:79], v[56:59], v[140:143], v[76:79]
    ds_read_b128 v[52:55], v3 offset:33792
    v_mfma_f32_16x16x32_bf16 v[80:83], v[60:63], v[140:143], v[80:83]
    ds_read_b128 v[56:59], v3 offset:34816
    s_waitcnt lgkmcnt(7)
    v_mfma_f32_16x16x32_bf16 v[84:87], v[16:19], v[140:143], v[84:87]
    ds_read_b128 v[60:63], v3 offset:35840
    buffer_load_dwordx4 v[168:171], v3, s[52:55], s30 offen offset:2048 sc1
    v_mfma_f32_16x16x32_bf16 v[88:91], v[20:23], v[140:143], v[88:91]
    ds_read_b128 v[16:19], v3 offset:36864
    buffer_load_dwordx4 v[68:71], v4, s[52:55], s8 offen offset:0 sc1
    v_mfma_f32_16x16x32_bf16 v[92:95], v[24:27], v[140:143], v[92:95]
    ds_read_b128 v[20:23], v3 offset:37888
    v_mfma_f32_16x16x32_bf16 v[96:99], v[28:31], v[140:143], v[96:99]
    ds_read_b128 v[24:27], v3 offset:38912
    s_waitcnt vmcnt(7) lgkmcnt(7)
    v_mfma_f32_16x16x32_bf16 v[72:75], v[32:35], v[144:147], v[72:75]
    ds_read_b128 v[28:31], v3 offset:39936
    buffer_load_dwordx4 v[172:175], v3, s[52:55], s30 offen offset:3072 sc1
    v_mfma_f32_16x16x32_bf16 v[76:79], v[36:39], v[144:147], v[76:79]
    ds_read_b128 v[32:35], v3 offset:40960
    v_mfma_f32_16x16x32_bf16 v[80:83], v[40:43], v[144:147], v[80:83]
    ds_read_b128 v[36:39], v3 offset:41984
    v_mfma_f32_16x16x32_bf16 v[84:87], v[44:47], v[144:147], v[84:87]
    ds_read_b128 v[40:43], v3 offset:43008
    s_waitcnt lgkmcnt(7)
    v_mfma_f32_16x16x32_bf16 v[88:91], v[48:51], v[144:147], v[88:91]
    ds_read_b128 v[44:47], v3 offset:44032
    s_add_u32 s30, s46, 12288
    buffer_load_dwordx4 v[176:179], v3, s[52:55], s30 offen offset:0 sc1
    v_mfma_f32_16x16x32_bf16 v[92:95], v[52:55], v[144:147], v[92:95]
    ds_read_b128 v[48:51], v3 offset:45056
    v_mfma_f32_16x16x32_bf16 v[96:99], v[56:59], v[144:147], v[96:99]
    ds_read_b128 v[52:55], v3 offset:46080
    s_waitcnt vmcnt(8)
    v_mfma_f32_16x16x32_bf16 v[72:75], v[60:63], v[148:151], v[72:75]
    ds_read_b128 v[56:59], v3 offset:47104
    s_waitcnt lgkmcnt(7)
    v_mfma_f32_16x16x32_bf16 v[76:79], v[16:19], v[148:151], v[76:79]
    ds_read_b128 v[60:63], v3 offset:48128
    buffer_load_dwordx4 v[180:183], v3, s[52:55], s30 offen offset:1024 sc1
    v_mfma_f32_16x16x32_bf16 v[80:83], v[20:23], v[148:151], v[80:83]
    ds_read_b128 v[16:19], v3 offset:49152
    v_mfma_f32_16x16x32_bf16 v[84:87], v[24:27], v[148:151], v[84:87]
    ds_read_b128 v[20:23], v3 offset:50176
    v_mfma_f32_16x16x32_bf16 v[88:91], v[28:31], v[148:151], v[88:91]
    ds_read_b128 v[24:27], v3 offset:51200
    s_waitcnt lgkmcnt(7)
    v_mfma_f32_16x16x32_bf16 v[92:95], v[32:35], v[148:151], v[92:95]
    ds_read_b128 v[28:31], v3 offset:52224
    buffer_load_dwordx4 v[184:187], v3, s[52:55], s30 offen offset:2048 sc1
    v_mfma_f32_16x16x32_bf16 v[96:99], v[36:39], v[148:151], v[96:99]
    ds_read_b128 v[32:35], v3 offset:53248
    s_waitcnt vmcnt(9)
    v_mfma_f32_16x16x32_bf16 v[72:75], v[40:43], v[152:155], v[72:75]
    ds_read_b128 v[36:39], v3 offset:54272
    v_mfma_f32_16x16x32_bf16 v[76:79], v[44:47], v[152:155], v[76:79]
    ds_read_b128 v[40:43], v3 offset:55296
    buffer_load_dwordx4 v[188:191], v3, s[52:55], s30 offen offset:3072 sc1
    s_waitcnt lgkmcnt(7)
    v_mfma_f32_16x16x32_bf16 v[80:83], v[48:51], v[152:155], v[80:83]
    ds_read_b128 v[44:47], v3 offset:56320
    v_mfma_f32_16x16x32_bf16 v[84:87], v[52:55], v[152:155], v[84:87]
    ds_read_b128 v[48:51], v6 offset:0
    v_mfma_f32_16x16x32_bf16 v[88:91], v[56:59], v[152:155], v[88:91]
    ds_read_b128 v[52:55], v6 offset:1024
    v_mfma_f32_16x16x32_bf16 v[92:95], v[60:63], v[152:155], v[92:95]
    ds_read_b128 v[56:59], v6 offset:2048
    s_add_u32 s31, s46, 16384
    buffer_load_dwordx4 v[192:195], v3, s[52:55], s31 offen offset:0 sc1
    s_waitcnt lgkmcnt(7)
    v_mfma_f32_16x16x32_bf16 v[96:99], v[16:19], v[152:155], v[96:99]
    ds_read_b128 v[60:63], v6 offset:3072
    s_waitcnt vmcnt(10)
    v_mfma_f32_16x16x32_bf16 v[72:75], v[20:23], v[156:159], v[72:75]
    ds_read_b128 v[16:19], v6 offset:4096
    v_mfma_f32_16x16x32_bf16 v[76:79], v[24:27], v[156:159], v[76:79]
    ds_read_b128 v[20:23], v6 offset:5120
    v_mfma_f32_16x16x32_bf16 v[80:83], v[28:31], v[156:159], v[80:83]
    ds_read_b128 v[24:27], v6 offset:6144
    buffer_load_dwordx4 v[196:199], v3, s[52:55], s31 offen offset:1024 sc1
    s_waitcnt lgkmcnt(7)
    v_mfma_f32_16x16x32_bf16 v[84:87], v[32:35], v[156:159], v[84:87]
    ds_read_b128 v[28:31], v6 offset:7168
    v_mfma_f32_16x16x32_bf16 v[88:91], v[36:39], v[156:159], v[88:91]
    ds_read_b128 v[32:35], v6 offset:8192
    v_mfma_f32_16x16x32_bf16 v[92:95], v[40:43], v[156:159], v[92:95]
    ds_read_b128 v[36:39], v6 offset:9216
    v_mfma_f32_16x16x32_bf16 v[96:99], v[44:47], v[156:159], v[96:99]
    ds_read_b128 v[40:43], v6 offset:10240
    buffer_load_dwordx4 v[200:203], v3, s[52:55], s31 offen offset:2048 sc1
    s_waitcnt vmcnt(11) lgkmcnt(7)
    v_mfma_f32_16x16x32_bf16 v[72:75], v[48:51], v[160:163], v[72:75]
    ds_read_b128 v[44:47], v6 offset:11264
    v_mfma_f32_16x16x32_bf16 v[76:79], v[52:55], v[160:163], v[76:79]
    ds_read_b128 v[48:51], v6 offset:12288
    v_mfma_f32_16x16x32_bf16 v[80:83], v[56:59], v[160:163], v[80:83]
    ds_read_b128 v[52:55], v6 offset:13312
    v_mfma_f32_16x16x32_bf16 v[84:87], v[60:63], v[160:163], v[84:87]
    ds_read_b128 v[56:59], v6 offset:14336
    buffer_load_dwordx4 v[204:207], v3, s[52:55], s31 offen offset:3072 sc1
    s_waitcnt lgkmcnt(7)
    v_mfma_f32_16x16x32_bf16 v[88:91], v[16:19], v[160:163], v[88:91]
    ds_read_b128 v[60:63], v6 offset:15360
    v_mfma_f32_16x16x32_bf16 v[92:95], v[20:23], v[160:163], v[92:95]
    ds_read_b128 v[16:19], v6 offset:16384
    v_mfma_f32_16x16x32_bf16 v[96:99], v[24:27], v[160:163], v[96:99]
    ds_read_b128 v[20:23], v6 offset:17408
    s_waitcnt vmcnt(11)
    v_mfma_f32_16x16x32_bf16 v[72:75], v[28:31], v[164:167], v[72:75]
    ds_read_b128 v[24:27], v6 offset:18432
    s_add_u32 s31, s46, 20480
    buffer_load_dwordx4 v[208:211], v3, s[52:55], s31 offen offset:0 sc1
    s_waitcnt lgkmcnt(7)
    v_mfma_f32_16x16x32_bf16 v[76:79], v[32:35], v[164:167], v[76:79]
    ds_read_b128 v[28:31], v6 offset:19456
    s_waitcnt vmcnt(10)
    v_or_b32 v64, v69, v71
    v_cmp_gt_i32 vcc, 0, v64
    s_cbranch_vccnz SWAIT_41
SOK_40:
    v_mfma_f32_16x16x32_bf16 v[80:83], v[36:39], v[164:167], v[80:83]
    ds_read_b128 v[32:35], v6 offset:20480
    v_add_f32 v68, v68, v70
    v_mfma_f32_16x16x32_bf16 v[84:87], v[40:43], v[164:167], v[84:87]
    ds_read_b128 v[36:39], v6 offset:21504
    v_add_f32 v69, v69, v71
    v_mfma_f32_16x16x32_bf16 v[88:91], v[44:47], v[164:167], v[88:91]
    ds_read_b128 v[40:43], v6 offset:22528
    buffer_load_dwordx4 v[212:215], v3, s[52:55], s31 offen offset:1024 sc1
    s_waitcnt lgkmcnt(7)
    v_mfma_f32_16x16x32_bf16 v[92:95], v[48:51], v[164:167], v[92:95]
    ds_read_b128 v[44:47], v6 offset:23552
    v_mov_b32 v70, v68
    v_mfma_f32_16x16x32_bf16 v[96:99], v[52:55], v[164:167], v[96:99]
    ds_read_b128 v[48:51], v6 offset:24576
    v_mfma_f32_16x16x32_bf16 v[72:75], v[56:59], v[168:171], v[72:75]
    ds_read_b128 v[52:55], v6 offset:25600
    v_mov_b32 v71, v69
    v_mfma_f32_16x16x32_bf16 v[76:79], v[60:63], v[168:171], v[76:79]
    ds_read_b128 v[56:59], v6 offset:26624
    buffer_load_dwordx4 v[216:219], v3, s[52:55], s31 offen offset:2048 sc1
    s_waitcnt lgkmcnt(7)
    v_mfma_f32_16x16x32_bf16 v[80:83], v[16:19], v[168:171], v[80:83]
    ds_read_b128 v[60:63], v6 offset:27648
    s_nop 0
    v_mfma_f32_16x16x32_bf16 v[84:87], v[20:23], v[168:171], v[84:87]
    ds_read_b128 v[16:19], v6 offset:28672
    v_permlane16_swap_b32 v68, v70
    v_mfma_f32_16x16x32_bf16 v[88:91], v[24:27], v[168:171], v[88:91]
    ds_read_b128 v[20:23], v6 offset:29696
    v_permlane16_swap_b32 v69, v71
    v_mfma_f32_16x16x32_bf16 v[92:95], v[28:31], v[168:171], v[92:95]
    ds_read_b128 v[24:27], v6 offset:30720
    buffer_load_dwordx4 v[220:223], v3, s[52:55], s31 offen offset:3072 sc1
    s_waitcnt lgkmcnt(7)
    v_mfma_f32_16x16x32_bf16 v[96:99], v[32:35], v[168:171], v[96:99]
    ds_read_b128 v[28:31], v6 offset:31744
    s_waitcnt vmcnt(12)
    v_mfma_f32_16x16x32_bf16 v[72:75], v[36:39], v[172:175], v[72:75]
    ds_read_b128 v[32:35], v6 offset:32768
    s_nop 0
    v_mfma_f32_16x16x32_bf16 v[76:79], v[40:43], v[172:175], v[76:79]
    ds_read_b128 v[36:39], v6 offset:33792
    v_add_f32 v68, v68, v70
    v_mfma_f32_16x16x32_bf16 v[80:83], v[44:47], v[172:175], v[80:83]
    ds_read_b128 v[40:43], v6 offset:34816
    s_add_u32 s31, s46, 24576
    buffer_load_dwordx4 v[224:227], v3, s[52:55], s31 offen offset:0 sc1
    s_waitcnt lgkmcnt(7)
    v_mfma_f32_16x16x32_bf16 v[84:87], v[48:51], v[172:175], v[84:87]
    ds_read_b128 v[44:47], v6 offset:35840
    v_add_f32 v69, v69, v71
    v_mfma_f32_16x16x32_bf16 v[88:91], v[52:55], v[172:175], v[88:91]
    ds_read_b128 v[48:51], v6 offset:36864
    v_mov_b32 v70, v68
    v_mfma_f32_16x16x32_bf16 v[92:95], v[56:59], v[172:175], v[92:95]
    ds_read_b128 v[52:55], v6 offset:37888
    buffer_load_dwordx4 v[228:231], v3, s[52:55], s31 offen offset:1024 sc1
    v_mfma_f32_16x16x32_bf16 v[96:99], v[60:63], v[172:175], v[96:99]
    ds_read_b128 v[56:59], v6 offset:38912
    s_waitcnt vmcnt(13) lgkmcnt(7)
    v_mfma_f32_16x16x32_bf16 v[72:75], v[16:19], v[176:179], v[72:75]
    ds_read_b128 v[60:63], v6 offset:39936
    v_mov_b32 v71, v69
    v_mfma_f32_16x16x32_bf16 v[76:79], v[20:23], v[176:179], v[76:79]
    ds_read_b128 v[16:19], v6 offset:40960
    s_nop 0
    v_mfma_f32_16x16x32_bf16 v[80:83], v[24:27], v[176:179], v[80:83]
    ds_read_b128 v[20:23], v6 offset:41984
    buffer_load_dwordx4 v[232:235], v3, s[52:55], s31 offen offset:2048 sc1
    v_mfma_f32_16x16x32_bf16 v[84:87], v[28:31], v[176:179], v[84:87]
    ds_read_b128 v[24:27], v6 offset:43008
    s_waitcnt lgkmcnt(7)
    v_mfma_f32_16x16x32_bf16 v[88:91], v[32:35], v[176:179], v[88:91]
    ds_read_b128 v[28:31], v6 offset:44032
    v_permlane32_swap_b32 v68, v70
    v_mfma_f32_16x16x32_bf16 v[92:95], v[36:39], v[176:179], v[92:95]
    ds_read_b128 v[32:35], v6 offset:45056
    v_permlane32_swap_b32 v69, v71
    v_mfma_f32_16x16x32_bf16 v[96:99], v[40:43], v[176:179], v[96:99]
    ds_read_b128 v[36:39], v6 offset:46080
    buffer_load_dwordx4 v[236:239], v3, s[52:55], s31 offen offset:3072 sc1
    s_waitcnt vmcnt(14)
    v_mfma_f32_16x16x32_bf16 v[72:75], v[44:47], v[180:183], v[72:75]
    ds_read_b128 v[40:43], v6 offset:47104
    s_waitcnt lgkmcnt(7)
    v_mfma_f32_16x16x32_bf16 v[76:79], v[48:51], v[180:183], v[76:79]
    ds_read_b128 v[44:47], v6 offset:48128
    s_nop 0
    v_mfma_f32_16x16x32_bf16 v[80:83], v[52:55], v[180:183], v[80:83]
    ds_read_b128 v[48:51], v6 offset:49152
    v_add_f32 v68, v68, v70
    v_mfma_f32_16x16x32_bf16 v[84:87], v[56:59], v[180:183], v[84:87]
    ds_read_b128 v[52:55], v6 offset:50176
    s_add_u32 s31, s46, 28672
    buffer_load_dwordx4 v[240:243], v3, s[52:55], s31 offen offset:0 sc1
    v_mfma_f32_16x16x32_bf16 v[88:91], v[60:63], v[180:183], v[88:91]
    ds_read_b128 v[56:59], v6 offset:51200
    s_waitcnt lgkmcnt(7)
    v_mfma_f32_16x16x32_bf16 v[92:95], v[16:19], v[180:183], v[92:95]
    ds_read_b128 v[60:63], v6 offset:52224
    v_add_f32 v69, v69, v71
    v_mfma_f32_16x16x32_bf16 v[96:99], v[20:23], v[180:183], v[96:99]
    ds_read_b128 v[16:19], v6 offset:53248
    s_waitcnt vmcnt(14)
    v_mfma_f32_16x16x32_bf16 v[72:75], v[24:27], v[184:187], v[72:75]
    ds_read_b128 v[20:23], v6 offset:54272
    buffer_load_dwordx4 v[244:247], v3, s[52:55], s31 offen offset:1024 sc1
    v_mfma_f32_16x16x32_bf16 v[76:79], v[28:31], v[184:187], v[76:79]
    ds_read_b128 v[24:27], v6 offset:55296
    s_waitcnt lgkmcnt(7)
    v_mfma_f32_16x16x32_bf16 v[80:83], v[32:35], v[184:187], v[80:83]
    ds_read_b128 v[28:31], v6 offset:56320
    v_mul_f32 v68, 0x3b000000, v68
    v_mfma_f32_16x16x32_bf16 v[84:87], v[36:39], v[184:187], v[84:87]
    ds_read_b128 v[32:35], v3 offset:0
    v_mul_f32 v69, 0x3b000000, v69
    v_mfma_f32_16x16x32_bf16 v[88:91], v[40:43], v[184:187], v[88:91]
    ds_read_b128 v[36:39], v3 offset:1024
    buffer_load_dwordx4 v[248:251], v3, s[52:55], s31 offen offset:2048 sc1
    v_mfma_f32_16x16x32_bf16 v[92:95], v[44:47], v[184:187], v[92:95]
    ds_read_b128 v[40:43], v3 offset:2048
    s_waitcnt lgkmcnt(7)
    v_mfma_f32_16x16x32_bf16 v[96:99], v[48:51], v[184:187], v[96:99]
    ds_read_b128 v[44:47], v3 offset:3072
    s_waitcnt vmcnt(15)
    v_mfma_f32_16x16x32_bf16 v[72:75], v[52:55], v[188:191], v[72:75]
    ds_read_b128 v[48:51], v3 offset:4096
    v_fma_f32 v69, -v68, v68, v69
    v_mfma_f32_16x16x32_bf16 v[76:79], v[56:59], v[188:191], v[76:79]
    ds_read_b128 v[52:55], v3 offset:5120
    buffer_load_dwordx4 v[252:255], v3, s[52:55], s31 offen offset:3072 sc1
    v_mfma_f32_16x16x32_bf16 v[80:83], v[60:63], v[188:191], v[80:83]
    ds_read_b128 v[56:59], v3 offset:6144
    s_waitcnt lgkmcnt(7)
    v_mfma_f32_16x16x32_bf16 v[84:87], v[16:19], v[188:191], v[84:87]
    ds_read_b128 v[60:63], v3 offset:7168
    v_max_f32 v69, 0, v69
    v_mfma_f32_16x16x32_bf16 v[88:91], v[20:23], v[188:191], v[88:91]
    ds_read_b128 v[16:19], v3 offset:8192
    v_cvt_pk_bf16_f32 v71, v68, v69
    v_mfma_f32_16x16x32_bf16 v[92:95], v[24:27], v[188:191], v[92:95]
    ds_read_b128 v[20:23], v3 offset:9216
    v_lshlrev_b32 v68, 16, v71
    v_mfma_f32_16x16x32_bf16 v[96:99], v[28:31], v[188:191], v[96:99]
    ds_read_b128 v[24:27], v3 offset:10240
    v_and_b32 v69, 0xffff0000, v71
    v_add_f32 v69, 0x3727c5ac, v69
    v_cvt_pk_bf16_f32 v71, v69, v69
    v_lshlrev_b32 v69, 16, v71
    v_sqrt_f32 v69, v69
    s_nop 0
    v_cvt_pk_bf16_f32 v71, v69, v69
    v_lshlrev_b32 v70, 16, v71
    v_rcp_f32 v69, v70
    s_nop 0
    v_cvt_pk_bf16_f32 v64, -v68, -v68
    v_cvt_pk_bf16_f32 v65, -v68, v70
    v_mul_f32 v69, v69, v69
    v_cndmask_b32 v64, 0, v64, s[34:35]
    v_cndmask_b32 v65, 0, v65, s[34:35]
    buffer_store_dword v69, v8, s[52:55], s13 offen offset:0 sc0 sc1
    buffer_load_dwordx4 v[68:71], v4, s[52:55], s8 offen offset:1024 sc1
    v_lshrrev_b32 v13, 2, v3
    v_and_b32 v13, 28, v13
    s_nop 1
    v_mfma_f32_16x16x16_bf16 v[72:75], a[240:241], v[64:65], v[72:75]
    v_mfma_f32_16x16x16_bf16 v[76:79], a[242:243], v[64:65], v[76:79]
    v_mfma_f32_16x16x16_bf16 v[80:83], a[244:245], v[64:65], v[80:83]
    v_mfma_f32_16x16x16_bf16 v[84:87], a[246:247], v[64:65], v[84:87]
    v_mfma_f32_16x16x16_bf16 v[88:91], a[248:249], v[64:65], v[88:91]
    v_mfma_f32_16x16x16_bf16 v[92:95], a[250:251], v[64:65], v[92:95]
    v_mfma_f32_16x16x16_bf16 v[96:99], a[252:253], v[64:65], v[96:99]
    s_waitcnt vmcnt(17) lgkmcnt(7)
    v_mfma_f32_16x16x32_bf16 v[100:103], v[32:35], v[192:195], 0
    ds_read_b128 v[28:31], v3 offset:11264
    v_mfma_f32_16x16x32_bf16 v[104:107], v[36:39], v[192:195], 0
    ds_read_b128 v[32:35], v3 offset:12288
    v_mfma_f32_16x16x32_bf16 v[108:111], v[40:43], v[192:195], 0
    ds_read_b128 v[36:39], v3 offset:13312
    v_mfma_f32_16x16x32_bf16 v[112:115], v[44:47], v[192:195], 0
    ds_read_b128 v[40:43], v3 offset:14336
    v_mul_f32 v72, v72, abs(v72)
    v_mul_f32 v73, v73, abs(v73)
    v_mul_f32 v74, v74, abs(v74)
    v_mul_f32 v75, v75, abs(v75)
    v_mul_f32 v76, v76, abs(v76)
    v_mul_f32 v77, v77, abs(v77)
    s_waitcnt lgkmcnt(7)
    v_mfma_f32_16x16x32_bf16 v[116:119], v[48:51], v[192:195], 0
    ds_read_b128 v[44:47], v3 offset:15360
    v_mul_f32 v78, v78, abs(v78)
    v_mul_f32 v79, v79, abs(v79)
    v_cvt_pk_bf16_f32 v72, v72, v73
    v_cvt_pk_bf16_f32 v73, v74, v75
    v_cvt_pk_bf16_f32 v74, v76, v77
    v_cvt_pk_bf16_f32 v75, v78, v79
    v_mfma_f32_16x16x32_bf16 v[120:123], v[52:55], v[192:195], 0
    ds_read_b128 v[48:51], v3 offset:16384
    v_pk_max_i16 v72, v72, 0
    v_pk_max_i16 v73, v73, 0
    v_pk_max_i16 v74, v74, 0
    v_pk_max_i16 v75, v75, 0
    buffer_store_dwordx4 v[72:75], v0, s[52:55], s10 offen offset:0 sc0 sc1
    v_mul_f32 v80, v80, abs(v80)
    v_mfma_f32_16x16x32_bf16 v[124:127], v[56:59], v[192:195], 0
    ds_read_b128 v[52:55], v3 offset:17408
    v_mul_f32 v81, v81, abs(v81)
    v_mul_f32 v82, v82, abs(v82)
    v_mul_f32 v83, v83, abs(v83)
    v_mul_f32 v84, v84, abs(v84)
    v_mul_f32 v85, v85, abs(v85)
    v_mul_f32 v86, v86, abs(v86)
    s_waitcnt vmcnt(17)
    v_mfma_f32_16x16x32_bf16 v[100:103], v[60:63], v[196:199], v[100:103]
    ds_read_b128 v[56:59], v3 offset:18432
    v_mul_f32 v87, v87, abs(v87)
    v_cvt_pk_bf16_f32 v80, v80, v81
    v_cvt_pk_bf16_f32 v81, v82, v83
    v_cvt_pk_bf16_f32 v82, v84, v85
    v_cvt_pk_bf16_f32 v83, v86, v87
    v_pk_max_i16 v80, v80, 0
    s_waitcnt lgkmcnt(7)
    v_mfma_f32_16x16x32_bf16 v[104:107], v[16:19], v[196:199], v[104:107]
    ds_read_b128 v[60:63], v3 offset:19456
    v_pk_max_i16 v81, v81, 0
    v_pk_max_i16 v82, v82, 0
    v_pk_max_i16 v83, v83, 0
    buffer_store_dwordx4 v[80:83], v0, s[52:55], s10 offen offset:2048 sc0 sc1
    v_mul_f32 v88, v88, abs(v88)
    v_mul_f32 v89, v89, abs(v89)
    v_mfma_f32_16x16x32_bf16 v[108:111], v[20:23], v[196:199], v[108:111]
    ds_read_b128 v[16:19], v3 offset:20480
    v_mul_f32 v90, v90, abs(v90)
    v_mul_f32 v91, v91, abs(v91)
    v_mul_f32 v92, v92, abs(v92)
    v_mul_f32 v93, v93, abs(v93)
    v_mul_f32 v94, v94, abs(v94)
    v_mul_f32 v95, v95, abs(v95)
    v_mfma_f32_16x16x32_bf16 v[112:115], v[24:27], v[196:199], v[112:115]
    ds_read_b128 v[20:23], v3 offset:21504
    v_cvt_pk_bf16_f32 v88, v88, v89
    v_cvt_pk_bf16_f32 v89, v90, v91
    v_cvt_pk_bf16_f32 v90, v92, v93
    v_cvt_pk_bf16_f32 v91, v94, v95
    v_pk_max_i16 v88, v88, 0
    v_pk_max_i16 v89, v89, 0
    v_mfma_f32_16x16x32_bf16 v[116:119], v[28:31], v[196:199], v[116:119]
    ds_read_b128 v[24:27], v3 offset:22528
    v_pk_max_i16 v90, v90, 0
    v_pk_max_i16 v91, v91, 0
    buffer_store_dwordx4 v[88:91], v0, s[52:55], s11 offen offset:0 sc0 sc1
    v_mul_f32 v96, v96, abs(v96)
    v_mul_f32 v97, v97, abs(v97)
    v_mul_f32 v98, v98, abs(v98)
    s_waitcnt lgkmcnt(7)
    v_mfma_f32_16x16x32_bf16 v[120:123], v[32:35], v[196:199], v[120:123]
    ds_read_b128 v[28:31], v3 offset:23552
    v_mul_f32 v99, v99, abs(v99)
    v_cvt_pk_bf16_f32 v96, v96, v97
    v_cvt_pk_bf16_f32 v97, v98, v99
    v_pk_max_i16 v96, v96, 0
    v_pk_max_i16 v97, v97, 0
    buffer_store_dwordx2 v[96:97], v1, s[52:55], s11 offen offset:2048 sc0 sc1
    v_mfma_f32_16x16x32_bf16 v[124:127], v[36:39], v[196:199], v[124:127]
    ds_read_b128 v[32:35], v3 offset:24576
    s_waitcnt vmcnt(4)
    v_or_b32 v66, v69, v71
    v_cmp_gt_i32 vcc, 0, v66
    s_cbranch_vccnz SWAIT_44
SOK_43:
    v_mfma_f32_16x16x32_bf16 v[100:103], v[40:43], v[200:203], v[100:103]
    ds_read_b128 v[36:39], v3 offset:25600
    v_add_f32 v68, v68, v70
    v_mfma_f32_16x16x32_bf16 v[104:107], v[44:47], v[200:203], v[104:107]
    ds_read_b128 v[40:43], v3 offset:26624
    v_add_f32 v69, v69, v71
    s_waitcnt lgkmcnt(7)
    v_mfma_f32_16x16x32_bf16 v[108:111], v[48:51], v[200:203], v[108:111]
    ds_read_b128 v[44:47], v3 offset:27648
    v_mov_b32 v70, v68
    v_mfma_f32_16x16x32_bf16 v[112:115], v[52:55], v[200:203], v[112:115]
    ds_read_b128 v[48:51], v3 offset:28672
    v_mov_b32 v71, v69
    v_mfma_f32_16x16x32_bf16 v[116:119], v[56:59], v[200:203], v[116:119]
    ds_read_b128 v[52:55], v3 offset:29696
    s_nop 0
    v_mfma_f32_16x16x32_bf16 v[120:123], v[60:63], v[200:203], v[120:123]
    ds_read_b128 v[56:59], v3 offset:30720
    v_permlane16_swap_b32 v68, v70
    s_waitcnt lgkmcnt(7)
    v_mfma_f32_16x16x32_bf16 v[124:127], v[16:19], v[200:203], v[124:127]
    ds_read_b128 v[60:63], v3 offset:31744
    v_permlane16_swap_b32 v69, v71
    v_mfma_f32_16x16x32_bf16 v[100:103], v[20:23], v[204:207], v[100:103]
    ds_read_b128 v[16:19], v3 offset:32768
    s_nop 0
    v_mfma_f32_16x16x32_bf16 v[104:107], v[24:27], v[204:207], v[104:107]
    ds_read_b128 v[20:23], v3 offset:33792
    v_add_f32 v68, v68, v70
    v_mfma_f32_16x16x32_bf16 v[108:111], v[28:31], v[204:207], v[108:111]
    ds_read_b128 v[24:27], v3 offset:34816
    v_add_f32 v69, v69, v71
    s_waitcnt lgkmcnt(7)
    v_mfma_f32_16x16x32_bf16 v[112:115], v[32:35], v[204:207], v[112:115]
    ds_read_b128 v[28:31], v3 offset:35840
    v_mov_b32 v70, v68
    v_mfma_f32_16x16x32_bf16 v[116:119], v[36:39], v[204:207], v[116:119]
    ds_read_b128 v[32:35], v3 offset:36864
    v_mov_b32 v71, v69
    v_mfma_f32_16x16x32_bf16 v[120:123], v[40:43], v[204:207], v[120:123]
    ds_read_b128 v[36:39], v3 offset:37888
    s_nop 0
    v_mfma_f32_16x16x32_bf16 v[124:127], v[44:47], v[204:207], v[124:127]
    ds_read_b128 v[40:43], v3 offset:38912
    v_permlane32_swap_b32 v68, v70
    s_waitcnt lgkmcnt(7)
    v_mfma_f32_16x16x32_bf16 v[100:103], v[48:51], v[208:211], v[100:103]
    ds_read_b128 v[44:47], v3 offset:39936
    v_permlane32_swap_b32 v69, v71
    v_mfma_f32_16x16x32_bf16 v[104:107], v[52:55], v[208:211], v[104:107]
    ds_read_b128 v[48:51], v3 offset:40960
    s_nop 0
    v_mfma_f32_16x16x32_bf16 v[108:111], v[56:59], v[208:211], v[108:111]
    ds_read_b128 v[52:55], v3 offset:41984
    v_add_f32 v68, v68, v70
    v_mfma_f32_16x16x32_bf16 v[112:115], v[60:63], v[208:211], v[112:115]
    ds_read_b128 v[56:59], v3 offset:43008
    v_add_f32 v69, v69, v71
    s_waitcnt lgkmcnt(7)
    v_mfma_f32_16x16x32_bf16 v[116:119], v[16:19], v[208:211], v[116:119]
    ds_read_b128 v[60:63], v3 offset:44032
    v_mul_f32 v68, 0x3b000000, v68
    v_mfma_f32_16x16x32_bf16 v[120:123], v[20:23], v[208:211], v[120:123]
    ds_read_b128 v[16:19], v3 offset:45056
    v_mul_f32 v69, 0x3b000000, v69
    v_mfma_f32_16x16x32_bf16 v[124:127], v[24:27], v[208:211], v[124:127]
    ds_read_b128 v[20:23], v3 offset:46080
    v_fma_f32 v69, -v68, v68, v69
    v_mfma_f32_16x16x32_bf16 v[100:103], v[28:31], v[212:215], v[100:103]
    ds_read_b128 v[24:27], v3 offset:47104
    v_max_f32 v69, 0, v69
    s_waitcnt lgkmcnt(7)
    v_mfma_f32_16x16x32_bf16 v[104:107], v[32:35], v[212:215], v[104:107]
    ds_read_b128 v[28:31], v3 offset:48128
    v_cvt_pk_bf16_f32 v71, v68, v69
    v_mfma_f32_16x16x32_bf16 v[108:111], v[36:39], v[212:215], v[108:111]
    ds_read_b128 v[32:35], v3 offset:49152
    v_lshlrev_b32 v68, 16, v71
    v_mfma_f32_16x16x32_bf16 v[112:115], v[40:43], v[212:215], v[112:115]
    ds_read_b128 v[36:39], v3 offset:50176
    v_and_b32 v69, 0xffff0000, v71
    v_mfma_f32_16x16x32_bf16 v[116:119], v[44:47], v[212:215], v[116:119]
    ds_read_b128 v[40:43], v3 offset:51200
    v_add_f32 v69, 0x3727c5ac, v69
    s_waitcnt lgkmcnt(7)
    v_mfma_f32_16x16x32_bf16 v[120:123], v[48:51], v[212:215], v[120:123]
    ds_read_b128 v[44:47], v3 offset:52224
    v_cvt_pk_bf16_f32 v71, v69, v69
    v_mfma_f32_16x16x32_bf16 v[124:127], v[52:55], v[212:215], v[124:127]
    ds_read_b128 v[48:51], v3 offset:53248
    v_lshlrev_b32 v69, 16, v71
    v_mfma_f32_16x16x32_bf16 v[100:103], v[56:59], v[216:219], v[100:103]
    ds_read_b128 v[52:55], v3 offset:54272
    v_sqrt_f32 v69, v69
    v_mfma_f32_16x16x32_bf16 v[104:107], v[60:63], v[216:219], v[104:107]
    ds_read_b128 v[56:59], v3 offset:55296
    s_nop 0
    s_waitcnt lgkmcnt(7)
    v_mfma_f32_16x16x32_bf16 v[108:111], v[16:19], v[216:219], v[108:111]
    ds_read_b128 v[60:63], v3 offset:56320
    v_cvt_pk_bf16_f32 v71, v69, v69
    v_mfma_f32_16x16x32_bf16 v[112:115], v[20:23], v[216:219], v[112:115]
    ds_read_b128 v[16:19], v6 offset:0
    v_lshlrev_b32 v70, 16, v71
    v_mfma_f32_16x16x32_bf16 v[116:119], v[24:27], v[216:219], v[116:119]
    ds_read_b128 v[20:23], v6 offset:1024
    v_rcp_f32 v69, v70
    v_mfma_f32_16x16x32_bf16 v[120:123], v[28:31], v[216:219], v[120:123]
    ds_read_b128 v[24:27], v6 offset:2048
    s_nop 0
    s_waitcnt lgkmcnt(7)
    v_mfma_f32_16x16x32_bf16 v[124:127], v[32:35], v[216:219], v[124:127]
    ds_read_b128 v[28:31], v6 offset:3072
    v_cvt_pk_bf16_f32 v66, -v68, -v68
    v_mfma_f32_16x16x32_bf16 v[100:103], v[36:39], v[220:223], v[100:103]
    ds_read_b128 v[32:35], v6 offset:4096
    v_cvt_pk_bf16_f32 v67, -v68, v70
    v_mfma_f32_16x16x32_bf16 v[104:107], v[40:43], v[220:223], v[104:107]
    ds_read_b128 v[36:39], v6 offset:5120
    v_mul_f32 v69, v69, v69
    v_mfma_f32_16x16x32_bf16 v[108:111], v[44:47], v[220:223], v[108:111]
    ds_read_b128 v[40:43], v6 offset:6144
    v_cndmask_b32 v66, 0, v66, s[34:35]
    s_waitcnt lgkmcnt(7)
    v_mfma_f32_16x16x32_bf16 v[112:115], v[48:51], v[220:223], v[112:115]
    ds_read_b128 v[44:47], v6 offset:7168
    v_cndmask_b32 v67, 0, v67, s[34:35]
    v_mfma_f32_16x16x32_bf16 v[116:119], v[52:55], v[220:223], v[116:119]
    ds_read_b128 v[48:51], v6 offset:8192
    buffer_store_dword v69, v8, s[52:55], s13 offen offset:64 sc0 sc1
    v_mfma_f32_16x16x32_bf16 v[120:123], v[56:59], v[220:223], v[120:123]
    ds_read_b128 v[52:55], v6 offset:9216
    v_mfma_f32_16x16x32_bf16 v[124:127], v[60:63], v[220:223], v[124:127]
    ds_read_b128 v[56:59], v6 offset:10240
    v_mov_b32 v7, 1
    s_waitcnt lgkmcnt(7)
    v_mfma_f32_16x16x32_bf16 v[100:103], v[16:19], v[224:227], v[100:103]
    ds_read_b128 v[60:63], v6 offset:11264
    s_waitcnt vmcnt(1)
    buffer_store_dword v7, v9, s[52:55], s74 offen offset:0
    v_mfma_f32_16x16x32_bf16 v[104:107], v[20:23], v[224:227], v[104:107]
    ds_read_b128 v[16:19], v6 offset:12288
    v_mfma_f32_16x16x32_bf16 v[108:111], v[24:27], v[224:227], v[108:111]
    ds_read_b128 v[20:23], v6 offset:13312
    v_mfma_f32_16x16x32_bf16 v[112:115], v[28:31], v[224:227], v[112:115]
    ds_read_b128 v[24:27], v6 offset:14336
    s_waitcnt lgkmcnt(7)
    v_mfma_f32_16x16x32_bf16 v[116:119], v[32:35], v[224:227], v[116:119]
    ds_read_b128 v[28:31], v6 offset:15360
    v_mfma_f32_16x16x32_bf16 v[120:123], v[36:39], v[224:227], v[120:123]
    ds_read_b128 v[32:35], v6 offset:16384
    v_mfma_f32_16x16x32_bf16 v[124:127], v[40:43], v[224:227], v[124:127]
    ds_read_b128 v[36:39], v6 offset:17408
    v_mfma_f32_16x16x32_bf16 v[100:103], v[44:47], v[228:231], v[100:103]
    ds_read_b128 v[40:43], v6 offset:18432
    s_waitcnt lgkmcnt(7)
    v_mfma_f32_16x16x32_bf16 v[104:107], v[48:51], v[228:231], v[104:107]
    ds_read_b128 v[44:47], v6 offset:19456
    v_mfma_f32_16x16x32_bf16 v[108:111], v[52:55], v[228:231], v[108:111]
    ds_read_b128 v[48:51], v6 offset:20480
    v_mfma_f32_16x16x32_bf16 v[112:115], v[56:59], v[228:231], v[112:115]
    ds_read_b128 v[52:55], v6 offset:21504
    v_mfma_f32_16x16x32_bf16 v[116:119], v[60:63], v[228:231], v[116:119]
    ds_read_b128 v[56:59], v6 offset:22528
    s_waitcnt lgkmcnt(7)
    v_mfma_f32_16x16x32_bf16 v[120:123], v[16:19], v[228:231], v[120:123]
    ds_read_b128 v[60:63], v6 offset:23552
    v_mfma_f32_16x16x32_bf16 v[124:127], v[20:23], v[228:231], v[124:127]
    ds_read_b128 v[16:19], v6 offset:24576
    v_mfma_f32_16x16x32_bf16 v[100:103], v[24:27], v[232:235], v[100:103]
    ds_read_b128 v[20:23], v6 offset:25600
    buffer_load_dword v14, v13, s[52:55], s75 offen offset:0 sc1
    v_mfma_f32_16x16x32_bf16 v[104:107], v[28:31], v[232:235], v[104:107]
    ds_read_b128 v[24:27], v6 offset:26624
    s_waitcnt lgkmcnt(7)
    v_mfma_f32_16x16x32_bf16 v[108:111], v[32:35], v[232:235], v[108:111]
    ds_read_b128 v[28:31], v6 offset:27648
    v_mfma_f32_16x16x32_bf16 v[112:115], v[36:39], v[232:235], v[112:115]
    ds_read_b128 v[32:35], v6 offset:28672
    v_mfma_f32_16x16x32_bf16 v[116:119], v[40:43], v[232:235], v[116:119]
    ds_read_b128 v[36:39], v6 offset:29696
    v_mfma_f32_16x16x32_bf16 v[120:123], v[44:47], v[232:235], v[120:123]
    ds_read_b128 v[40:43], v6 offset:30720
    s_waitcnt lgkmcnt(7)
    v_mfma_f32_16x16x32_bf16 v[124:127], v[48:51], v[232:235], v[124:127]
    ds_read_b128 v[44:47], v6 offset:31744
    v_mfma_f32_16x16x32_bf16 v[100:103], v[52:55], v[236:239], v[100:103]
    ds_read_b128 v[48:51], v6 offset:32768
    v_mfma_f32_16x16x32_bf16 v[104:107], v[56:59], v[236:239], v[104:107]
    ds_read_b128 v[52:55], v6 offset:33792
    v_mfma_f32_16x16x32_bf16 v[108:111], v[60:63], v[236:239], v[108:111]
    ds_read_b128 v[56:59], v6 offset:34816
    s_waitcnt lgkmcnt(7)
    v_mfma_f32_16x16x32_bf16 v[112:115], v[16:19], v[236:239], v[112:115]
    ds_read_b128 v[60:63], v6 offset:35840
    v_mfma_f32_16x16x32_bf16 v[116:119], v[20:23], v[236:239], v[116:119]
    ds_read_b128 v[16:19], v6 offset:36864
    v_mfma_f32_16x16x32_bf16 v[120:123], v[24:27], v[236:239], v[120:123]
    ds_read_b128 v[20:23], v6 offset:37888
    v_mfma_f32_16x16x32_bf16 v[124:127], v[28:31], v[236:239], v[124:127]
    ds_read_b128 v[24:27], v6 offset:38912
    s_waitcnt lgkmcnt(7)
    v_mfma_f32_16x16x32_bf16 v[100:103], v[32:35], v[240:243], v[100:103]
    ds_read_b128 v[28:31], v6 offset:39936
    s_waitcnt vmcnt(0)
    v_cmp_gt_u32 vcc, 1, v14
    s_cbranch_vccnz FWAIT_47
FOK_46:
    v_mfma_f32_16x16x32_bf16 v[104:107], v[36:39], v[240:243], v[104:107]
    ds_read_b128 v[32:35], v6 offset:40960
    buffer_load_dwordx4 v[128:131], v3, s[52:55], s88 offen offset:0 sc1
    v_mfma_f32_16x16x32_bf16 v[108:111], v[40:43], v[240:243], v[108:111]
    ds_read_b128 v[36:39], v6 offset:41984
    v_mfma_f32_16x16x32_bf16 v[112:115], v[44:47], v[240:243], v[112:115]
    ds_read_b128 v[40:43], v6 offset:43008
    s_waitcnt lgkmcnt(7)
    v_mfma_f32_16x16x32_bf16 v[116:119], v[48:51], v[240:243], v[116:119]
    ds_read_b128 v[44:47], v6 offset:44032
    buffer_load_dwordx4 v[132:135], v3, s[52:55], s88 offen offset:1024 sc1
    v_mfma_f32_16x16x32_bf16 v[120:123], v[52:55], v[240:243], v[120:123]
    ds_read_b128 v[48:51], v6 offset:45056
    v_mfma_f32_16x16x32_bf16 v[124:127], v[56:59], v[240:243], v[124:127]
    ds_read_b128 v[52:55], v6 offset:46080
    v_mfma_f32_16x16x32_bf16 v[100:103], v[60:63], v[244:247], v[100:103]
    ds_read_b128 v[56:59], v6 offset:47104
    buffer_load_dwordx4 v[136:139], v3, s[52:55], s88 offen offset:2048 sc1
    s_waitcnt lgkmcnt(7)
    v_mfma_f32_16x16x32_bf16 v[104:107], v[16:19], v[244:247], v[104:107]
    ds_read_b128 v[60:63], v6 offset:48128
    v_mfma_f32_16x16x32_bf16 v[108:111], v[20:23], v[244:247], v[108:111]
    ds_read_b128 v[16:19], v6 offset:49152
    v_mfma_f32_16x16x32_bf16 v[112:115], v[24:27], v[244:247], v[112:115]
    ds_read_b128 v[20:23], v6 offset:50176
    buffer_load_dwordx4 v[140:143], v3, s[52:55], s88 offen offset:3072 sc1
    v_mfma_f32_16x16x32_bf16 v[116:119], v[28:31], v[244:247], v[116:119]
    ds_read_b128 v[24:27], v6 offset:51200
    s_waitcnt lgkmcnt(7)
    v_mfma_f32_16x16x32_bf16 v[120:123], v[32:35], v[244:247], v[120:123]
    ds_read_b128 v[28:31], v6 offset:52224
    v_mfma_f32_16x16x32_bf16 v[124:127], v[36:39], v[244:247], v[124:127]
    ds_read_b128 v[32:35], v6 offset:53248
    buffer_load_dwordx4 v[144:147], v3, s[52:55], s89 offen offset:0 sc1
    v_mfma_f32_16x16x32_bf16 v[100:103], v[40:43], v[248:251], v[100:103]
    ds_read_b128 v[36:39], v6 offset:54272
    v_mfma_f32_16x16x32_bf16 v[104:107], v[44:47], v[248:251], v[104:107]
    ds_read_b128 v[40:43], v6 offset:55296
    s_waitcnt lgkmcnt(7)
    v_mfma_f32_16x16x32_bf16 v[108:111], v[48:51], v[248:251], v[108:111]
    ds_read_b128 v[44:47], v6 offset:56320
    buffer_load_dwordx4 v[148:151], v3, s[52:55], s89 offen offset:1024 sc1
    v_mfma_f32_16x16x32_bf16 v[112:115], v[52:55], v[248:251], v[112:115]
    v_mfma_f32_16x16x32_bf16 v[116:119], v[56:59], v[248:251], v[116:119]
    v_mfma_f32_16x16x32_bf16 v[120:123], v[60:63], v[248:251], v[120:123]
    buffer_load_dwordx4 v[152:155], v3, s[52:55], s89 offen offset:2048 sc1
    s_waitcnt lgkmcnt(4)
    v_mfma_f32_16x16x32_bf16 v[124:127], v[16:19], v[248:251], v[124:127]
    v_mfma_f32_16x16x32_bf16 v[100:103], v[20:23], v[252:255], v[100:103]
    v_mfma_f32_16x16x32_bf16 v[104:107], v[24:27], v[252:255], v[104:107]
    buffer_load_dwordx4 v[156:159], v3, s[52:55], s89 offen offset:3072 sc1
    v_mfma_f32_16x16x32_bf16 v[108:111], v[28:31], v[252:255], v[108:111]
    s_waitcnt lgkmcnt(0)
    v_mfma_f32_16x16x32_bf16 v[112:115], v[32:35], v[252:255], v[112:115]
    v_mfma_f32_16x16x32_bf16 v[116:119], v[36:39], v[252:255], v[116:119]
    buffer_load_dwordx4 v[160:163], v3, s[52:55], s90 offen offset:0 sc1
    v_mfma_f32_16x16x32_bf16 v[120:123], v[40:43], v[252:255], v[120:123]
    v_mfma_f32_16x16x32_bf16 v[124:127], v[44:47], v[252:255], v[124:127]
    buffer_load_dwordx4 v[164:167], v3, s[52:55], s90 offen offset:1024 sc1
    buffer_load_dwordx4 v[168:171], v3, s[52:55], s90 offen offset:2048 sc1
    buffer_load_dwordx4 v[172:175], v3, s[52:55], s90 offen offset:3072 sc1
    buffer_load_dwordx4 v[176:179], v3, s[52:55], s91 offen offset:0 sc1
    buffer_load_dwordx4 v[180:183], v3, s[52:55], s91 offen offset:1024 sc1
    buffer_load_dwordx4 v[184:187], v3, s[52:55], s91 offen offset:2048 sc1
    buffer_load_dwordx4 v[188:191], v3, s[52:55], s91 offen offset:3072 sc1
    s_nop 1
    v_mfma_f32_16x16x16_bf16 v[100:103], a[240:241], v[66:67], v[100:103]
    v_mfma_f32_16x16x16_bf16 v[104:107], a[242:243], v[66:67], v[104:107]
    v_mfma_f32_16x16x16_bf16 v[108:111], a[244:245], v[66:67], v[108:111]
    v_mfma_f32_16x16x16_bf16 v[112:115], a[246:247], v[66:67], v[112:115]
    v_mfma_f32_16x16x16_bf16 v[116:119], a[248:249], v[66:67], v[116:119]
    v_mfma_f32_16x16x16_bf16 v[120:123], a[250:251], v[66:67], v[120:123]
    v_mfma_f32_16x16x16_bf16 v[124:127], a[252:253], v[66:67], v[124:127]
    s_waitcnt vmcnt(15)
    v_mfma_f32_32x32x16_bf16 v[192:207], a[0:3], v[128:131], 0
    v_and_b32 v90, 0x70, v3
    s_lshl_b32 s26, s20, 7
    buffer_load_dwordx4 v[96:99], v90, s[60:63], s26 offen
    v_lshrrev_b32 v91, 7, v3
    v_lshlrev_b32 v91, 2, v91
    buffer_load_dword v88, v91, s[52:55], s43 offen offset:0 sc1
    v_mfma_f32_32x32x16_bf16 v[208:223], a[4:7], v[128:131], 0
    v_mul_f32 v100, v100, abs(v100)
    v_mul_f32 v101, v101, abs(v101)
    v_mul_f32 v102, v102, abs(v102)
    v_mul_f32 v103, v103, abs(v103)
    v_mul_f32 v104, v104, abs(v104)
    v_mul_f32 v105, v105, abs(v105)
    s_waitcnt vmcnt(16)
    v_mfma_f32_32x32x16_bf16 v[192:207], a[8:11], v[132:135], v[192:207]
    v_mul_f32 v106, v106, abs(v106)
    v_mul_f32 v107, v107, abs(v107)
    v_cvt_pk_bf16_f32 v100, v100, v101
    v_cvt_pk_bf16_f32 v101, v102, v103
    v_cvt_pk_bf16_f32 v102, v104, v105
    v_cvt_pk_bf16_f32 v103, v106, v107
    v_mfma_f32_32x32x16_bf16 v[208:223], a[12:15], v[132:135], v[208:223]
    v_pk_max_i16 v100, v100, 0
    v_pk_max_i16 v101, v101, 0
    v_pk_max_i16 v102, v102, 0
    v_pk_max_i16 v103, v103, 0
    buffer_store_dwordx4 v[100:103], v0, s[52:55], s4 offen offset:0 sc0 sc1
    v_mul_f32 v108, v108, abs(v108)
    s_waitcnt vmcnt(16)
    v_mfma_f32_32x32x16_bf16 v[192:207], a[16:19], v[136:139], v[192:207]
    v_mul_f32 v109, v109, abs(v109)
    v_mul_f32 v110, v110, abs(v110)
    v_mul_f32 v111, v111, abs(v111)
    v_mul_f32 v112, v112, abs(v112)
    v_mul_f32 v113, v113, abs(v113)
    v_mul_f32 v114, v114, abs(v114)
    v_mfma_f32_32x32x16_bf16 v[208:223], a[20:23], v[136:139], v[208:223]
    v_mul_f32 v115, v115, abs(v115)
    v_cvt_pk_bf16_f32 v108, v108, v109
    v_cvt_pk_bf16_f32 v109, v110, v111
    v_cvt_pk_bf16_f32 v110, v112, v113
    v_cvt_pk_bf16_f32 v111, v114, v115
    v_pk_max_i16 v108, v108, 0
    s_waitcnt vmcnt(15)
    v_mfma_f32_32x32x16_bf16 v[192:207], a[24:27], v[140:143], v[192:207]
    v_pk_max_i16 v109, v109, 0
    v_pk_max_i16 v110, v110, 0
    v_pk_max_i16 v111, v111, 0
    buffer_store_dwordx4 v[108:111], v0, s[52:55], s4 offen offset:2048 sc0 sc1
    v_mul_f32 v116, v116, abs(v116)
    v_mul_f32 v117, v117, abs(v117)
    v_mfma_f32_32x32x16_bf16 v[208:223], a[28:31], v[140:143], v[208:223]
    v_mul_f32 v118, v118, abs(v118)
    v_mul_f32 v119, v119, abs(v119)
    v_mul_f32 v120, v120, abs(v120)
    v_mul_f32 v121, v121, abs(v121)
    v_mul_f32 v122, v122, abs(v122)
    v_mul_f32 v123, v123, abs(v123)
    s_waitcnt vmcnt(15)
    v_mfma_f32_32x32x16_bf16 v[192:207], a[32:35], v[144:147], v[192:207]
    v_cvt_pk_bf16_f32 v116, v116, v117
    v_cvt_pk_bf16_f32 v117, v118, v119
    v_cvt_pk_bf16_f32 v118, v120, v121
    v_cvt_pk_bf16_f32 v119, v122, v123
    v_pk_max_i16 v116, v116, 0
    v_pk_max_i16 v117, v117, 0
    v_mfma_f32_32x32x16_bf16 v[208:223], a[36:39], v[144:147], v[208:223]
    v_pk_max_i16 v118, v118, 0
    v_pk_max_i16 v119, v119, 0
    buffer_store_dwordx4 v[116:119], v0, s[52:55], s5 offen offset:0 sc0 sc1
    v_mul_f32 v124, v124, abs(v124)
    v_mul_f32 v125, v125, abs(v125)
    v_mul_f32 v126, v126, abs(v126)
    s_waitcnt vmcnt(15)
    v_mfma_f32_32x32x16_bf16 v[192:207], a[40:43], v[148:151], v[192:207]
    v_mul_f32 v127, v127, abs(v127)
    v_cvt_pk_bf16_f32 v124, v124, v125
    v_cvt_pk_bf16_f32 v125, v126, v127
    v_pk_max_i16 v124, v124, 0
    v_pk_max_i16 v125, v125, 0
    buffer_store_dwordx2 v[124:125], v1, s[52:55], s5 offen offset:2048 sc0 sc1
    v_mfma_f32_32x32x16_bf16 v[208:223], a[44:47], v[148:151], v[208:223]
    v_and_b32 v118, 0x70, v3
    s_lshl_b32 s26, s20, 7
    buffer_load_dwordx4 v[124:127], v118, s[60:63], s26 offen
    s_waitcnt vmcnt(16)
    v_mfma_f32_32x32x16_bf16 v[192:207], a[48:51], v[152:155], v[192:207]
    v_mfma_f32_32x32x16_bf16 v[208:223], a[52:55], v[152:155], v[208:223]
    buffer_load_dwordx4 v[16:19], v3, s[52:55], s92 offen offset:0 sc1
    s_waitcnt vmcnt(16)
    v_mfma_f32_32x32x16_bf16 v[192:207], a[56:59], v[156:159], v[192:207]
    v_mfma_f32_32x32x16_bf16 v[208:223], a[60:63], v[156:159], v[208:223]
    buffer_load_dwordx4 v[20:23], v3, s[52:55], s92 offen offset:1024 sc1
    s_waitcnt vmcnt(16)
    v_mfma_f32_32x32x16_bf16 v[192:207], a[64:67], v[160:163], v[192:207]
    v_mfma_f32_32x32x16_bf16 v[208:223], a[68:71], v[160:163], v[208:223]
    buffer_load_dwordx4 v[24:27], v3, s[52:55], s92 offen offset:2048 sc1
    s_waitcnt vmcnt(16)
    v_mfma_f32_32x32x16_bf16 v[192:207], a[72:75], v[164:167], v[192:207]
    v_mfma_f32_32x32x16_bf16 v[208:223], a[76:79], v[164:167], v[208:223]
    buffer_load_dwordx4 v[28:31], v3, s[52:55], s92 offen offset:3072 sc1
    s_waitcnt vmcnt(16)
    v_mfma_f32_32x32x16_bf16 v[192:207], a[80:83], v[168:171], v[192:207]
    v_mfma_f32_32x32x16_bf16 v[208:223], a[84:87], v[168:171], v[208:223]
    buffer_load_dwordx4 v[32:35], v3, s[52:55], s93 offen offset:0 sc1
    s_waitcnt vmcnt(16)
    v_mfma_f32_32x32x16_bf16 v[192:207], a[88:91], v[172:175], v[192:207]
    v_mfma_f32_32x32x16_bf16 v[208:223], a[92:95], v[172:175], v[208:223]
    buffer_load_dwordx4 v[36:39], v3, s[52:55], s93 offen offset:1024 sc1
    v_mov_b32 v7, 2
    s_waitcnt vmcnt(7)
    buffer_store_dword v7, v9, s[52:55], s74 offen offset:0
    v_mfma_f32_32x32x16_bf16 v[192:207], a[96:99], v[176:179], v[192:207]
    v_mfma_f32_32x32x16_bf16 v[208:223], a[100:103], v[176:179], v[208:223]
    buffer_load_dwordx4 v[40:43], v3, s[52:55], s93 offen offset:2048 sc1
    v_mfma_f32_32x32x16_bf16 v[192:207], a[104:107], v[180:183], v[192:207]
    v_mfma_f32_32x32x16_bf16 v[208:223], a[108:111], v[180:183], v[208:223]
    buffer_load_dwordx4 v[44:47], v3, s[52:55], s93 offen offset:3072 sc1
    v_mfma_f32_32x32x16_bf16 v[192:207], a[112:115], v[184:187], v[192:207]
    v_mfma_f32_32x32x16_bf16 v[208:223], a[116:119], v[184:187], v[208:223]
    buffer_load_dwordx4 v[48:51], v3, s[52:55], s94 offen offset:0 sc1
    v_accvgpr_read_b32 v92, a224
    v_lshlrev_b32 v93, 16, v96
    v_and_b32 v94, 0xffff0000, v96
    v_lshlrev_b32 v72, 16, v92
    v_and_b32 v73, 0xffff0000, v92
    v_mfma_f32_32x32x16_bf16 v[192:207], a[120:123], v[188:191], v[192:207]
    v_add_f32 v72, v72, v93
    v_add_f32 v73, v73, v94
    v_accvgpr_read_b32 v92, a225
    v_lshlrev_b32 v93, 16, v97
    v_and_b32 v94, 0xffff0000, v97
    v_lshlrev_b32 v74, 16, v92
    v_mfma_f32_32x32x16_bf16 v[208:223], a[124:127], v[188:191], v[208:223]
    buffer_load_dwordx4 v[52:55], v3, s[52:55], s94 offen offset:1024 sc1
    v_and_b32 v75, 0xffff0000, v92
    v_add_f32 v74, v74, v93
    v_add_f32 v75, v75, v94
    v_accvgpr_read_b32 v92, a226
    v_lshlrev_b32 v93, 16, v98
    s_waitcnt vmcnt(10)
    v_mfma_f32_32x32x16_bf16 v[192:207], a[128:131], v[16:19], v[192:207]
    buffer_load_dword v14, v13, s[52:55], s75 offen offset:0 sc1
    v_and_b32 v94, 0xffff0000, v98
    v_lshlrev_b32 v76, 16, v92
    v_and_b32 v77, 0xffff0000, v92
    v_add_f32 v76, v76, v93
    v_add_f32 v77, v77, v94
    v_mfma_f32_32x32x16_bf16 v[208:223], a[132:135], v[16:19], v[208:223]
    buffer_load_dwordx4 v[56:59], v3, s[52:55], s94 offen offset:2048 sc1
    v_accvgpr_read_b32 v92, a227
    v_lshlrev_b32 v93, 16, v99
    v_and_b32 v94, 0xffff0000, v99
    v_lshlrev_b32 v78, 16, v92
    v_and_b32 v79, 0xffff0000, v92
    s_waitcnt vmcnt(11)
    v_mfma_f32_32x32x16_bf16 v[192:207], a[136:139], v[20:23], v[192:207]
    v_add_f32 v78, v78, v93
    v_add_f32 v79, v79, v94
    v_accvgpr_read_b32 v80, a232
    v_lshlrev_b32 v80, 16, v80
    v_accvgpr_read_b32 v81, a233
    v_lshlrev_b32 v81, 16, v81
    v_mfma_f32_32x32x16_bf16 v[208:223], a[140:143], v[20:23], v[208:223]
    buffer_load_dwordx4 v[60:63], v3, s[52:55], s94 offen offset:3072 sc1
    v_accvgpr_read_b32 v82, a234
    v_lshlrev_b32 v82, 16, v82
    v_accvgpr_read_b32 v83, a235
    v_lshlrev_b32 v83, 16, v83
    v_accvgpr_read_b32 v84, a236
    s_waitcnt vmcnt(11)
    v_mfma_f32_32x32x16_bf16 v[192:207], a[144:147], v[24:27], v[192:207]
    v_lshlrev_b32 v84, 16, v84
    v_accvgpr_read_b32 v85, a237
    v_lshlrev_b32 v85, 16, v85
    v_accvgpr_read_b32 v86, a238
    v_lshlrev_b32 v86, 16, v86
    v_accvgpr_read_b32 v87, a239
    v_mfma_f32_32x32x16_bf16 v[208:223], a[148:151], v[24:27], v[208:223]
    v_lshlrev_b32 v87, 16, v87
    v_accvgpr_read_b32 v120, a228
    v_lshlrev_b32 v121, 16, v124
    v_and_b32 v122, 0xffff0000, v124
    v_lshlrev_b32 v100, 16, v120
    v_and_b32 v101, 0xffff0000, v120
    s_waitcnt vmcnt(10)
    v_mfma_f32_32x32x16_bf16 v[192:207], a[152:155], v[28:31], v[192:207]
    v_add_f32 v100, v100, v121
    v_add_f32 v101, v101, v122
    v_accvgpr_read_b32 v120, a229
    v_lshlrev_b32 v121, 16, v125
    v_and_b32 v122, 0xffff0000, v125
    v_lshlrev_b32 v102, 16, v120
    v_mfma_f32_32x32x16_bf16 v[208:223], a[156:159], v[28:31], v[208:223]
    v_and_b32 v103, 0xffff0000, v120
    v_add_f32 v102, v102, v121
    v_add_f32 v103, v103, v122
    v_accvgpr_read_b32 v120, a230
    v_lshlrev_b32 v121, 16, v126
    v_and_b32 v122, 0xffff0000, v126
    s_waitcnt vmcnt(9)
    v_mfma_f32_32x32x16_bf16 v[192:207], a[160:163], v[32:35], v[192:207]
    s_waitcnt vmcnt(2)
    v_cmp_gt_u32 vcc, 2, v14
    s_cbranch_vccnz FWAIT_49
FOK_48:
    buffer_load_dwordx4 v[16:19], v3, s[52:55], s95 offen offset:0 sc1
    v_lshlrev_b32 v104, 16, v120
    v_mfma_f32_32x32x16_bf16 v[208:223], a[164:167], v[32:35], v[208:223]
    buffer_load_dwordx4 v[20:23], v3, s[52:55], s95 offen offset:1024 sc1
    v_and_b32 v105, 0xffff0000, v120
    v_add_f32 v104, v104, v121
    v_add_f32 v105, v105, v122
    v_accvgpr_read_b32 v120, a231
    v_lshlrev_b32 v121, 16, v127
    v_mfma_f32_32x32x16_bf16 v[192:207], a[168:171], v[36:39], v[192:207]
    buffer_load_dwordx4 v[24:27], v3, s[52:55], s95 offen offset:2048 sc1
    v_and_b32 v122, 0xffff0000, v127
    v_lshlrev_b32 v106, 16, v120
    v_and_b32 v107, 0xffff0000, v120
    v_add_f32 v106, v106, v121
    v_add_f32 v107, v107, v122
    v_mfma_f32_32x32x16_bf16 v[208:223], a[172:175], v[36:39], v[208:223]
    buffer_load_dwordx4 v[28:31], v3, s[52:55], s95 offen offset:3072 sc1
    v_accvgpr_read_b32 v108, a232
    v_and_b32 v108, 0xffff0000, v108
    v_accvgpr_read_b32 v109, a233
    v_and_b32 v109, 0xffff0000, v109
    v_accvgpr_read_b32 v110, a234
    v_mfma_f32_32x32x16_bf16 v[192:207], a[176:179], v[40:43], v[192:207]
    v_and_b32 v110, 0xffff0000, v110
    v_accvgpr_read_b32 v111, a235
    v_and_b32 v111, 0xffff0000, v111
    v_accvgpr_read_b32 v112, a236
    v_and_b32 v112, 0xffff0000, v112
    v_accvgpr_read_b32 v113, a237
    v_mfma_f32_32x32x16_bf16 v[208:223], a[180:183], v[40:43], v[208:223]
    buffer_load_dwordx4 v[32:35], v3, s[52:55], s96 offen offset:0 sc1
    v_and_b32 v113, 0xffff0000, v113
    v_accvgpr_read_b32 v114, a238
    v_and_b32 v114, 0xffff0000, v114
    v_accvgpr_read_b32 v115, a239
    v_and_b32 v115, 0xffff0000, v115
    v_mfma_f32_32x32x16_bf16 v[192:207], a[184:187], v[44:47], v[192:207]
    v_mfma_f32_32x32x16_bf16 v[208:223], a[188:191], v[44:47], v[208:223]
    buffer_load_dwordx4 v[36:39], v3, s[52:55], s96 offen offset:1024 sc1
    v_mfma_f32_32x32x16_bf16 v[192:207], a[192:195], v[48:51], v[192:207]
    v_mfma_f32_32x32x16_bf16 v[208:223], a[196:199], v[48:51], v[208:223]
    buffer_load_dwordx4 v[40:43], v3, s[52:55], s96 offen offset:2048 sc1
    v_mfma_f32_32x32x16_bf16 v[192:207], a[200:203], v[52:55], v[192:207]
    v_mfma_f32_32x32x16_bf16 v[208:223], a[204:207], v[52:55], v[208:223]
    buffer_load_dwordx4 v[44:47], v3, s[52:55], s96 offen offset:3072 sc1
    s_waitcnt vmcnt(9)
    v_mfma_f32_32x32x16_bf16 v[192:207], a[208:211], v[56:59], v[192:207]
    v_mfma_f32_32x32x16_bf16 v[208:223], a[212:215], v[56:59], v[208:223]
    buffer_load_dwordx4 v[48:51], v3, s[52:55], s97 offen offset:0 sc1
    s_waitcnt vmcnt(9)
    v_mfma_f32_32x32x16_bf16 v[192:207], a[216:219], v[60:63], v[192:207]
    v_mfma_f32_32x32x16_bf16 v[208:223], a[220:223], v[60:63], v[208:223]
    buffer_load_dwordx4 v[52:55], v3, s[52:55], s97 offen offset:1024 sc1
    s_add_u32 s8, s8, 0x20000
    s_waitcnt vmcnt(9)
    v_mfma_f32_32x32x16_bf16 v[224:239], a[0:3], v[16:19], 0
    v_lshrrev_b32 v119, 7, v3
    v_lshlrev_b32 v119, 2, v119
    buffer_load_dword v116, v119, s[52:55], s43 offen offset:64 sc1
    s_nop 1
    v_mfma_f32_32x32x16_bf16 v[240:255], a[4:7], v[16:19], 0
    buffer_load_dwordx4 v[56:59], v3, s[52:55], s97 offen offset:2048 sc1
    s_waitcnt vmcnt(10)
    v_mfma_f32_32x32x16_bf16 v[224:239], a[8:11], v[20:23], v[224:239]
    ds_write_b128 v2, v[192:195] offset:0
    v_mfma_f32_32x32x16_bf16 v[240:255], a[12:15], v[20:23], v[240:255]
    buffer_load_dwordx4 v[60:63], v3, s[52:55], s97 offen offset:3072 sc1
    ds_write_b128 v2, v[196:199] offset:4352
    s_waitcnt vmcnt(10)
    v_mfma_f32_32x32x16_bf16 v[224:239], a[16:19], v[24:27], v[224:239]
    ds_write_b128 v2, v[200:203] offset:1088
    v_mfma_f32_32x32x16_bf16 v[240:255], a[20:23], v[24:27], v[240:255]
    buffer_load_dwordx4 v[16:19], v3, s[52:55], s98 offen offset:0 sc1
    ds_write_b128 v2, v[204:207] offset:5440
    s_waitcnt vmcnt(10)
    v_mfma_f32_32x32x16_bf16 v[224:239], a[24:27], v[28:31], v[224:239]
    ds_write_b128 v2, v[208:211] offset:2176
    v_mfma_f32_32x32x16_bf16 v[240:255], a[28:31], v[28:31], v[240:255]
    buffer_load_dwordx4 v[20:23], v3, s[52:55], s98 offen offset:1024 sc1
    ds_write_b128 v2, v[212:215] offset:6528
    s_waitcnt vmcnt(10)
    v_mfma_f32_32x32x16_bf16 v[224:239], a[32:35], v[32:35], v[224:239]
    ds_write_b128 v2, v[216:219] offset:3264
    v_mfma_f32_32x32x16_bf16 v[240:255], a[36:39], v[32:35], v[240:255]
    buffer_load_dwordx4 v[24:27], v3, s[52:55], s98 offen offset:2048 sc1
    ds_write_b128 v2, v[220:223] offset:7616
    s_waitcnt vmcnt(10)
    v_mfma_f32_32x32x16_bf16 v[224:239], a[40:43], v[36:39], v[224:239]
    v_mfma_f32_32x32x16_bf16 v[240:255], a[44:47], v[36:39], v[240:255]
    buffer_load_dwordx4 v[28:31], v3, s[52:55], s98 offen offset:3072 sc1
    s_waitcnt vmcnt(10)
    v_mfma_f32_32x32x16_bf16 v[224:239], a[48:51], v[40:43], v[224:239]
    v_mfma_f32_32x32x16_bf16 v[240:255], a[52:55], v[40:43], v[240:255]
    buffer_load_dwordx4 v[32:35], v3, s[52:55], s99 offen offset:0 sc1
    s_waitcnt lgkmcnt(0)
    s_barrier
    ds_read_b128 v[160:163], v10 offset:0
    ds_read_b128 v[164:167], v10 offset:4352
    ds_read_b128 v[168:171], v10 offset:8704
    s_waitcnt vmcnt(10)
    v_mfma_f32_32x32x16_bf16 v[224:239], a[56:59], v[44:47], v[224:239]
    ds_read_b128 v[172:175], v10 offset:13056
    ds_read_b128 v[176:179], v10 offset:17408
    ds_read_b128 v[180:183], v10 offset:21760
    ds_read_b128 v[184:187], v10 offset:26112
    ds_read_b128 v[188:191], v10 offset:30464
    v_mfma_f32_32x32x16_bf16 v[240:255], a[60:63], v[44:47], v[240:255]
    buffer_load_dwordx4 v[36:39], v3, s[52:55], s99 offen offset:1024 sc1
    s_waitcnt vmcnt(10)
    v_mfma_f32_32x32x16_bf16 v[224:239], a[64:67], v[48:51], v[224:239]
    v_mfma_f32_32x32x16_bf16 v[240:255], a[68:71], v[48:51], v[240:255]
    buffer_load_dwordx4 v[40:43], v3, s[52:55], s99 offen offset:2048 sc1
    s_waitcnt lgkmcnt(4)
    v_add_f32 v160, v160, v168
    v_add_f32 v161, v161, v169
    v_add_f32 v162, v162, v170
    v_add_f32 v163, v163, v171
    s_waitcnt vmcnt(10)
    v_mfma_f32_32x32x16_bf16 v[224:239], a[72:75], v[52:55], v[224:239]
    v_add_f32 v164, v164, v172
    v_add_f32 v165, v165, v173
    v_add_f32 v166, v166, v174
    v_add_f32 v167, v167, v175
    s_waitcnt lgkmcnt(0)
    v_add_f32 v176, v176, v184
    v_mfma_f32_32x32x16_bf16 v[240:255], a[76:79], v[52:55], v[240:255]
    buffer_load_dwordx4 v[44:47], v3, s[52:55], s99 offen offset:3072 sc1
    v_add_f32 v177, v177, v185
    v_add_f32 v178, v178, v186
    v_add_f32 v179, v179, v187
    v_add_f32 v180, v180, v188
    v_add_f32 v181, v181, v189
    s_waitcnt vmcnt(9)
    v_mfma_f32_32x32x16_bf16 v[224:239], a[80:83], v[56:59], v[224:239]
    v_add_f32 v182, v182, v190
    v_add_f32 v183, v183, v191
    v_add_f32 v160, v160, v176
    v_add_f32 v161, v161, v177
    v_add_f32 v162, v162, v178
    v_add_f32 v163, v163, v179
    v_mfma_f32_32x32x16_bf16 v[240:255], a[84:87], v[56:59], v[240:255]
    buffer_load_dwordx4 v[48:51], v3, s[52:55], s100 offen offset:0 sc1
    v_add_f32 v164, v164, v180
    v_add_f32 v165, v165, v181
    v_add_f32 v166, v166, v182
    v_add_f32 v167, v167, v183
    v_fmac_f32 v72, v160, v88
    s_waitcnt vmcnt(9)
    v_mfma_f32_32x32x16_bf16 v[224:239], a[88:91], v[60:63], v[224:239]
    v_fmac_f32 v73, v161, v88
    v_fmac_f32 v74, v162, v88
    v_fmac_f32 v75, v163, v88
    v_fmac_f32 v76, v164, v88
    v_fmac_f32 v77, v165, v88
    v_fmac_f32 v78, v166, v88
    v_mfma_f32_32x32x16_bf16 v[240:255], a[92:95], v[60:63], v[240:255]
    buffer_load_dwordx4 v[52:55], v3, s[52:55], s100 offen offset:1024 sc1
    v_fmac_f32 v79, v167, v88
    v_add_f32 v90, v72, v73
    v_mul_f32 v91, v72, v72
    v_fmac_f32 v91, v73, v73
    v_add_f32 v90, v90, v74
    s_waitcnt vmcnt(9)
    v_mfma_f32_32x32x16_bf16 v[224:239], a[96:99], v[16:19], v[224:239]
    v_fmac_f32 v91, v74, v74
    v_add_f32 v90, v90, v75
    v_fmac_f32 v91, v75, v75
    v_add_f32 v90, v90, v76
    v_fmac_f32 v91, v76, v76
    v_add_f32 v90, v90, v77
    v_mfma_f32_32x32x16_bf16 v[240:255], a[100:103], v[16:19], v[240:255]
    buffer_load_dwordx4 v[56:59], v3, s[52:55], s100 offen offset:2048 sc1
    v_fmac_f32 v91, v77, v77
    v_add_f32 v90, v90, v78
    v_fmac_f32 v91, v78, v78
    v_add_f32 v90, v90, v79
    v_fmac_f32 v91, v79, v79
    s_waitcnt vmcnt(9)
    v_mfma_f32_32x32x16_bf16 v[224:239], a[104:107], v[20:23], v[224:239]
    s_nop 0
    v_add_f32_dpp v90, v90, v90 quad_perm:[1,0,3,2] row_mask:0xf bank_mask:0xf
    v_add_f32_dpp v91, v91, v91 quad_perm:[1,0,3,2] row_mask:0xf bank_mask:0xf
    s_nop 0
    v_add_f32_dpp v90, v90, v90 quad_perm:[2,3,0,1] row_mask:0xf bank_mask:0xf
    v_add_f32_dpp v91, v91, v91 quad_perm:[2,3,0,1] row_mask:0xf bank_mask:0xf
    v_mfma_f32_32x32x16_bf16 v[240:255], a[108:111], v[20:23], v[240:255]
    buffer_load_dwordx4 v[60:63], v3, s[52:55], s100 offen offset:3072 sc1
    s_nop 0
    v_add_f32_dpp v90, v90, v90 row_half_mirror row_mask:0xf bank_mask:0xf
    v_add_f32_dpp v91, v91, v91 row_half_mirror row_mask:0xf bank_mask:0xf
    v_and_b32 v91, 0x7fffffff, v91
    buffer_store_dwordx2 v[90:91], v11, s[52:55], s7 offen offset:0
    s_waitcnt vmcnt(10)
    v_mfma_f32_32x32x16_bf16 v[224:239], a[112:115], v[24:27], v[224:239]
    v_mfma_f32_32x32x16_bf16 v[240:255], a[116:119], v[24:27], v[240:255]
    buffer_load_dwordx4 v[16:19], v3, s[52:55], s101 offen offset:0 sc1
    s_waitcnt vmcnt(10)
    v_mfma_f32_32x32x16_bf16 v[224:239], a[120:123], v[28:31], v[224:239]
    v_mfma_f32_32x32x16_bf16 v[240:255], a[124:127], v[28:31], v[240:255]
    buffer_load_dwordx4 v[20:23], v3, s[52:55], s101 offen offset:1024 sc1
    s_waitcnt vmcnt(10)
    v_mfma_f32_32x32x16_bf16 v[224:239], a[128:131], v[32:35], v[224:239]
    buffer_load_dwordx2 v[92:93], v5, s[52:55], s7 offen offset:0 sc1
    s_barrier
    v_mfma_f32_32x32x16_bf16 v[240:255], a[132:135], v[32:35], v[240:255]
    buffer_load_dwordx4 v[24:27], v3, s[52:55], s101 offen offset:2048 sc1
    s_waitcnt vmcnt(11)
    v_mfma_f32_32x32x16_bf16 v[224:239], a[136:139], v[36:39], v[224:239]
    v_mfma_f32_32x32x16_bf16 v[240:255], a[140:143], v[36:39], v[240:255]
    buffer_load_dwordx4 v[28:31], v3, s[52:55], s101 offen offset:3072 sc1
    s_waitcnt vmcnt(11)
    v_mfma_f32_32x32x16_bf16 v[224:239], a[144:147], v[40:43], v[224:239]
    v_mfma_f32_32x32x16_bf16 v[240:255], a[148:151], v[40:43], v[240:255]
    s_waitcnt vmcnt(10)
    v_mfma_f32_32x32x16_bf16 v[224:239], a[152:155], v[44:47], v[224:239]
    v_mfma_f32_32x32x16_bf16 v[240:255], a[156:159], v[44:47], v[240:255]
    s_waitcnt vmcnt(9)
    v_mfma_f32_32x32x16_bf16 v[224:239], a[160:163], v[48:51], v[224:239]
    v_mfma_f32_32x32x16_bf16 v[240:255], a[164:167], v[48:51], v[240:255]
    s_waitcnt vmcnt(8)
    v_mfma_f32_32x32x16_bf16 v[224:239], a[168:171], v[52:55], v[224:239]
    v_mfma_f32_32x32x16_bf16 v[240:255], a[172:175], v[52:55], v[240:255]
    s_waitcnt vmcnt(7)
    v_mfma_f32_32x32x16_bf16 v[224:239], a[176:179], v[56:59], v[224:239]
    s_waitcnt vmcnt(2)
    v_cmp_gt_i32 vcc, 0, v93
    s_cbranch_vccnz SWAIT_51
SOK_50:
    s_nop 0
    v_add_f32_dpp v92, v92, v92 quad_perm:[1,0,3,2] row_mask:0xf bank_mask:0xf
    v_add_f32_dpp v93, v93, v93 quad_perm:[1,0,3,2] row_mask:0xf bank_mask:0xf
    v_mfma_f32_32x32x16_bf16 v[240:255], a[180:183], v[56:59], v[240:255]
    s_nop 0
    v_add_f32_dpp v92, v92, v92 quad_perm:[2,3,0,1] row_mask:0xf bank_mask:0xf
    v_add_f32_dpp v93, v93, v93 quad_perm:[2,3,0,1] row_mask:0xf bank_mask:0xf
    s_nop 0
    v_add_f32_dpp v92, v92, v92 row_half_mirror row_mask:0xf bank_mask:0xf
    v_add_f32_dpp v93, v93, v93 row_half_mirror row_mask:0xf bank_mask:0xf
    v_mfma_f32_32x32x16_bf16 v[224:239], a[184:187], v[60:63], v[224:239]
    v_mul_f32 v92, 0x3b000000, v92
    v_mul_f32 v93, 0x3b000000, v93
    v_fma_f32 v93, -v92, v92, v93
    v_max_f32 v93, 0, v93
    v_cvt_pk_bf16_f32 v94, v92, v93
    v_lshlrev_b32 v92, 16, v94
    v_mfma_f32_32x32x16_bf16 v[240:255], a[188:191], v[60:63], v[240:255]
    v_and_b32 v93, 0xffff0000, v94
    v_add_f32 v93, 0x3727c5ac, v93
    v_cvt_pk_bf16_f32 v94, v93, v93
    v_lshlrev_b32 v93, 16, v94
    v_sqrt_f32 v93, v93
    s_nop 0
    v_mfma_f32_32x32x16_bf16 v[224:239], a[192:195], v[16:19], v[224:239]
    v_cvt_pk_bf16_f32 v94, v93, v93
    v_lshlrev_b32 v93, 16, v94
    v_rcp_f32 v93, v93
    s_nop 0
    v_mul_f32 v92, -v92, v93
    v_fma_f32 v96, v72, v93, v92
    v_mfma_f32_32x32x16_bf16 v[224:239], a[200:203], v[20:23], v[224:239]
    v_fma_f32 v97, v73, v93, v92
    v_fma_f32 v98, v74, v93, v92
    v_fma_f32 v99, v75, v93, v92
    v_fmac_f32 v72, v96, v80
    v_fmac_f32 v73, v97, v81
    v_fmac_f32 v74, v98, v82
    s_waitcnt vmcnt(1)
    v_mfma_f32_32x32x16_bf16 v[224:239], a[208:211], v[24:27], v[224:239]
    v_fmac_f32 v75, v99, v83
    v_fma_f32 v96, v76, v93, v92
    v_fma_f32 v97, v77, v93, v92
    v_fma_f32 v98, v78, v93, v92
    v_fma_f32 v99, v79, v93, v92
    v_fmac_f32 v76, v96, v84
    s_waitcnt vmcnt(0)
    v_mfma_f32_32x32x16_bf16 v[224:239], a[216:219], v[28:31], v[224:239]
    v_fmac_f32 v77, v97, v85
    v_fmac_f32 v78, v98, v86
    v_fmac_f32 v79, v99, v87
    v_cvt_pk_bf16_f32 v96, v72, v73
    v_cvt_pk_bf16_f32 v97, v74, v75
    v_cvt_pk_bf16_f32 v98, v76, v77
    v_mfma_f32_32x32x16_bf16 v[240:255], a[196:199], v[16:19], v[240:255]
    v_cvt_pk_bf16_f32 v99, v78, v79
    buffer_store_dwordx4 v[96:99], v12, s[52:55], s28 offen
    v_lshlrev_b32 v72, 16, v96
    v_and_b32 v76, 0xffff0000, v96
    v_lshlrev_b32 v73, 16, v97
    v_mfma_f32_32x32x16_bf16 v[240:255], a[204:207], v[20:23], v[240:255]
    v_and_b32 v77, 0xffff0000, v97
    v_lshlrev_b32 v74, 16, v98
    v_and_b32 v78, 0xffff0000, v98
    v_lshlrev_b32 v75, 16, v99
    v_and_b32 v79, 0xffff0000, v99
    v_mfma_f32_32x32x16_bf16 v[240:255], a[212:215], v[24:27], v[240:255]
    ds_write_b128 v2, v[224:227] offset:0
    ds_write_b128 v2, v[228:231] offset:4352
    v_mfma_f32_32x32x16_bf16 v[240:255], a[220:223], v[28:31], v[240:255]
    ds_write_b128 v2, v[232:235] offset:1088
    ds_write_b128 v2, v[236:239] offset:5440
    v_add_f32 v90, v72, v73
    v_mul_f32 v91, v72, v72
    v_fmac_f32 v91, v73, v73
    v_add_f32 v90, v90, v74
    v_fmac_f32 v91, v74, v74
    v_add_f32 v90, v90, v75
    v_fmac_f32 v91, v75, v75
    v_add_f32 v90, v90, v76
    v_fmac_f32 v91, v76, v76
    v_add_f32 v90, v90, v77
    s_nop 0
    ds_write_b128 v2, v[240:243] offset:2176
    ds_write_b128 v2, v[244:247] offset:6528
    ds_write_b128 v2, v[248:251] offset:3264
    ds_write_b128 v2, v[252:255] offset:7616
    v_fmac_f32 v91, v77, v77
    v_add_f32 v90, v90, v78
    v_mov_b32 v7, 3
    s_waitcnt vmcnt(0)
    buffer_store_dword v7, v9, s[52:55], s68 offen offset:512
    v_lshrrev_b32 v13, 2, v3
    v_and_b32 v13, 60, v13
    s_waitcnt lgkmcnt(0)
    s_barrier
    ds_read_b128 v[16:19], v10 offset:0
    ds_read_b128 v[20:23], v10 offset:4352
    ds_read_b128 v[24:27], v10 offset:8704
    ds_read_b128 v[28:31], v10 offset:13056
    ds_read_b128 v[32:35], v10 offset:17408
    ds_read_b128 v[36:39], v10 offset:21760
    ds_read_b128 v[40:43], v10 offset:26112
    ds_read_b128 v[44:47], v10 offset:30464
    buffer_load_dword v14, v13, s[52:55], s69 offen offset:512 sc1
    v_fmac_f32 v91, v78, v78
    v_add_f32 v90, v90, v79
    v_fmac_f32 v91, v79, v79
    s_nop 0
    v_add_f32_dpp v90, v90, v90 quad_perm:[1,0,3,2] row_mask:0xf bank_mask:0xf
    v_add_f32_dpp v91, v91, v91 quad_perm:[1,0,3,2] row_mask:0xf bank_mask:0xf
    s_nop 0
    v_add_f32_dpp v90, v90, v90 quad_perm:[2,3,0,1] row_mask:0xf bank_mask:0xf
    v_add_f32_dpp v91, v91, v91 quad_perm:[2,3,0,1] row_mask:0xf bank_mask:0xf
    s_nop 0
    v_add_f32_dpp v90, v90, v90 row_half_mirror row_mask:0xf bank_mask:0xf
    v_add_f32_dpp v91, v91, v91 row_half_mirror row_mask:0xf bank_mask:0xf
    v_and_b32 v91, 0x7fffffff, v91
    buffer_store_dwordx2 v[90:91], v11, s[52:55], s9 offen offset:0
    v_accvgpr_write_b32 a224, v96
    v_accvgpr_write_b32 a225, v97
    v_accvgpr_write_b32 a226, v98
    v_accvgpr_write_b32 a227, v99
    s_waitcnt lgkmcnt(4)
    v_pk_add_f32 v[16:17], v[16:17], v[24:25]
    v_pk_add_f32 v[18:19], v[18:19], v[26:27]
    v_pk_add_f32 v[20:21], v[20:21], v[28:29]
    v_pk_add_f32 v[22:23], v[22:23], v[30:31]
    s_waitcnt lgkmcnt(0)
    v_pk_add_f32 v[32:33], v[32:33], v[40:41]
    v_pk_add_f32 v[34:35], v[34:35], v[42:43]
    v_pk_add_f32 v[36:37], v[36:37], v[44:45]
    v_pk_add_f32 v[38:39], v[38:39], v[46:47]
    v_pk_add_f32 v[16:17], v[16:17], v[32:33]
    v_pk_add_f32 v[18:19], v[18:19], v[34:35]
    v_pk_add_f32 v[20:21], v[20:21], v[36:37]
    v_pk_add_f32 v[22:23], v[22:23], v[38:39]
    v_pk_fma_f32 v[100:101], v[16:17], v[116:117], v[100:101] op_sel_hi:[1,0,1]
    v_pk_fma_f32 v[102:103], v[18:19], v[116:117], v[102:103] op_sel_hi:[1,0,1]
    v_pk_fma_f32 v[104:105], v[20:21], v[116:117], v[104:105] op_sel_hi:[1,0,1]
    v_pk_fma_f32 v[106:107], v[22:23], v[116:117], v[106:107] op_sel_hi:[1,0,1]
    v_pk_add_f32 v[120:121], v[100:101], v[102:103]
    v_pk_mul_f32 v[122:123], v[100:101], v[100:101]
    v_pk_fma_f32 v[122:123], v[102:103], v[102:103], v[122:123]
    v_pk_add_f32 v[120:121], v[120:121], v[104:105]
    v_pk_fma_f32 v[122:123], v[104:105], v[104:105], v[122:123]
    v_pk_add_f32 v[120:121], v[120:121], v[106:107]
    v_pk_fma_f32 v[122:123], v[106:107], v[106:107], v[122:123]
    v_add_f32 v118, v120, v121
    v_add_f32 v119, v122, v123
    s_nop 0
    v_add_f32_dpp v118, v118, v118 quad_perm:[1,0,3,2] row_mask:0xf bank_mask:0xf
    v_add_f32_dpp v119, v119, v119 quad_perm:[1,0,3,2] row_mask:0xf bank_mask:0xf
    s_nop 0
    v_add_f32_dpp v118, v118, v118 quad_perm:[2,3,0,1] row_mask:0xf bank_mask:0xf
    v_add_f32_dpp v119, v119, v119 quad_perm:[2,3,0,1] row_mask:0xf bank_mask:0xf
    s_nop 0
    v_add_f32_dpp v118, v118, v118 row_half_mirror row_mask:0xf bank_mask:0xf
    v_add_f32_dpp v119, v119, v119 row_half_mirror row_mask:0xf bank_mask:0xf
    v_and_b32 v119, 0x7fffffff, v119
    buffer_store_dwordx2 v[118:119], v11, s[52:55], s7 offen offset:1024
    s_waitcnt vmcnt(2)
    v_cmp_gt_u32 vcc, 3, v14
    s_cbranch_vccnz FWAIT_54
FOK_53:
    buffer_load_dwordx2 v[120:121], v5, s[52:55], s7 offen offset:1024 sc1
    s_add_u32 s30, s46, 0
    buffer_load_dwordx4 v[128:131], v3, s[52:55], s30 offen offset:0 sc1
    buffer_load_dwordx4 v[132:135], v3, s[52:55], s30 offen offset:1024 sc1
    buffer_load_dwordx4 v[136:139], v3, s[52:55], s30 offen offset:2048 sc1
    buffer_load_dwordx4 v[140:143], v3, s[52:55], s30 offen offset:3072 sc1
    s_add_u32 s30, s46, 4096
    buffer_load_dwordx4 v[144:147], v3, s[52:55], s30 offen offset:0 sc1
    buffer_load_dwordx4 v[148:151], v3, s[52:55], s30 offen offset:1024 sc1
    ds_read_b128 v[16:19], v3 offset:0
    ds_read_b128 v[20:23], v3 offset:1024
    ds_read_b128 v[24:27], v3 offset:2048
    ds_read_b128 v[28:31], v3 offset:3072
    ds_read_b128 v[32:35], v3 offset:4096
    ds_read_b128 v[36:39], v3 offset:5120
    ds_read_b128 v[40:43], v3 offset:6144
    ds_read_b128 v[44:47], v3 offset:7168
    ds_read_b128 v[48:51], v3 offset:8192
    ds_read_b128 v[52:55], v3 offset:9216
    ds_read_b128 v[56:59], v3 offset:10240
    s_waitcnt vmcnt(6)
    v_cmp_gt_i32 vcc, 0, v121
    s_cbranch_vccnz SWAIT_56
SOK_55:
    s_nop 0
    v_add_f32_dpp v120, v120, v120 quad_perm:[1,0,3,2] row_mask:0xf bank_mask:0xf
    v_add_f32_dpp v121, v121, v121 quad_perm:[1,0,3,2] row_mask:0xf bank_mask:0xf
    s_nop 0
    v_add_f32_dpp v120, v120, v120 quad_perm:[2,3,0,1] row_mask:0xf bank_mask:0xf
    v_add_f32_dpp v121, v121, v121 quad_perm:[2,3,0,1] row_mask:0xf bank_mask:0xf
    s_nop 0
    v_add_f32_dpp v120, v120, v120 row_half_mirror row_mask:0xf bank_mask:0xf
    v_add_f32_dpp v121, v121, v121 row_half_mirror row_mask:0xf bank_mask:0xf
    v_mul_f32 v120, 0x3b000000, v120
    v_mul_f32 v121, 0x3b000000, v121
    v_fma_f32 v121, -v120, v120, v121
    v_max_f32 v121, 0, v121
    v_cvt_pk_bf16_f32 v122, v120, v121
    v_lshlrev_b32 v120, 16, v122
    v_and_b32 v121, 0xffff0000, v122
    v_add_f32 v121, 0x3727c5ac, v121
    v_cvt_pk_bf16_f32 v122, v121, v121
    v_lshlrev_b32 v121, 16, v122
    v_sqrt_f32 v121, v121
    s_nop 0
    v_cvt_pk_bf16_f32 v122, v121, v121
    v_lshlrev_b32 v121, 16, v122
    v_rcp_f32 v121, v121
    s_nop 0
    v_mul_f32 v120, -v120, v121
    v_pk_fma_f32 v[124:125], v[100:101], v[120:121], v[120:121] op_sel:[0,1,0] op_sel_hi:[1,1,0]
    v_pk_fma_f32 v[126:127], v[102:103], v[120:121], v[120:121] op_sel:[0,1,0] op_sel_hi:[1,1,0]
    v_pk_fma_f32 v[100:101], v[124:125], v[108:109], v[100:101]
    v_pk_fma_f32 v[102:103], v[126:127], v[110:111], v[102:103]
    v_pk_fma_f32 v[124:125], v[104:105], v[120:121], v[120:121] op_sel:[0,1,0] op_sel_hi:[1,1,0]
    v_pk_fma_f32 v[126:127], v[106:107], v[120:121], v[120:121] op_sel:[0,1,0] op_sel_hi:[1,1,0]
    v_pk_fma_f32 v[104:105], v[124:125], v[112:113], v[104:105]
    v_pk_fma_f32 v[106:107], v[126:127], v[114:115], v[106:107]
    v_cvt_pk_bf16_f32 v124, v100, v101
    v_cvt_pk_bf16_f32 v125, v102, v103
    v_cvt_pk_bf16_f32 v126, v104, v105
    v_cvt_pk_bf16_f32 v127, v106, v107
    buffer_store_dwordx4 v[124:127], v12, s[52:55], s33 offen
    s_waitcnt vmcnt(6) lgkmcnt(7)
    v_mfma_f32_16x16x32_bf16 v[72:75], v[16:19], v[128:131], 0
    ds_read_b128 v[60:63], v3 offset:11264
    v_lshlrev_b32 v100, 16, v124
    v_mfma_f32_16x16x32_bf16 v[76:79], v[20:23], v[128:131], 0
    ds_read_b128 v[16:19], v3 offset:12288
    buffer_load_dwordx4 v[152:155], v3, s[52:55], s30 offen offset:2048 sc1
    v_and_b32 v104, 0xffff0000, v124
    v_mfma_f32_16x16x32_bf16 v[80:83], v[24:27], v[128:131], 0
    ds_read_b128 v[20:23], v3 offset:13312
    v_lshlrev_b32 v101, 16, v125
    v_mfma_f32_16x16x32_bf16 v[84:87], v[28:31], v[128:131], 0
    ds_read_b128 v[24:27], v3 offset:14336
    v_and_b32 v105, 0xffff0000, v125
    s_waitcnt lgkmcnt(7)
    v_mfma_f32_16x16x32_bf16 v[88:91], v[32:35], v[128:131], 0
    ds_read_b128 v[28:31], v3 offset:15360
    v_lshlrev_b32 v102, 16, v126
    v_mfma_f32_16x16x32_bf16 v[92:95], v[36:39], v[128:131], 0
    ds_read_b128 v[32:35], v3 offset:16384
    buffer_load_dwordx4 v[156:159], v3, s[52:55], s30 offen offset:3072 sc1
    v_and_b32 v106, 0xffff0000, v126
    v_mfma_f32_16x16x32_bf16 v[96:99], v[40:43], v[128:131], 0
    ds_read_b128 v[36:39], v3 offset:17408
    v_lshlrev_b32 v103, 16, v127
    s_waitcnt vmcnt(7)
    v_mfma_f32_16x16x32_bf16 v[72:75], v[44:47], v[132:135], v[72:75]
    ds_read_b128 v[40:43], v3 offset:18432
    v_and_b32 v107, 0xffff0000, v127
    s_waitcnt lgkmcnt(7)
    v_mfma_f32_16x16x32_bf16 v[76:79], v[48:51], v[132:135], v[76:79]
    ds_read_b128 v[44:47], v3 offset:19456
    v_add_f32 v118, v100, v101
    v_mfma_f32_16x16x32_bf16 v[80:83], v[52:55], v[132:135], v[80:83]
    ds_read_b128 v[48:51], v3 offset:20480
    s_add_u32 s30, s46, 8192
    buffer_load_dwordx4 v[160:163], v3, s[52:55], s30 offen offset:0 sc1
    v_mul_f32 v119, v100, v100
    v_mfma_f32_16x16x32_bf16 v[84:87], v[56:59], v[132:135], v[84:87]
    ds_read_b128 v[52:55], v3 offset:21504
    v_fmac_f32 v119, v101, v101
    v_mfma_f32_16x16x32_bf16 v[88:91], v[60:63], v[132:135], v[88:91]
    ds_read_b128 v[56:59], v3 offset:22528
    v_add_f32 v118, v118, v102
    s_waitcnt lgkmcnt(7)
    v_mfma_f32_16x16x32_bf16 v[92:95], v[16:19], v[132:135], v[92:95]
    ds_read_b128 v[60:63], v3 offset:23552
    v_fmac_f32 v119, v102, v102
    v_mfma_f32_16x16x32_bf16 v[96:99], v[20:23], v[132:135], v[96:99]
    ds_read_b128 v[16:19], v3 offset:24576
    buffer_load_dwordx4 v[164:167], v3, s[52:55], s30 offen offset:1024 sc1
    v_add_f32 v118, v118, v103
    s_waitcnt vmcnt(8)
    v_mfma_f32_16x16x32_bf16 v[72:75], v[24:27], v[136:139], v[72:75]
    ds_read_b128 v[20:23], v3 offset:25600
    v_mov_b32 v7, 4
    v_mfma_f32_16x16x32_bf16 v[76:79], v[28:31], v[136:139], v[76:79]
    ds_read_b128 v[24:27], v3 offset:26624
    s_waitcnt vmcnt(4)
    s_waitcnt lgkmcnt(7)
    v_mfma_f32_16x16x32_bf16 v[80:83], v[32:35], v[136:139], v[80:83]
    ds_read_b128 v[28:31], v3 offset:27648
    buffer_store_dword v7, v9, s[52:55], s68 offen offset:512
    v_mfma_f32_16x16x32_bf16 v[84:87], v[36:39], v[136:139], v[84:87]
    ds_read_b128 v[32:35], v3 offset:28672
    buffer_load_dwordx4 v[168:171], v3, s[52:55], s30 offen offset:2048 sc1
    v_fmac_f32 v119, v103, v103
    v_mfma_f32_16x16x32_bf16 v[88:91], v[40:43], v[136:139], v[88:91]
    ds_read_b128 v[36:39], v3 offset:29696
    v_add_f32 v118, v118, v104
    v_mfma_f32_16x16x32_bf16 v[92:95], v[44:47], v[136:139], v[92:95]
    ds_read_b128 v[40:43], v3 offset:30720
    v_fmac_f32 v119, v104, v104
    s_waitcnt lgkmcnt(7)
    v_mfma_f32_16x16x32_bf16 v[96:99], v[48:51], v[136:139], v[96:99]
    ds_read_b128 v[44:47], v3 offset:31744
    v_add_f32 v118, v118, v105
    v_mfma_f32_16x16x32_bf16 v[72:75], v[52:55], v[140:143], v[72:75]
    ds_read_b128 v[48:51], v3 offset:32768
    buffer_load_dwordx4 v[172:175], v3, s[52:55], s30 offen offset:3072 sc1
    v_fmac_f32 v119, v105, v105
    v_mfma_f32_16x16x32_bf16 v[76:79], v[56:59], v[140:143], v[76:79]
    ds_read_b128 v[52:55], v3 offset:33792
    v_add_f32 v118, v118, v106
    v_mfma_f32_16x16x32_bf16 v[80:83], v[60:63], v[140:143], v[80:83]
    ds_read_b128 v[56:59], v3 offset:34816
    v_fmac_f32 v119, v106, v106
    s_waitcnt lgkmcnt(7)
    v_mfma_f32_16x16x32_bf16 v[84:87], v[16:19], v[140:143], v[84:87]
    ds_read_b128 v[60:63], v3 offset:35840
    v_add_f32 v118, v118, v107
    v_mfma_f32_16x16x32_bf16 v[88:91], v[20:23], v[140:143], v[88:91]
    ds_read_b128 v[16:19], v3 offset:36864
    s_add_u32 s30, s46, 12288
    buffer_load_dwordx4 v[176:179], v3, s[52:55], s30 offen offset:0 sc1
    v_fmac_f32 v119, v107, v107
    v_mfma_f32_16x16x32_bf16 v[92:95], v[24:27], v[140:143], v[92:95]
    ds_read_b128 v[20:23], v3 offset:37888
    s_nop 0
    v_mfma_f32_16x16x32_bf16 v[96:99], v[28:31], v[140:143], v[96:99]
    ds_read_b128 v[24:27], v3 offset:38912
    v_add_f32_dpp v118, v118, v118 quad_perm:[1,0,3,2] row_mask:0xf bank_mask:0xf
    s_waitcnt lgkmcnt(7)
    v_mfma_f32_16x16x32_bf16 v[72:75], v[32:35], v[144:147], v[72:75]
    ds_read_b128 v[28:31], v3 offset:39936
    v_add_f32_dpp v119, v119, v119 quad_perm:[1,0,3,2] row_mask:0xf bank_mask:0xf
    v_mfma_f32_16x16x32_bf16 v[76:79], v[36:39], v[144:147], v[76:79]
    ds_read_b128 v[32:35], v3 offset:40960
    buffer_load_dwordx4 v[180:183], v3, s[52:55], s30 offen offset:1024 sc1
    s_nop 0
    v_mfma_f32_16x16x32_bf16 v[80:83], v[40:43], v[144:147], v[80:83]
    ds_read_b128 v[36:39], v3 offset:41984
    v_add_f32_dpp v118, v118, v118 quad_perm:[2,3,0,1] row_mask:0xf bank_mask:0xf
    v_mfma_f32_16x16x32_bf16 v[84:87], v[44:47], v[144:147], v[84:87]
    ds_read_b128 v[40:43], v3 offset:43008
    v_add_f32_dpp v119, v119, v119 quad_perm:[2,3,0,1] row_mask:0xf bank_mask:0xf
    s_waitcnt lgkmcnt(7)
    v_mfma_f32_16x16x32_bf16 v[88:91], v[48:51], v[144:147], v[88:91]
    ds_read_b128 v[44:47], v3 offset:44032
    s_nop 0
    v_mfma_f32_16x16x32_bf16 v[92:95], v[52:55], v[144:147], v[92:95]
    ds_read_b128 v[48:51], v3 offset:45056
    buffer_load_dwordx4 v[184:187], v3, s[52:55], s30 offen offset:2048 sc1
    v_add_f32_dpp v118, v118, v118 row_half_mirror row_mask:0xf bank_mask:0xf
    v_mfma_f32_16x16x32_bf16 v[96:99], v[56:59], v[144:147], v[96:99]
    ds_read_b128 v[52:55], v3 offset:46080
    v_add_f32_dpp v119, v119, v119 row_half_mirror row_mask:0xf bank_mask:0xf
    v_mfma_f32_16x16x32_bf16 v[72:75], v[60:63], v[148:151], v[72:75]
    ds_read_b128 v[56:59], v3 offset:47104
    v_and_b32 v119, 0x7fffffff, v119
    s_waitcnt lgkmcnt(7)
    v_mfma_f32_16x16x32_bf16 v[76:79], v[16:19], v[148:151], v[76:79]
    ds_read_b128 v[60:63], v3 offset:48128
    buffer_store_dwordx2 v[118:119], v11, s[52:55], s9 offen offset:1024
    v_mfma_f32_16x16x32_bf16 v[80:83], v[20:23], v[148:151], v[80:83]
    ds_read_b128 v[16:19], v3 offset:49152
    buffer_load_dwordx4 v[188:191], v3, s[52:55], s30 offen offset:3072 sc1
    v_accvgpr_write_b32 a228, v124
    v_mfma_f32_16x16x32_bf16 v[84:87], v[24:27], v[148:151], v[84:87]
    ds_read_b128 v[20:23], v3 offset:50176
    v_accvgpr_write_b32 a229, v125
    v_mfma_f32_16x16x32_bf16 v[88:91], v[28:31], v[148:151], v[88:91]
    ds_read_b128 v[24:27], v3 offset:51200
    v_accvgpr_write_b32 a230, v126
    s_waitcnt lgkmcnt(7)
    v_mfma_f32_16x16x32_bf16 v[92:95], v[32:35], v[148:151], v[92:95]
    ds_read_b128 v[28:31], v3 offset:52224
    v_accvgpr_write_b32 a231, v127
    v_mfma_f32_16x16x32_bf16 v[96:99], v[36:39], v[148:151], v[96:99]
    ds_read_b128 v[32:35], v3 offset:53248
    buffer_load_dwordx4 v[68:71], v4, s[52:55], s8 offen offset:0 sc1
    s_waitcnt vmcnt(12)
    v_mfma_f32_16x16x32_bf16 v[72:75], v[40:43], v[152:155], v[72:75]
    ds_read_b128 v[36:39], v3 offset:54272
    v_mfma_f32_16x16x32_bf16 v[76:79], v[44:47], v[152:155], v[76:79]
    ds_read_b128 v[40:43], v3 offset:55296
    s_waitcnt lgkmcnt(7)
    v_mfma_f32_16x16x32_bf16 v[80:83], v[48:51], v[152:155], v[80:83]
    ds_read_b128 v[44:47], v3 offset:56320
    v_mfma_f32_16x16x32_bf16 v[84:87], v[52:55], v[152:155], v[84:87]
    ds_read_b128 v[48:51], v6 offset:0
    v_mfma_f32_16x16x32_bf16 v[88:91], v[56:59], v[152:155], v[88:91]
    ds_read_b128 v[52:55], v6 offset:1024
    v_mfma_f32_16x16x32_bf16 v[92:95], v[60:63], v[152:155], v[92:95]
    ds_read_b128 v[56:59], v6 offset:2048
    s_waitcnt lgkmcnt(7)
    v_mfma_f32_16x16x32_bf16 v[96:99], v[16:19], v[152:155], v[96:99]
    ds_read_b128 v[60:63], v6 offset:3072
    s_waitcnt vmcnt(11)
    v_mfma_f32_16x16x32_bf16 v[72:75], v[20:23], v[156:159], v[72:75]
    ds_read_b128 v[16:19], v6 offset:4096
    v_mfma_f32_16x16x32_bf16 v[76:79], v[24:27], v[156:159], v[76:79]
    ds_read_b128 v[20:23], v6 offset:5120
    v_mfma_f32_16x16x32_bf16 v[80:83], v[28:31], v[156:159], v[80:83]
    ds_read_b128 v[24:27], v6 offset:6144
    s_waitcnt lgkmcnt(7)
    v_mfma_f32_16x16x32_bf16 v[84:87], v[32:35], v[156:159], v[84:87]
    ds_read_b128 v[28:31], v6 offset:7168
    v_mfma_f32_16x16x32_bf16 v[88:91], v[36:39], v[156:159], v[88:91]
    ds_read_b128 v[32:35], v6 offset:8192
    v_mfma_f32_16x16x32_bf16 v[92:95], v[40:43], v[156:159], v[92:95]
    ds_read_b128 v[36:39], v6 offset:9216
    v_mfma_f32_16x16x32_bf16 v[96:99], v[44:47], v[156:159], v[96:99]
    ds_read_b128 v[40:43], v6 offset:10240
    s_waitcnt vmcnt(10) lgkmcnt(7)
    v_mfma_f32_16x16x32_bf16 v[72:75], v[48:51], v[160:163], v[72:75]
    ds_read_b128 v[44:47], v6 offset:11264
    v_mfma_f32_16x16x32_bf16 v[76:79], v[52:55], v[160:163], v[76:79]
    ds_read_b128 v[48:51], v6 offset:12288
    v_mfma_f32_16x16x32_bf16 v[80:83], v[56:59], v[160:163], v[80:83]
    ds_read_b128 v[52:55], v6 offset:13312
    v_mfma_f32_16x16x32_bf16 v[84:87], v[60:63], v[160:163], v[84:87]
    ds_read_b128 v[56:59], v6 offset:14336
    s_waitcnt lgkmcnt(7)
    v_mfma_f32_16x16x32_bf16 v[88:91], v[16:19], v[160:163], v[88:91]
    ds_read_b128 v[60:63], v6 offset:15360
    v_mfma_f32_16x16x32_bf16 v[92:95], v[20:23], v[160:163], v[92:95]
    ds_read_b128 v[16:19], v6 offset:16384
    v_mfma_f32_16x16x32_bf16 v[96:99], v[24:27], v[160:163], v[96:99]
    ds_read_b128 v[20:23], v6 offset:17408
    s_waitcnt vmcnt(9)
    v_mfma_f32_16x16x32_bf16 v[72:75], v[28:31], v[164:167], v[72:75]
    ds_read_b128 v[24:27], v6 offset:18432
    s_waitcnt lgkmcnt(7)
    v_mfma_f32_16x16x32_bf16 v[76:79], v[32:35], v[164:167], v[76:79]
    ds_read_b128 v[28:31], v6 offset:19456
    v_mfma_f32_16x16x32_bf16 v[80:83], v[36:39], v[164:167], v[80:83]
    ds_read_b128 v[32:35], v6 offset:20480
    v_mfma_f32_16x16x32_bf16 v[84:87], v[40:43], v[164:167], v[84:87]
    ds_read_b128 v[36:39], v6 offset:21504
    buffer_load_dword v14, v13, s[52:55], s69 offen offset:512 sc1
    v_mfma_f32_16x16x32_bf16 v[88:91], v[44:47], v[164:167], v[88:91]
    ds_read_b128 v[40:43], v6 offset:22528
    s_waitcnt lgkmcnt(7)
    v_mfma_f32_16x16x32_bf16 v[92:95], v[48:51], v[164:167], v[92:95]
    ds_read_b128 v[44:47], v6 offset:23552
    v_mfma_f32_16x16x32_bf16 v[96:99], v[52:55], v[164:167], v[96:99]
    ds_read_b128 v[48:51], v6 offset:24576
    s_waitcnt vmcnt(8)
    v_mfma_f32_16x16x32_bf16 v[72:75], v[56:59], v[168:171], v[72:75]
    ds_read_b128 v[52:55], v6 offset:25600
    v_mfma_f32_16x16x32_bf16 v[76:79], v[60:63], v[168:171], v[76:79]
    ds_read_b128 v[56:59], v6 offset:26624
    s_waitcnt lgkmcnt(7)
    v_mfma_f32_16x16x32_bf16 v[80:83], v[16:19], v[168:171], v[80:83]
    ds_read_b128 v[60:63], v6 offset:27648
    v_mfma_f32_16x16x32_bf16 v[84:87], v[20:23], v[168:171], v[84:87]
    ds_read_b128 v[16:19], v6 offset:28672
    v_mfma_f32_16x16x32_bf16 v[88:91], v[24:27], v[168:171], v[88:91]
    ds_read_b128 v[20:23], v6 offset:29696
    v_mfma_f32_16x16x32_bf16 v[92:95], v[28:31], v[168:171], v[92:95]
    ds_read_b128 v[24:27], v6 offset:30720
    s_waitcnt lgkmcnt(7)
    v_mfma_f32_16x16x32_bf16 v[96:99], v[32:35], v[168:171], v[96:99]
    ds_read_b128 v[28:31], v6 offset:31744
    s_waitcnt vmcnt(7)
    v_mfma_f32_16x16x32_bf16 v[72:75], v[36:39], v[172:175], v[72:75]
    ds_read_b128 v[32:35], v6 offset:32768
    v_mfma_f32_16x16x32_bf16 v[76:79], v[40:43], v[172:175], v[76:79]
    ds_read_b128 v[36:39], v6 offset:33792
    v_mfma_f32_16x16x32_bf16 v[80:83], v[44:47], v[172:175], v[80:83]
    ds_read_b128 v[40:43], v6 offset:34816
    s_waitcnt lgkmcnt(7)
    v_mfma_f32_16x16x32_bf16 v[84:87], v[48:51], v[172:175], v[84:87]
    ds_read_b128 v[44:47], v6 offset:35840
    v_mfma_f32_16x16x32_bf16 v[88:91], v[52:55], v[172:175], v[88:91]
    ds_read_b128 v[48:51], v6 offset:36864
    s_waitcnt vmcnt(0)
    v_cmp_gt_u32 vcc, 4, v14
    s_cbranch_vccnz FWAIT_59
FOK_58:
    v_mfma_f32_16x16x32_bf16 v[92:95], v[56:59], v[172:175], v[92:95]
    ds_read_b128 v[52:55], v6 offset:37888
    s_add_u32 s31, s46, 16384
    buffer_load_dwordx4 v[192:195], v3, s[52:55], s31 offen offset:0 sc1
    v_mfma_f32_16x16x32_bf16 v[96:99], v[60:63], v[172:175], v[96:99]
    ds_read_b128 v[56:59], v6 offset:38912
    v_or_b32 v64, v69, v71
    v_cmp_gt_i32 vcc, 0, v64
    s_cbranch_vccnz SWAIT_61
SOK_60:
    s_waitcnt lgkmcnt(7)
    v_mfma_f32_16x16x32_bf16 v[72:75], v[16:19], v[176:179], v[72:75]
    ds_read_b128 v[60:63], v6 offset:39936
    v_add_f32 v68, v68, v70
    v_mfma_f32_16x16x32_bf16 v[76:79], v[20:23], v[176:179], v[76:79]
    ds_read_b128 v[16:19], v6 offset:40960
    v_add_f32 v69, v69, v71
    v_mfma_f32_16x16x32_bf16 v[80:83], v[24:27], v[176:179], v[80:83]
    ds_read_b128 v[20:23], v6 offset:41984
    v_mov_b32 v70, v68
    v_mfma_f32_16x16x32_bf16 v[84:87], v[28:31], v[176:179], v[84:87]
    ds_read_b128 v[24:27], v6 offset:43008
    buffer_load_dwordx4 v[196:199], v3, s[52:55], s31 offen offset:1024 sc1
    s_waitcnt lgkmcnt(7)
    v_mfma_f32_16x16x32_bf16 v[88:91], v[32:35], v[176:179], v[88:91]
    ds_read_b128 v[28:31], v6 offset:44032
    v_mov_b32 v71, v69
    v_mfma_f32_16x16x32_bf16 v[92:95], v[36:39], v[176:179], v[92:95]
    ds_read_b128 v[32:35], v6 offset:45056
    s_nop 0
    v_mfma_f32_16x16x32_bf16 v[96:99], v[40:43], v[176:179], v[96:99]
    ds_read_b128 v[36:39], v6 offset:46080
    v_permlane16_swap_b32 v68, v70
    v_mfma_f32_16x16x32_bf16 v[72:75], v[44:47], v[180:183], v[72:75]
    ds_read_b128 v[40:43], v6 offset:47104
    v_permlane16_swap_b32 v69, v71
    s_waitcnt lgkmcnt(7)
    v_mfma_f32_16x16x32_bf16 v[76:79], v[48:51], v[180:183], v[76:79]
    ds_read_b128 v[44:47], v6 offset:48128
    buffer_load_dwordx4 v[200:203], v3, s[52:55], s31 offen offset:2048 sc1
    v_mfma_f32_16x16x32_bf16 v[80:83], v[52:55], v[180:183], v[80:83]
    ds_read_b128 v[48:51], v6 offset:49152
    s_nop 0
    v_mfma_f32_16x16x32_bf16 v[84:87], v[56:59], v[180:183], v[84:87]
    ds_read_b128 v[52:55], v6 offset:50176
    v_add_f32 v68, v68, v70
    v_mfma_f32_16x16x32_bf16 v[88:91], v[60:63], v[180:183], v[88:91]
    ds_read_b128 v[56:59], v6 offset:51200
    v_add_f32 v69, v69, v71
    s_waitcnt lgkmcnt(7)
    v_mfma_f32_16x16x32_bf16 v[92:95], v[16:19], v[180:183], v[92:95]
    ds_read_b128 v[60:63], v6 offset:52224
    v_mov_b32 v70, v68
    v_mfma_f32_16x16x32_bf16 v[96:99], v[20:23], v[180:183], v[96:99]
    ds_read_b128 v[16:19], v6 offset:53248
    buffer_load_dwordx4 v[204:207], v3, s[52:55], s31 offen offset:3072 sc1
    v_mfma_f32_16x16x32_bf16 v[72:75], v[24:27], v[184:187], v[72:75]
    ds_read_b128 v[20:23], v6 offset:54272
    v_mov_b32 v71, v69
    v_mfma_f32_16x16x32_bf16 v[76:79], v[28:31], v[184:187], v[76:79]
    ds_read_b128 v[24:27], v6 offset:55296
    s_nop 0
    s_waitcnt lgkmcnt(7)
    v_mfma_f32_16x16x32_bf16 v[80:83], v[32:35], v[184:187], v[80:83]
    ds_read_b128 v[28:31], v6 offset:56320
    v_permlane32_swap_b32 v68, v70
    v_mfma_f32_16x16x32_bf16 v[84:87], v[36:39], v[184:187], v[84:87]
    ds_read_b128 v[32:35], v3 offset:0
    v_permlane32_swap_b32 v69, v71
    v_mfma_f32_16x16x32_bf16 v[88:91], v[40:43], v[184:187], v[88:91]
    ds_read_b128 v[36:39], v3 offset:1024
    s_add_u32 s31, s46, 20480
    buffer_load_dwordx4 v[208:211], v3, s[52:55], s31 offen offset:0 sc1
    v_mfma_f32_16x16x32_bf16 v[92:95], v[44:47], v[184:187], v[92:95]
    ds_read_b128 v[40:43], v3 offset:2048
    s_nop 0
    s_waitcnt lgkmcnt(7)
    v_mfma_f32_16x16x32_bf16 v[96:99], v[48:51], v[184:187], v[96:99]
    ds_read_b128 v[44:47], v3 offset:3072
    v_add_f32 v68, v68, v70
    v_mfma_f32_16x16x32_bf16 v[72:75], v[52:55], v[188:191], v[72:75]
    ds_read_b128 v[48:51], v3 offset:4096
    v_add_f32 v69, v69, v71
    v_mfma_f32_16x16x32_bf16 v[76:79], v[56:59], v[188:191], v[76:79]
    ds_read_b128 v[52:55], v3 offset:5120
    v_mul_f32 v68, 0x3b000000, v68
    v_mfma_f32_16x16x32_bf16 v[80:83], v[60:63], v[188:191], v[80:83]
    ds_read_b128 v[56:59], v3 offset:6144
    buffer_load_dwordx4 v[212:215], v3, s[52:55], s31 offen offset:1024 sc1
    s_waitcnt lgkmcnt(7)
    v_mfma_f32_16x16x32_bf16 v[84:87], v[16:19], v[188:191], v[84:87]
    ds_read_b128 v[60:63], v3 offset:7168
    v_mul_f32 v69, 0x3b000000, v69
    v_mfma_f32_16x16x32_bf16 v[88:91], v[20:23], v[188:191], v[88:91]
    ds_read_b128 v[16:19], v3 offset:8192
    v_fma_f32 v69, -v68, v68, v69
    v_mfma_f32_16x16x32_bf16 v[92:95], v[24:27], v[188:191], v[92:95]
    ds_read_b128 v[20:23], v3 offset:9216
    v_max_f32 v69, 0, v69
    v_mfma_f32_16x16x32_bf16 v[96:99], v[28:31], v[188:191], v[96:99]
    ds_read_b128 v[24:27], v3 offset:10240
    v_cvt_pk_bf16_f32 v71, v68, v69
    buffer_load_dwordx4 v[216:219], v3, s[52:55], s31 offen offset:2048 sc1
    v_lshlrev_b32 v68, 16, v71
    v_and_b32 v69, 0xffff0000, v71
    v_add_f32 v69, 0x3727c5ac, v69
    v_cvt_pk_bf16_f32 v71, v69, v69
    buffer_load_dwordx4 v[220:223], v3, s[52:55], s31 offen offset:3072 sc1
    v_lshlrev_b32 v69, 16, v71
    v_sqrt_f32 v69, v69
    s_nop 0
    v_cvt_pk_bf16_f32 v71, v69, v69
    v_lshlrev_b32 v70, 16, v71
    v_rcp_f32 v69, v70
    s_nop 0
    v_cvt_pk_bf16_f32 v64, -v68, -v68
    v_cvt_pk_bf16_f32 v65, -v68, v70
    v_mul_f32 v69, v69, v69
    v_cndmask_b32 v64, 0, v64, s[34:35]
    v_cndmask_b32 v65, 0, v65, s[34:35]
    buffer_store_dword v69, v8, s[52:55], s13 offen offset:0
    s_nop 1
    v_mfma_f32_16x16x16_bf16 v[72:75], a[240:241], v[64:65], v[72:75]
    v_mfma_f32_16x16x16_bf16 v[76:79], a[242:243], v[64:65], v[76:79]
    v_mfma_f32_16x16x16_bf16 v[80:83], a[244:245], v[64:65], v[80:83]
    v_mfma_f32_16x16x16_bf16 v[84:87], a[246:247], v[64:65], v[84:87]
    v_mfma_f32_16x16x16_bf16 v[88:91], a[248:249], v[64:65], v[88:91]
    v_mfma_f32_16x16x16_bf16 v[92:95], a[250:251], v[64:65], v[92:95]
    v_mfma_f32_16x16x16_bf16 v[96:99], a[252:253], v[64:65], v[96:99]
    s_waitcnt vmcnt(8) lgkmcnt(7)
    v_mfma_f32_16x16x32_bf16 v[100:103], v[32:35], v[192:195], 0
    ds_read_b128 v[28:31], v3 offset:11264
    v_mfma_f32_16x16x32_bf16 v[104:107], v[36:39], v[192:195], 0
    ds_read_b128 v[32:35], v3 offset:12288
    s_add_u32 s31, s46, 24576
    buffer_load_dwordx4 v[224:227], v3, s[52:55], s31 offen offset:0 sc1
    v_mfma_f32_16x16x32_bf16 v[108:111], v[40:43], v[192:195], 0
    ds_read_b128 v[36:39], v3 offset:13312
    v_mfma_f32_16x16x32_bf16 v[112:115], v[44:47], v[192:195], 0
    ds_read_b128 v[40:43], v3 offset:14336
    v_mul_f32 v72, v72, abs(v72)
    v_mul_f32 v73, v73, abs(v73)
    v_mul_f32 v74, v74, abs(v74)
    v_mul_f32 v75, v75, abs(v75)
    v_mul_f32 v76, v76, abs(v76)
    v_mul_f32 v77, v77, abs(v77)
    s_waitcnt lgkmcnt(7)
    v_mfma_f32_16x16x32_bf16 v[116:119], v[48:51], v[192:195], 0
    ds_read_b128 v[44:47], v3 offset:15360
    v_mul_f32 v78, v78, abs(v78)
    v_mul_f32 v79, v79, abs(v79)
    v_cvt_pk_bf16_f32 v72, v72, v73
    v_cvt_pk_bf16_f32 v73, v74, v75
    v_cvt_pk_bf16_f32 v74, v76, v77
    v_cvt_pk_bf16_f32 v75, v78, v79
    v_mfma_f32_16x16x32_bf16 v[120:123], v[52:55], v[192:195], 0
    ds_read_b128 v[48:51], v3 offset:16384
    v_pk_max_i16 v72, v72, 0
    v_pk_max_i16 v73, v73, 0
    v_pk_max_i16 v74, v74, 0
    v_pk_max_i16 v75, v75, 0
    buffer_store_dwordx4 v[72:75], v0, s[52:55], s10 offen offset:0
    v_mul_f32 v80, v80, abs(v80)
    v_mfma_f32_16x16x32_bf16 v[124:127], v[56:59], v[192:195], 0
    ds_read_b128 v[52:55], v3 offset:17408
    buffer_load_dwordx4 v[228:231], v3, s[52:55], s31 offen offset:1024 sc1
    v_mul_f32 v81, v81, abs(v81)
    v_mul_f32 v82, v82, abs(v82)
    v_mul_f32 v83, v83, abs(v83)
    v_mul_f32 v84, v84, abs(v84)
    v_mul_f32 v85, v85, abs(v85)
    v_mul_f32 v86, v86, abs(v86)
    s_waitcnt vmcnt(10)
    v_mfma_f32_16x16x32_bf16 v[100:103], v[60:63], v[196:199], v[100:103]
    ds_read_b128 v[56:59], v3 offset:18432
    v_mul_f32 v87, v87, abs(v87)
    v_cvt_pk_bf16_f32 v80, v80, v81
    v_cvt_pk_bf16_f32 v81, v82, v83
    v_cvt_pk_bf16_f32 v82, v84, v85
    v_cvt_pk_bf16_f32 v83, v86, v87
    v_pk_max_i16 v80, v80, 0
    s_waitcnt lgkmcnt(7)
    v_mfma_f32_16x16x32_bf16 v[104:107], v[16:19], v[196:199], v[104:107]
    ds_read_b128 v[60:63], v3 offset:19456
    v_pk_max_i16 v81, v81, 0
    v_pk_max_i16 v82, v82, 0
    v_pk_max_i16 v83, v83, 0
    buffer_store_dwordx4 v[80:83], v0, s[52:55], s10 offen offset:2048
    v_mul_f32 v88, v88, abs(v88)
    v_mul_f32 v89, v89, abs(v89)
    v_mfma_f32_16x16x32_bf16 v[108:111], v[20:23], v[196:199], v[108:111]
    ds_read_b128 v[16:19], v3 offset:20480
    v_mul_f32 v90, v90, abs(v90)
    v_mul_f32 v91, v91, abs(v91)
    v_mul_f32 v92, v92, abs(v92)
    v_mul_f32 v93, v93, abs(v93)
    v_mul_f32 v94, v94, abs(v94)
    v_mul_f32 v95, v95, abs(v95)
    v_mfma_f32_16x16x32_bf16 v[112:115], v[24:27], v[196:199], v[112:115]
    ds_read_b128 v[20:23], v3 offset:21504
    v_cvt_pk_bf16_f32 v88, v88, v89
    v_cvt_pk_bf16_f32 v89, v90, v91
    v_cvt_pk_bf16_f32 v90, v92, v93
    v_cvt_pk_bf16_f32 v91, v94, v95
    v_pk_max_i16 v88, v88, 0
    v_pk_max_i16 v89, v89, 0
    v_mfma_f32_16x16x32_bf16 v[116:119], v[28:31], v[196:199], v[116:119]
    ds_read_b128 v[24:27], v3 offset:22528
    buffer_load_dwordx4 v[232:235], v3, s[52:55], s31 offen offset:2048 sc1
    v_pk_max_i16 v90, v90, 0
    v_pk_max_i16 v91, v91, 0
    buffer_store_dwordx4 v[88:91], v0, s[52:55], s11 offen offset:0
    v_mul_f32 v96, v96, abs(v96)
    v_mul_f32 v97, v97, abs(v97)
    v_mul_f32 v98, v98, abs(v98)
    s_waitcnt lgkmcnt(7)
    v_mfma_f32_16x16x32_bf16 v[120:123], v[32:35], v[196:199], v[120:123]
    ds_read_b128 v[28:31], v3 offset:23552
    v_mul_f32 v99, v99, abs(v99)
    v_cvt_pk_bf16_f32 v96, v96, v97
    v_cvt_pk_bf16_f32 v97, v98, v99
    v_pk_max_i16 v96, v96, 0
    v_pk_max_i16 v97, v97, 0
    buffer_store_dwordx2 v[96:97], v1, s[52:55], s11 offen offset:2048
    v_mfma_f32_16x16x32_bf16 v[124:127], v[36:39], v[196:199], v[124:127]
    ds_read_b128 v[32:35], v3 offset:24576
    buffer_load_dwordx4 v[68:71], v4, s[52:55], s8 offen offset:1024 sc1
    s_waitcnt vmcnt(14)
    v_mfma_f32_16x16x32_bf16 v[100:103], v[40:43], v[200:203], v[100:103]
    ds_read_b128 v[36:39], v3 offset:25600
    v_lshrrev_b32 v13, 2, v3
    v_mfma_f32_16x16x32_bf16 v[104:107], v[44:47], v[200:203], v[104:107]
    ds_read_b128 v[40:43], v3 offset:26624
    v_and_b32 v13, 28, v13
    s_waitcnt lgkmcnt(7)
    v_mfma_f32_16x16x32_bf16 v[108:111], v[48:51], v[200:203], v[108:111]
    ds_read_b128 v[44:47], v3 offset:27648
    buffer_load_dwordx4 v[236:239], v3, s[52:55], s31 offen offset:3072 sc1
    v_accvgpr_read_b32 v12, a255
    v_mfma_f32_16x16x32_bf16 v[112:115], v[52:55], v[200:203], v[112:115]
    ds_read_b128 v[48:51], v3 offset:28672
    v_mfma_f32_16x16x32_bf16 v[116:119], v[56:59], v[200:203], v[116:119]
    ds_read_b128 v[52:55], v3 offset:29696
    v_mfma_f32_16x16x32_bf16 v[120:123], v[60:63], v[200:203], v[120:123]
    ds_read_b128 v[56:59], v3 offset:30720
    s_waitcnt lgkmcnt(7)
    v_mfma_f32_16x16x32_bf16 v[124:127], v[16:19], v[200:203], v[124:127]
    ds_read_b128 v[60:63], v3 offset:31744
    s_waitcnt vmcnt(14)
    v_mfma_f32_16x16x32_bf16 v[100:103], v[20:23], v[204:207], v[100:103]
    ds_read_b128 v[16:19], v3 offset:32768
    s_add_u32 s31, s46, 28672
    buffer_load_dwordx4 v[240:243], v3, s[52:55], s31 offen offset:0 sc1
    v_mfma_f32_16x16x32_bf16 v[104:107], v[24:27], v[204:207], v[104:107]
    ds_read_b128 v[20:23], v3 offset:33792
    v_mfma_f32_16x16x32_bf16 v[108:111], v[28:31], v[204:207], v[108:111]
    ds_read_b128 v[24:27], v3 offset:34816
    s_waitcnt lgkmcnt(7)
    v_mfma_f32_16x16x32_bf16 v[112:115], v[32:35], v[204:207], v[112:115]
    ds_read_b128 v[28:31], v3 offset:35840
    v_mfma_f32_16x16x32_bf16 v[116:119], v[36:39], v[204:207], v[116:119]
    ds_read_b128 v[32:35], v3 offset:36864
    v_mfma_f32_16x16x32_bf16 v[120:123], v[40:43], v[204:207], v[120:123]
    ds_read_b128 v[36:39], v3 offset:37888
    buffer_load_dwordx4 v[244:247], v3, s[52:55], s31 offen offset:1024 sc1
    v_mfma_f32_16x16x32_bf16 v[124:127], v[44:47], v[204:207], v[124:127]
    ds_read_b128 v[40:43], v3 offset:38912
    s_waitcnt vmcnt(15) lgkmcnt(7)
    v_mfma_f32_16x16x32_bf16 v[100:103], v[48:51], v[208:211], v[100:103]
    ds_read_b128 v[44:47], v3 offset:39936
    v_mfma_f32_16x16x32_bf16 v[104:107], v[52:55], v[208:211], v[104:107]
    ds_read_b128 v[48:51], v3 offset:40960
    v_mfma_f32_16x16x32_bf16 v[108:111], v[56:59], v[208:211], v[108:111]
    ds_read_b128 v[52:55], v3 offset:41984
    v_mfma_f32_16x16x32_bf16 v[112:115], v[60:63], v[208:211], v[112:115]
    ds_read_b128 v[56:59], v3 offset:43008
    buffer_load_dwordx4 v[248:251], v3, s[52:55], s31 offen offset:2048 sc1
    s_waitcnt lgkmcnt(7)
    v_mfma_f32_16x16x32_bf16 v[116:119], v[16:19], v[208:211], v[116:119]
    ds_read_b128 v[60:63], v3 offset:44032
    v_mfma_f32_16x16x32_bf16 v[120:123], v[20:23], v[208:211], v[120:123]
    ds_read_b128 v[16:19], v3 offset:45056
    v_mfma_f32_16x16x32_bf16 v[124:127], v[24:27], v[208:211], v[124:127]
    ds_read_b128 v[20:23], v3 offset:46080
    s_waitcnt vmcnt(15)
    v_mfma_f32_16x16x32_bf16 v[100:103], v[28:31], v[212:215], v[100:103]
    ds_read_b128 v[24:27], v3 offset:47104
    s_waitcnt lgkmcnt(7)
    v_mfma_f32_16x16x32_bf16 v[104:107], v[32:35], v[212:215], v[104:107]
    ds_read_b128 v[28:31], v3 offset:48128
    buffer_load_dwordx4 v[252:255], v3, s[52:55], s31 offen offset:3072 sc1
    v_mfma_f32_16x16x32_bf16 v[108:111], v[36:39], v[212:215], v[108:111]
    ds_read_b128 v[32:35], v3 offset:49152
    v_mov_b32 v7, 1
    v_mfma_f32_16x16x32_bf16 v[112:115], v[40:43], v[212:215], v[112:115]
    ds_read_b128 v[36:39], v3 offset:50176
    s_waitcnt vmcnt(6)
    buffer_store_dword v7, v9, s[52:55], s74 offen offset:256
    v_mfma_f32_16x16x32_bf16 v[116:119], v[44:47], v[212:215], v[116:119]
    ds_read_b128 v[40:43], v3 offset:51200
    s_waitcnt lgkmcnt(7)
    v_mfma_f32_16x16x32_bf16 v[120:123], v[48:51], v[212:215], v[120:123]
    ds_read_b128 v[44:47], v3 offset:52224
    v_mfma_f32_16x16x32_bf16 v[124:127], v[52:55], v[212:215], v[124:127]
    ds_read_b128 v[48:51], v3 offset:53248
    s_waitcnt vmcnt(6)
    v_or_b32 v66, v69, v71
    v_cmp_gt_i32 vcc, 0, v66
    s_cbranch_vccnz SWAIT_64
SOK_63:
    v_mfma_f32_16x16x32_bf16 v[100:103], v[56:59], v[216:219], v[100:103]
    ds_read_b128 v[52:55], v3 offset:54272
    v_add_f32 v68, v68, v70
    v_mfma_f32_16x16x32_bf16 v[104:107], v[60:63], v[216:219], v[104:107]
    ds_read_b128 v[56:59], v3 offset:55296
    v_add_f32 v69, v69, v71
    s_waitcnt lgkmcnt(7)
    v_mfma_f32_16x16x32_bf16 v[108:111], v[16:19], v[216:219], v[108:111]
    ds_read_b128 v[60:63], v3 offset:56320
    v_mov_b32 v70, v68
    v_mfma_f32_16x16x32_bf16 v[112:115], v[20:23], v[216:219], v[112:115]
    ds_read_b128 v[16:19], v6 offset:0
    v_mov_b32 v71, v69
    v_mfma_f32_16x16x32_bf16 v[116:119], v[24:27], v[216:219], v[116:119]
    ds_read_b128 v[20:23], v6 offset:1024
    s_nop 0
    v_mfma_f32_16x16x32_bf16 v[120:123], v[28:31], v[216:219], v[120:123]
    ds_read_b128 v[24:27], v6 offset:2048
    v_permlane16_swap_b32 v68, v70
    s_waitcnt lgkmcnt(7)
    v_mfma_f32_16x16x32_bf16 v[124:127], v[32:35], v[216:219], v[124:127]
    ds_read_b128 v[28:31], v6 offset:3072
    v_permlane16_swap_b32 v69, v71
    v_mfma_f32_16x16x32_bf16 v[100:103], v[36:39], v[220:223], v[100:103]
    ds_read_b128 v[32:35], v6 offset:4096
    s_nop 0
    v_mfma_f32_16x16x32_bf16 v[104:107], v[40:43], v[220:223], v[104:107]
    ds_read_b128 v[36:39], v6 offset:5120
    v_add_f32 v68, v68, v70
    v_mfma_f32_16x16x32_bf16 v[108:111], v[44:47], v[220:223], v[108:111]
    ds_read_b128 v[40:43], v6 offset:6144
    v_add_f32 v69, v69, v71
    s_waitcnt lgkmcnt(7)
    v_mfma_f32_16x16x32_bf16 v[112:115], v[48:51], v[220:223], v[112:115]
    ds_read_b128 v[44:47], v6 offset:7168
    buffer_load_dword v14, v13, s[52:55], s75 offen offset:256 sc1
    v_mov_b32 v70, v68
    v_mfma_f32_16x16x32_bf16 v[116:119], v[52:55], v[220:223], v[116:119]
    ds_read_b128 v[48:51], v6 offset:8192
    v_mov_b32 v71, v69
    v_mfma_f32_16x16x32_bf16 v[120:123], v[56:59], v[220:223], v[120:123]
    ds_read_b128 v[52:55], v6 offset:9216
    s_nop 0
    v_mfma_f32_16x16x32_bf16 v[124:127], v[60:63], v[220:223], v[124:127]
    ds_read_b128 v[56:59], v6 offset:10240
    v_permlane32_swap_b32 v68, v70
    s_waitcnt lgkmcnt(7)
    v_mfma_f32_16x16x32_bf16 v[100:103], v[16:19], v[224:227], v[100:103]
    ds_read_b128 v[60:63], v6 offset:11264
    v_permlane32_swap_b32 v69, v71
    v_mfma_f32_16x16x32_bf16 v[104:107], v[20:23], v[224:227], v[104:107]
    ds_read_b128 v[16:19], v6 offset:12288
    s_nop 0
    v_mfma_f32_16x16x32_bf16 v[108:111], v[24:27], v[224:227], v[108:111]
    ds_read_b128 v[20:23], v6 offset:13312
    v_add_f32 v68, v68, v70
    v_mfma_f32_16x16x32_bf16 v[112:115], v[28:31], v[224:227], v[112:115]
    ds_read_b128 v[24:27], v6 offset:14336
    v_add_f32 v69, v69, v71
    s_waitcnt lgkmcnt(7)
    v_mfma_f32_16x16x32_bf16 v[116:119], v[32:35], v[224:227], v[116:119]
    ds_read_b128 v[28:31], v6 offset:15360
    v_mul_f32 v68, 0x3b000000, v68
    v_mfma_f32_16x16x32_bf16 v[120:123], v[36:39], v[224:227], v[120:123]
    ds_read_b128 v[32:35], v6 offset:16384
    v_mul_f32 v69, 0x3b000000, v69
    v_mfma_f32_16x16x32_bf16 v[124:127], v[40:43], v[224:227], v[124:127]
    ds_read_b128 v[36:39], v6 offset:17408
    v_fma_f32 v69, -v68, v68, v69
    v_mfma_f32_16x16x32_bf16 v[100:103], v[44:47], v[228:231], v[100:103]
    ds_read_b128 v[40:43], v6 offset:18432
    v_max_f32 v69, 0, v69
    s_waitcnt lgkmcnt(7)
    v_mfma_f32_16x16x32_bf16 v[104:107], v[48:51], v[228:231], v[104:107]
    ds_read_b128 v[44:47], v6 offset:19456
    v_cvt_pk_bf16_f32 v71, v68, v69
    v_mfma_f32_16x16x32_bf16 v[108:111], v[52:55], v[228:231], v[108:111]
    ds_read_b128 v[48:51], v6 offset:20480
    v_lshlrev_b32 v68, 16, v71
    v_mfma_f32_16x16x32_bf16 v[112:115], v[56:59], v[228:231], v[112:115]
    ds_read_b128 v[52:55], v6 offset:21504
    s_waitcnt vmcnt(0)
    v_cmp_gt_u32 vcc, 1, v14
    s_cbranch_vccnz FWAIT_67
FOK_66:
    v_and_b32 v69, 0xffff0000, v71
    v_mfma_f32_16x16x32_bf16 v[116:119], v[60:63], v[228:231], v[116:119]
    ds_read_b128 v[56:59], v6 offset:22528
    buffer_load_dwordx4 v[128:131], v3, s[52:55], s88 offen offset:0 sc1
    v_add_f32 v69, 0x3727c5ac, v69
    s_waitcnt lgkmcnt(7)
    v_mfma_f32_16x16x32_bf16 v[120:123], v[16:19], v[228:231], v[120:123]
    ds_read_b128 v[60:63], v6 offset:23552
    v_cvt_pk_bf16_f32 v71, v69, v69
    v_mfma_f32_16x16x32_bf16 v[124:127], v[20:23], v[228:231], v[124:127]
    ds_read_b128 v[16:19], v6 offset:24576
    v_lshlrev_b32 v69, 16, v71
    v_mfma_f32_16x16x32_bf16 v[100:103], v[24:27], v[232:235], v[100:103]
    ds_read_b128 v[20:23], v6 offset:25600
    buffer_load_dwordx4 v[132:135], v3, s[52:55], s88 offen offset:1024 sc1
    v_sqrt_f32 v69, v69
    v_mfma_f32_16x16x32_bf16 v[104:107], v[28:31], v[232:235], v[104:107]
    ds_read_b128 v[24:27], v6 offset:26624
    s_nop 0
    s_waitcnt lgkmcnt(7)
    v_mfma_f32_16x16x32_bf16 v[108:111], v[32:35], v[232:235], v[108:111]
    ds_read_b128 v[28:31], v6 offset:27648
    v_cvt_pk_bf16_f32 v71, v69, v69
    v_mfma_f32_16x16x32_bf16 v[112:115], v[36:39], v[232:235], v[112:115]
    ds_read_b128 v[32:35], v6 offset:28672
    buffer_load_dwordx4 v[136:139], v3, s[52:55], s88 offen offset:2048 sc1
    v_lshlrev_b32 v70, 16, v71
    v_mfma_f32_16x16x32_bf16 v[116:119], v[40:43], v[232:235], v[116:119]
    ds_read_b128 v[36:39], v6 offset:29696
    v_rcp_f32 v69, v70
    v_mfma_f32_16x16x32_bf16 v[120:123], v[44:47], v[232:235], v[120:123]
    ds_read_b128 v[40:43], v6 offset:30720
    s_nop 0
    s_waitcnt lgkmcnt(7)
    v_mfma_f32_16x16x32_bf16 v[124:127], v[48:51], v[232:235], v[124:127]
    ds_read_b128 v[44:47], v6 offset:31744
    buffer_load_dwordx4 v[140:143], v3, s[52:55], s88 offen offset:3072 sc1
    v_cvt_pk_bf16_f32 v66, -v68, -v68
    v_mfma_f32_16x16x32_bf16 v[100:103], v[52:55], v[236:239], v[100:103]
    ds_read_b128 v[48:51], v6 offset:32768
    v_cvt_pk_bf16_f32 v67, -v68, v70
    v_mfma_f32_16x16x32_bf16 v[104:107], v[56:59], v[236:239], v[104:107]
    ds_read_b128 v[52:55], v6 offset:33792
    v_mul_f32 v69, v69, v69
    v_mfma_f32_16x16x32_bf16 v[108:111], v[60:63], v[236:239], v[108:111]
    ds_read_b128 v[56:59], v6 offset:34816
    buffer_load_dwordx4 v[144:147], v3, s[52:55], s89 offen offset:0 sc1
    v_cndmask_b32 v66, 0, v66, s[34:35]
    s_waitcnt lgkmcnt(7)
    v_mfma_f32_16x16x32_bf16 v[112:115], v[16:19], v[236:239], v[112:115]
    ds_read_b128 v[60:63], v6 offset:35840
    v_cndmask_b32 v67, 0, v67, s[34:35]
    v_mfma_f32_16x16x32_bf16 v[116:119], v[20:23], v[236:239], v[116:119]
    ds_read_b128 v[16:19], v6 offset:36864
    buffer_store_dword v69, v8, s[52:55], s13 offen offset:64
    v_mfma_f32_16x16x32_bf16 v[120:123], v[24:27], v[236:239], v[120:123]
    ds_read_b128 v[20:23], v6 offset:37888
    buffer_load_dwordx4 v[148:151], v3, s[52:55], s89 offen offset:1024 sc1
    v_mfma_f32_16x16x32_bf16 v[124:127], v[28:31], v[236:239], v[124:127]
    ds_read_b128 v[24:27], v6 offset:38912
    s_waitcnt lgkmcnt(7)
    v_mfma_f32_16x16x32_bf16 v[100:103], v[32:35], v[240:243], v[100:103]
    ds_read_b128 v[28:31], v6 offset:39936
    v_mfma_f32_16x16x32_bf16 v[104:107], v[36:39], v[240:243], v[104:107]
    ds_read_b128 v[32:35], v6 offset:40960
    buffer_load_dwordx4 v[152:155], v3, s[52:55], s89 offen offset:2048 sc1
    v_mfma_f32_16x16x32_bf16 v[108:111], v[40:43], v[240:243], v[108:111]
    ds_read_b128 v[36:39], v6 offset:41984
    v_mfma_f32_16x16x32_bf16 v[112:115], v[44:47], v[240:243], v[112:115]
    ds_read_b128 v[40:43], v6 offset:43008
    s_waitcnt lgkmcnt(7)
    v_mfma_f32_16x16x32_bf16 v[116:119], v[48:51], v[240:243], v[116:119]
    ds_read_b128 v[44:47], v6 offset:44032
    buffer_load_dwordx4 v[156:159], v3, s[52:55], s89 offen offset:3072 sc1
    v_mfma_f32_16x16x32_bf16 v[120:123], v[52:55], v[240:243], v[120:123]
    ds_read_b128 v[48:51], v6 offset:45056
    v_mfma_f32_16x16x32_bf16 v[124:127], v[56:59], v[240:243], v[124:127]
    ds_read_b128 v[52:55], v6 offset:46080
    v_mfma_f32_16x16x32_bf16 v[100:103], v[60:63], v[244:247], v[100:103]
    ds_read_b128 v[56:59], v6 offset:47104
    buffer_load_dwordx4 v[160:163], v3, s[52:55], s90 offen offset:0 sc1
    s_waitcnt lgkmcnt(7)
    v_mfma_f32_16x16x32_bf16 v[104:107], v[16:19], v[244:247], v[104:107]
    ds_read_b128 v[60:63], v6 offset:48128
    v_mfma_f32_16x16x32_bf16 v[108:111], v[20:23], v[244:247], v[108:111]
    ds_read_b128 v[16:19], v6 offset:49152
    v_mfma_f32_16x16x32_bf16 v[112:115], v[24:27], v[244:247], v[112:115]
    ds_read_b128 v[20:23], v6 offset:50176
    buffer_load_dwordx4 v[164:167], v3, s[52:55], s90 offen offset:1024 sc1
    v_mfma_f32_16x16x32_bf16 v[116:119], v[28:31], v[244:247], v[116:119]
    ds_read_b128 v[24:27], v6 offset:51200
    s_waitcnt lgkmcnt(7)
    v_mfma_f32_16x16x32_bf16 v[120:123], v[32:35], v[244:247], v[120:123]
    ds_read_b128 v[28:31], v6 offset:52224
    v_mfma_f32_16x16x32_bf16 v[124:127], v[36:39], v[244:247], v[124:127]
    ds_read_b128 v[32:35], v6 offset:53248
    buffer_load_dwordx4 v[168:171], v3, s[52:55], s90 offen offset:2048 sc1
    v_mfma_f32_16x16x32_bf16 v[100:103], v[40:43], v[248:251], v[100:103]
    ds_read_b128 v[36:39], v6 offset:54272
    v_mfma_f32_16x16x32_bf16 v[104:107], v[44:47], v[248:251], v[104:107]
    ds_read_b128 v[40:43], v6 offset:55296
    s_waitcnt lgkmcnt(7)
    v_mfma_f32_16x16x32_bf16 v[108:111], v[48:51], v[248:251], v[108:111]
    ds_read_b128 v[44:47], v6 offset:56320
    buffer_load_dwordx4 v[172:175], v3, s[52:55], s90 offen offset:3072 sc1
    v_mfma_f32_16x16x32_bf16 v[112:115], v[52:55], v[248:251], v[112:115]
    v_mfma_f32_16x16x32_bf16 v[116:119], v[56:59], v[248:251], v[116:119]
    v_mfma_f32_16x16x32_bf16 v[120:123], v[60:63], v[248:251], v[120:123]
    buffer_load_dwordx4 v[176:179], v3, s[52:55], s91 offen offset:0 sc1
    s_waitcnt lgkmcnt(4)
    v_mfma_f32_16x16x32_bf16 v[124:127], v[16:19], v[248:251], v[124:127]
    v_mfma_f32_16x16x32_bf16 v[100:103], v[20:23], v[252:255], v[100:103]
    v_mfma_f32_16x16x32_bf16 v[104:107], v[24:27], v[252:255], v[104:107]
    buffer_load_dwordx4 v[180:183], v3, s[52:55], s91 offen offset:1024 sc1
    v_mfma_f32_16x16x32_bf16 v[108:111], v[28:31], v[252:255], v[108:111]
    s_waitcnt lgkmcnt(0)
    v_mfma_f32_16x16x32_bf16 v[112:115], v[32:35], v[252:255], v[112:115]
    v_mfma_f32_16x16x32_bf16 v[116:119], v[36:39], v[252:255], v[116:119]
    buffer_load_dwordx4 v[184:187], v3, s[52:55], s91 offen offset:2048 sc1
    v_mfma_f32_16x16x32_bf16 v[120:123], v[40:43], v[252:255], v[120:123]
    v_mfma_f32_16x16x32_bf16 v[124:127], v[44:47], v[252:255], v[124:127]
    buffer_load_dwordx4 v[188:191], v3, s[52:55], s91 offen offset:3072 sc1
    s_nop 1
    v_mfma_f32_16x16x16_bf16 v[100:103], a[240:241], v[66:67], v[100:103]
    v_mfma_f32_16x16x16_bf16 v[104:107], a[242:243], v[66:67], v[104:107]
    v_mfma_f32_16x16x16_bf16 v[108:111], a[244:245], v[66:67], v[108:111]
    v_mfma_f32_16x16x16_bf16 v[112:115], a[246:247], v[66:67], v[112:115]
    v_mfma_f32_16x16x16_bf16 v[116:119], a[248:249], v[66:67], v[116:119]
    v_mfma_f32_16x16x16_bf16 v[120:123], a[250:251], v[66:67], v[120:123]
    v_mfma_f32_16x16x16_bf16 v[124:127], a[252:253], v[66:67], v[124:127]
    s_waitcnt vmcnt(16)
    v_mfma_f32_32x32x16_bf16 v[192:207], a[0:3], v[128:131], 0
    v_and_b32 v90, 0x70, v3
    s_lshl_b32 s26, s20, 7
    buffer_load_dwordx4 v[96:99], v90, s[60:63], s26 offen
    v_lshrrev_b32 v91, 7, v3
    v_lshlrev_b32 v91, 2, v91
    buffer_load_dword v88, v91, s[52:55], s43 offen offset:0 sc1
    v_mfma_f32_32x32x16_bf16 v[208:223], a[4:7], v[128:131], 0
    v_mul_f32 v100, v100, abs(v100)
    v_mul_f32 v101, v101, abs(v101)
    v_mul_f32 v102, v102, abs(v102)
    v_mul_f32 v103, v103, abs(v103)
    v_mul_f32 v104, v104, abs(v104)
    v_mul_f32 v105, v105, abs(v105)
    s_waitcnt vmcnt(17)
    v_mfma_f32_32x32x16_bf16 v[192:207], a[8:11], v[132:135], v[192:207]
    v_mul_f32 v106, v106, abs(v106)
    v_mul_f32 v107, v107, abs(v107)
    v_cvt_pk_bf16_f32 v100, v100, v101
    v_cvt_pk_bf16_f32 v101, v102, v103
    v_cvt_pk_bf16_f32 v102, v104, v105
    v_cvt_pk_bf16_f32 v103, v106, v107
    v_mfma_f32_32x32x16_bf16 v[208:223], a[12:15], v[132:135], v[208:223]
    v_pk_max_i16 v100, v100, 0
    v_pk_max_i16 v101, v101, 0
    v_pk_max_i16 v102, v102, 0
    v_pk_max_i16 v103, v103, 0
    buffer_store_dwordx4 v[100:103], v0, s[52:55], s4 offen offset:0
    v_mul_f32 v108, v108, abs(v108)
    s_waitcnt vmcnt(17)
    v_mfma_f32_32x32x16_bf16 v[192:207], a[16:19], v[136:139], v[192:207]
    v_mul_f32 v109, v109, abs(v109)
    v_mul_f32 v110, v110, abs(v110)
    v_mul_f32 v111, v111, abs(v111)
    v_mul_f32 v112, v112, abs(v112)
    v_mul_f32 v113, v113, abs(v113)
    v_mul_f32 v114, v114, abs(v114)
    v_mfma_f32_32x32x16_bf16 v[208:223], a[20:23], v[136:139], v[208:223]
    v_mul_f32 v115, v115, abs(v115)
    v_cvt_pk_bf16_f32 v108, v108, v109
    v_cvt_pk_bf16_f32 v109, v110, v111
    v_cvt_pk_bf16_f32 v110, v112, v113
    v_cvt_pk_bf16_f32 v111, v114, v115
    v_pk_max_i16 v108, v108, 0
    s_waitcnt vmcnt(16)
    v_mfma_f32_32x32x16_bf16 v[192:207], a[24:27], v[140:143], v[192:207]
    v_pk_max_i16 v109, v109, 0
    v_pk_max_i16 v110, v110, 0
    v_pk_max_i16 v111, v111, 0
    buffer_store_dwordx4 v[108:111], v0, s[52:55], s4 offen offset:2048
    v_mul_f32 v116, v116, abs(v116)
    v_mul_f32 v117, v117, abs(v117)
    v_mfma_f32_32x32x16_bf16 v[208:223], a[28:31], v[140:143], v[208:223]
    v_mul_f32 v118, v118, abs(v118)
    v_mul_f32 v119, v119, abs(v119)
    v_mul_f32 v120, v120, abs(v120)
    v_mul_f32 v121, v121, abs(v121)
    v_mul_f32 v122, v122, abs(v122)
    v_mul_f32 v123, v123, abs(v123)
    s_waitcnt vmcnt(16)
    v_mfma_f32_32x32x16_bf16 v[192:207], a[32:35], v[144:147], v[192:207]
    v_cvt_pk_bf16_f32 v116, v116, v117
    v_cvt_pk_bf16_f32 v117, v118, v119
    v_cvt_pk_bf16_f32 v118, v120, v121
    v_cvt_pk_bf16_f32 v119, v122, v123
    v_pk_max_i16 v116, v116, 0
    v_pk_max_i16 v117, v117, 0
    v_mfma_f32_32x32x16_bf16 v[208:223], a[36:39], v[144:147], v[208:223]
    v_pk_max_i16 v118, v118, 0
    v_pk_max_i16 v119, v119, 0
    buffer_store_dwordx4 v[116:119], v0, s[52:55], s5 offen offset:0
    v_mul_f32 v124, v124, abs(v124)
    v_mul_f32 v125, v125, abs(v125)
    v_mul_f32 v126, v126, abs(v126)
    s_waitcnt vmcnt(15)
    v_mfma_f32_32x32x16_bf16 v[192:207], a[40:43], v[148:151], v[192:207]
    v_mul_f32 v127, v127, abs(v127)
    v_cvt_pk_bf16_f32 v124, v124, v125
    v_cvt_pk_bf16_f32 v125, v126, v127
    v_pk_max_i16 v124, v124, 0
    v_pk_max_i16 v125, v125, 0
    buffer_store_dwordx2 v[124:125], v1, s[52:55], s5 offen offset:2048
    v_mfma_f32_32x32x16_bf16 v[208:223], a[44:47], v[148:151], v[208:223]
    v_and_b32 v118, 0x70, v3
    s_lshl_b32 s26, s20, 7
    buffer_load_dwordx4 v[124:127], v118, s[60:63], s26 offen
    s_waitcnt vmcnt(16)
    v_mfma_f32_32x32x16_bf16 v[192:207], a[48:51], v[152:155], v[192:207]
    v_mfma_f32_32x32x16_bf16 v[208:223], a[52:55], v[152:155], v[208:223]
    buffer_load_dwordx4 v[16:19], v3, s[52:55], s92 offen offset:0 sc1
    s_waitcnt vmcnt(16)
    v_mfma_f32_32x32x16_bf16 v[192:207], a[56:59], v[156:159], v[192:207]
    v_mfma_f32_32x32x16_bf16 v[208:223], a[60:63], v[156:159], v[208:223]
    buffer_load_dwordx4 v[20:23], v3, s[52:55], s92 offen offset:1024 sc1
    s_waitcnt vmcnt(16)
    v_mfma_f32_32x32x16_bf16 v[192:207], a[64:67], v[160:163], v[192:207]
    v_mfma_f32_32x32x16_bf16 v[208:223], a[68:71], v[160:163], v[208:223]
    buffer_load_dwordx4 v[24:27], v3, s[52:55], s92 offen offset:2048 sc1
    s_waitcnt vmcnt(16)
    v_mfma_f32_32x32x16_bf16 v[192:207], a[72:75], v[164:167], v[192:207]
    v_mfma_f32_32x32x16_bf16 v[208:223], a[76:79], v[164:167], v[208:223]
    buffer_load_dwordx4 v[28:31], v3, s[52:55], s92 offen offset:3072 sc1
    s_waitcnt vmcnt(16)
    v_mfma_f32_32x32x16_bf16 v[192:207], a[80:83], v[168:171], v[192:207]
    v_mfma_f32_32x32x16_bf16 v[208:223], a[84:87], v[168:171], v[208:223]
    buffer_load_dwordx4 v[32:35], v3, s[52:55], s93 offen offset:0 sc1
    s_waitcnt vmcnt(16)
    v_mfma_f32_32x32x16_bf16 v[192:207], a[88:91], v[172:175], v[192:207]
    v_mfma_f32_32x32x16_bf16 v[208:223], a[92:95], v[172:175], v[208:223]
    buffer_load_dwordx4 v[36:39], v3, s[52:55], s93 offen offset:1024 sc1
    v_mov_b32 v7, 2
    s_waitcnt vmcnt(7)
    buffer_store_dword v7, v9, s[52:55], s74 offen offset:256
    v_mfma_f32_32x32x16_bf16 v[192:207], a[96:99], v[176:179], v[192:207]
    v_mfma_f32_32x32x16_bf16 v[208:223], a[100:103], v[176:179], v[208:223]
    buffer_load_dwordx4 v[40:43], v3, s[52:55], s93 offen offset:2048 sc1
    v_mfma_f32_32x32x16_bf16 v[192:207], a[104:107], v[180:183], v[192:207]
    v_mfma_f32_32x32x16_bf16 v[208:223], a[108:111], v[180:183], v[208:223]
    buffer_load_dwordx4 v[44:47], v3, s[52:55], s93 offen offset:3072 sc1
    v_mfma_f32_32x32x16_bf16 v[192:207], a[112:115], v[184:187], v[192:207]
    v_mfma_f32_32x32x16_bf16 v[208:223], a[116:119], v[184:187], v[208:223]
    buffer_load_dwordx4 v[48:51], v3, s[52:55], s94 offen offset:0 sc1
    v_accvgpr_read_b32 v92, a224
    v_lshlrev_b32 v93, 16, v96
    v_and_b32 v94, 0xffff0000, v96
    v_lshlrev_b32 v72, 16, v92
    v_and_b32 v73, 0xffff0000, v92
    v_mfma_f32_32x32x16_bf16 v[192:207], a[120:123], v[188:191], v[192:207]
    v_add_f32 v72, v72, v93
    v_add_f32 v73, v73, v94
    v_accvgpr_read_b32 v92, a225
    v_lshlrev_b32 v93, 16, v97
    v_and_b32 v94, 0xffff0000, v97
    v_lshlrev_b32 v74, 16, v92
    v_mfma_f32_32x32x16_bf16 v[208:223], a[124:127], v[188:191], v[208:223]
    buffer_load_dwordx4 v[52:55], v3, s[52:55], s94 offen offset:1024 sc1
    v_and_b32 v75, 0xffff0000, v92
    v_add_f32 v74, v74, v93
    v_add_f32 v75, v75, v94
    v_accvgpr_read_b32 v92, a226
    v_lshlrev_b32 v93, 16, v98
    s_waitcnt vmcnt(10)
    v_mfma_f32_32x32x16_bf16 v[192:207], a[128:131], v[16:19], v[192:207]
    v_and_b32 v94, 0xffff0000, v98
    v_lshlrev_b32 v76, 16, v92
    v_and_b32 v77, 0xffff0000, v92
    v_add_f32 v76, v76, v93
    v_add_f32 v77, v77, v94
    v_accvgpr_read_b32 v92, a227
    v_mfma_f32_32x32x16_bf16 v[208:223], a[132:135], v[16:19], v[208:223]
    buffer_load_dwordx4 v[56:59], v3, s[52:55], s94 offen offset:2048 sc1
    v_lshlrev_b32 v93, 16, v99
    v_and_b32 v94, 0xffff0000, v99
    v_lshlrev_b32 v78, 16, v92
    v_and_b32 v79, 0xffff0000, v92
    v_add_f32 v78, v78, v93
    s_waitcnt vmcnt(10)
    v_mfma_f32_32x32x16_bf16 v[192:207], a[136:139], v[20:23], v[192:207]
    buffer_load_dword v14, v13, s[52:55], s75 offen offset:256 sc1
    v_add_f32 v79, v79, v94
    v_accvgpr_read_b32 v120, a228
    v_lshlrev_b32 v121, 16, v124
    v_and_b32 v122, 0xffff0000, v124
    v_lshlrev_b32 v100, 16, v120
    v_mfma_f32_32x32x16_bf16 v[208:223], a[140:143], v[20:23], v[208:223]
    buffer_load_dwordx4 v[60:63], v3, s[52:55], s94 offen offset:3072 sc1
    v_and_b32 v101, 0xffff0000, v120
    v_add_f32 v100, v100, v121
    v_add_f32 v101, v101, v122
    v_accvgpr_read_b32 v120, a229
    v_lshlrev_b32 v121, 16, v125
    s_waitcnt vmcnt(11)
    v_mfma_f32_32x32x16_bf16 v[192:207], a[144:147], v[24:27], v[192:207]
    v_and_b32 v122, 0xffff0000, v125
    v_lshlrev_b32 v102, 16, v120
    v_and_b32 v103, 0xffff0000, v120
    v_add_f32 v102, v102, v121
    v_add_f32 v103, v103, v122
    v_accvgpr_read_b32 v120, a230
    v_mfma_f32_32x32x16_bf16 v[208:223], a[148:151], v[24:27], v[208:223]
    v_lshlrev_b32 v121, 16, v126
    v_and_b32 v122, 0xffff0000, v126
    v_lshlrev_b32 v104, 16, v120
    v_and_b32 v105, 0xffff0000, v120
    v_add_f32 v104, v104, v121
    v_add_f32 v105, v105, v122
    s_waitcnt vmcnt(10)
    v_mfma_f32_32x32x16_bf16 v[192:207], a[152:155], v[28:31], v[192:207]
    v_accvgpr_read_b32 v120, a231
    v_lshlrev_b32 v121, 16, v127
    v_and_b32 v122, 0xffff0000, v127
    v_lshlrev_b32 v106, 16, v120
    v_and_b32 v107, 0xffff0000, v120
    v_add_f32 v106, v106, v121
    v_mfma_f32_32x32x16_bf16 v[208:223], a[156:159], v[28:31], v[208:223]
    v_add_f32 v107, v107, v122
    s_waitcnt vmcnt(9)
    v_mfma_f32_32x32x16_bf16 v[192:207], a[160:163], v[32:35], v[192:207]
    v_mfma_f32_32x32x16_bf16 v[208:223], a[164:167], v[32:35], v[208:223]
    s_waitcnt vmcnt(8)
    v_mfma_f32_32x32x16_bf16 v[192:207], a[168:171], v[36:39], v[192:207]
    v_mfma_f32_32x32x16_bf16 v[208:223], a[172:175], v[36:39], v[208:223]
    s_waitcnt vmcnt(6)
    v_mfma_f32_32x32x16_bf16 v[192:207], a[176:179], v[40:43], v[192:207]
    s_waitcnt vmcnt(1)
    v_cmp_gt_u32 vcc, 2, v14
    s_cbranch_vccnz FWAIT_69
FOK_68:
    buffer_load_dwordx4 v[16:19], v3, s[52:55], s95 offen offset:0 sc1
    v_mfma_f32_32x32x16_bf16 v[208:223], a[180:183], v[40:43], v[208:223]
    buffer_load_dwordx4 v[20:23], v3, s[52:55], s95 offen offset:1024 sc1
    v_mfma_f32_32x32x16_bf16 v[192:207], a[184:187], v[44:47], v[192:207]
    buffer_load_dwordx4 v[24:27], v3, s[52:55], s95 offen offset:2048 sc1
    v_mfma_f32_32x32x16_bf16 v[208:223], a[188:191], v[44:47], v[208:223]
    buffer_load_dwordx4 v[28:31], v3, s[52:55], s95 offen offset:3072 sc1
    v_mfma_f32_32x32x16_bf16 v[192:207], a[192:195], v[48:51], v[192:207]
    buffer_load_dwordx4 v[32:35], v3, s[52:55], s96 offen offset:0 sc1
    v_mfma_f32_32x32x16_bf16 v[208:223], a[196:199], v[48:51], v[208:223]
    buffer_load_dwordx4 v[36:39], v3, s[52:55], s96 offen offset:1024 sc1
    v_mfma_f32_32x32x16_bf16 v[192:207], a[200:203], v[52:55], v[192:207]
    buffer_load_dwordx4 v[40:43], v3, s[52:55], s96 offen offset:2048 sc1
    v_mfma_f32_32x32x16_bf16 v[208:223], a[204:207], v[52:55], v[208:223]
    buffer_load_dwordx4 v[44:47], v3, s[52:55], s96 offen offset:3072 sc1
    v_mfma_f32_32x32x16_bf16 v[192:207], a[208:211], v[56:59], v[192:207]
    v_mfma_f32_32x32x16_bf16 v[208:223], a[212:215], v[56:59], v[208:223]
    buffer_load_dwordx4 v[48:51], v3, s[52:55], s97 offen offset:0 sc1
    s_waitcnt vmcnt(9)
    v_mfma_f32_32x32x16_bf16 v[192:207], a[216:219], v[60:63], v[192:207]
    v_mfma_f32_32x32x16_bf16 v[208:223], a[220:223], v[60:63], v[208:223]
    buffer_load_dwordx4 v[52:55], v3, s[52:55], s97 offen offset:1024 sc1
    s_waitcnt vmcnt(9)
    v_mfma_f32_32x32x16_bf16 v[224:239], a[0:3], v[16:19], 0
    v_lshrrev_b32 v119, 7, v3
    v_lshlrev_b32 v119, 2, v119
    buffer_load_dword v116, v119, s[52:55], s43 offen offset:64 sc1
    s_nop 1
    v_mfma_f32_32x32x16_bf16 v[240:255], a[4:7], v[16:19], 0
    buffer_load_dwordx4 v[56:59], v3, s[52:55], s97 offen offset:2048 sc1
    s_waitcnt vmcnt(10)
    v_mfma_f32_32x32x16_bf16 v[224:239], a[8:11], v[20:23], v[224:239]
    ds_write_b128 v2, v[192:195] offset:0
    v_mfma_f32_32x32x16_bf16 v[240:255], a[12:15], v[20:23], v[240:255]
    buffer_load_dwordx4 v[60:63], v3, s[52:55], s97 offen offset:3072 sc1
    ds_write_b128 v2, v[196:199] offset:4352
    s_waitcnt vmcnt(10)
    v_mfma_f32_32x32x16_bf16 v[224:239], a[16:19], v[24:27], v[224:239]
    ds_write_b128 v2, v[200:203] offset:1088
    v_mfma_f32_32x32x16_bf16 v[240:255], a[20:23], v[24:27], v[240:255]
    buffer_load_dwordx4 v[16:19], v3, s[52:55], s98 offen offset:0 sc1
    ds_write_b128 v2, v[204:207] offset:5440
    s_waitcnt vmcnt(10)
    v_mfma_f32_32x32x16_bf16 v[224:239], a[24:27], v[28:31], v[224:239]
    ds_write_b128 v2, v[208:211] offset:2176
    v_mfma_f32_32x32x16_bf16 v[240:255], a[28:31], v[28:31], v[240:255]
    buffer_load_dwordx4 v[20:23], v3, s[52:55], s98 offen offset:1024 sc1
    ds_write_b128 v2, v[212:215] offset:6528
    s_waitcnt vmcnt(10)
    v_mfma_f32_32x32x16_bf16 v[224:239], a[32:35], v[32:35], v[224:239]
    ds_write_b128 v2, v[216:219] offset:3264
    v_mfma_f32_32x32x16_bf16 v[240:255], a[36:39], v[32:35], v[240:255]
    buffer_load_dwordx4 v[24:27], v3, s[52:55], s98 offen offset:2048 sc1
    ds_write_b128 v2, v[220:223] offset:7616
    s_waitcnt vmcnt(10)
    v_mfma_f32_32x32x16_bf16 v[224:239], a[40:43], v[36:39], v[224:239]
    v_mfma_f32_32x32x16_bf16 v[240:255], a[44:47], v[36:39], v[240:255]
    buffer_load_dwordx4 v[28:31], v3, s[52:55], s98 offen offset:3072 sc1
    s_waitcnt vmcnt(10)
    v_mfma_f32_32x32x16_bf16 v[224:239], a[48:51], v[40:43], v[224:239]
    v_mfma_f32_32x32x16_bf16 v[240:255], a[52:55], v[40:43], v[240:255]
    buffer_load_dwordx4 v[32:35], v3, s[52:55], s99 offen offset:0 sc1
    s_waitcnt lgkmcnt(0)
    s_barrier
    ds_read_b128 v[160:163], v10 offset:0
    ds_read_b128 v[164:167], v10 offset:4352
    ds_read_b128 v[168:171], v10 offset:8704
    s_waitcnt vmcnt(10)
    v_mfma_f32_32x32x16_bf16 v[224:239], a[56:59], v[44:47], v[224:239]
    ds_read_b128 v[172:175], v10 offset:13056
    ds_read_b128 v[176:179], v10 offset:17408
    ds_read_b128 v[180:183], v10 offset:21760
    ds_read_b128 v[184:187], v10 offset:26112
    ds_read_b128 v[188:191], v10 offset:30464
    v_mfma_f32_32x32x16_bf16 v[240:255], a[60:63], v[44:47], v[240:255]
    buffer_load_dwordx4 v[36:39], v3, s[52:55], s99 offen offset:1024 sc1
    s_waitcnt vmcnt(10)
    v_mfma_f32_32x32x16_bf16 v[224:239], a[64:67], v[48:51], v[224:239]
    v_mfma_f32_32x32x16_bf16 v[240:255], a[68:71], v[48:51], v[240:255]
    buffer_load_dwordx4 v[40:43], v3, s[52:55], s99 offen offset:2048 sc1
    s_waitcnt lgkmcnt(4)
    v_add_f32 v160, v160, v168
    v_add_f32 v161, v161, v169
    v_add_f32 v162, v162, v170
    v_add_f32 v163, v163, v171
    s_waitcnt vmcnt(10)
    v_mfma_f32_32x32x16_bf16 v[224:239], a[72:75], v[52:55], v[224:239]
    v_add_f32 v164, v164, v172
    v_add_f32 v165, v165, v173
    v_add_f32 v166, v166, v174
    v_add_f32 v167, v167, v175
    s_waitcnt lgkmcnt(0)
    v_add_f32 v176, v176, v184
    v_mfma_f32_32x32x16_bf16 v[240:255], a[76:79], v[52:55], v[240:255]
    buffer_load_dwordx4 v[44:47], v3, s[52:55], s99 offen offset:3072 sc1
    v_add_f32 v177, v177, v185
    v_add_f32 v178, v178, v186
    v_add_f32 v179, v179, v187
    v_add_f32 v180, v180, v188
    v_add_f32 v181, v181, v189
    s_waitcnt vmcnt(9)
    v_mfma_f32_32x32x16_bf16 v[224:239], a[80:83], v[56:59], v[224:239]
    v_add_f32 v182, v182, v190
    v_add_f32 v183, v183, v191
    v_add_f32 v160, v160, v176
    v_add_f32 v161, v161, v177
    v_add_f32 v162, v162, v178
    v_add_f32 v163, v163, v179
    v_mfma_f32_32x32x16_bf16 v[240:255], a[84:87], v[56:59], v[240:255]
    buffer_load_dwordx4 v[48:51], v3, s[52:55], s100 offen offset:0 sc1
    v_add_f32 v164, v164, v180
    v_add_f32 v165, v165, v181
    v_add_f32 v166, v166, v182
    v_add_f32 v167, v167, v183
    v_fmac_f32 v72, v160, v88
    s_waitcnt vmcnt(9)
    v_mfma_f32_32x32x16_bf16 v[224:239], a[88:91], v[60:63], v[224:239]
    v_fmac_f32 v73, v161, v88
    v_fmac_f32 v74, v162, v88
    v_fmac_f32 v75, v163, v88
    v_fmac_f32 v76, v164, v88
    v_fmac_f32 v77, v165, v88
    v_fmac_f32 v78, v166, v88
    v_mfma_f32_32x32x16_bf16 v[240:255], a[92:95], v[60:63], v[240:255]
    buffer_load_dwordx4 v[52:55], v3, s[52:55], s100 offen offset:1024 sc1
    v_fmac_f32 v79, v167, v88
    v_cvt_pk_bf16_f32 v96, v72, v73
    v_cvt_pk_bf16_f32 v97, v74, v75
    v_cvt_pk_bf16_f32 v98, v76, v77
    v_cvt_pk_bf16_f32 v99, v78, v79
    s_waitcnt vmcnt(9)
    v_mfma_f32_32x32x16_bf16 v[224:239], a[96:99], v[16:19], v[224:239]
    buffer_store_dwordx4 v[96:99], v12, s[56:59], s47 offen offset:0
    v_mfma_f32_32x32x16_bf16 v[240:255], a[100:103], v[16:19], v[240:255]
    buffer_load_dwordx4 v[56:59], v3, s[52:55], s100 offen offset:2048 sc1
    s_waitcnt vmcnt(10)
    v_mfma_f32_32x32x16_bf16 v[224:239], a[104:107], v[20:23], v[224:239]
    v_mfma_f32_32x32x16_bf16 v[240:255], a[108:111], v[20:23], v[240:255]
    buffer_load_dwordx4 v[60:63], v3, s[52:55], s100 offen offset:3072 sc1
    s_waitcnt vmcnt(10)
    v_mfma_f32_32x32x16_bf16 v[224:239], a[112:115], v[24:27], v[224:239]
    s_barrier
    v_mfma_f32_32x32x16_bf16 v[240:255], a[116:119], v[24:27], v[240:255]
    buffer_load_dwordx4 v[16:19], v3, s[52:55], s101 offen offset:0 sc1
    s_waitcnt vmcnt(10)
    v_mfma_f32_32x32x16_bf16 v[224:239], a[120:123], v[28:31], v[224:239]
    v_mfma_f32_32x32x16_bf16 v[240:255], a[124:127], v[28:31], v[240:255]
    buffer_load_dwordx4 v[20:23], v3, s[52:55], s101 offen offset:1024 sc1
    s_waitcnt vmcnt(10)
    v_mfma_f32_32x32x16_bf16 v[224:239], a[128:131], v[32:35], v[224:239]
    v_mfma_f32_32x32x16_bf16 v[240:255], a[132:135], v[32:35], v[240:255]
    buffer_load_dwordx4 v[24:27], v3, s[52:55], s101 offen offset:2048 sc1
    s_waitcnt vmcnt(10)
    v_mfma_f32_32x32x16_bf16 v[224:239], a[136:139], v[36:39], v[224:239]
    v_mfma_f32_32x32x16_bf16 v[240:255], a[140:143], v[36:39], v[240:255]
    buffer_load_dwordx4 v[28:31], v3, s[52:55], s101 offen offset:3072 sc1
    s_waitcnt vmcnt(10)
    v_mfma_f32_32x32x16_bf16 v[224:239], a[144:147], v[40:43], v[224:239]
    v_mfma_f32_32x32x16_bf16 v[240:255], a[148:151], v[40:43], v[240:255]
    s_waitcnt vmcnt(9)
    v_mfma_f32_32x32x16_bf16 v[224:239], a[152:155], v[44:47], v[224:239]
    v_mfma_f32_32x32x16_bf16 v[240:255], a[156:159], v[44:47], v[240:255]
    s_waitcnt vmcnt(8)
    v_mfma_f32_32x32x16_bf16 v[224:239], a[160:163], v[48:51], v[224:239]
    v_mfma_f32_32x32x16_bf16 v[240:255], a[164:167], v[48:51], v[240:255]
    s_waitcnt vmcnt(7)
    v_mfma_f32_32x32x16_bf16 v[224:239], a[168:171], v[52:55], v[224:239]
    v_mfma_f32_32x32x16_bf16 v[240:255], a[172:175], v[52:55], v[240:255]
    s_waitcnt vmcnt(5)
    v_mfma_f32_32x32x16_bf16 v[224:239], a[176:179], v[56:59], v[224:239]
    v_mfma_f32_32x32x16_bf16 v[240:255], a[180:183], v[56:59], v[240:255]
    s_waitcnt vmcnt(4)
    v_mfma_f32_32x32x16_bf16 v[224:239], a[184:187], v[60:63], v[224:239]
    v_mfma_f32_32x32x16_bf16 v[240:255], a[188:191], v[60:63], v[240:255]
    s_waitcnt vmcnt(3)
    v_mfma_f32_32x32x16_bf16 v[224:239], a[192:195], v[16:19], v[224:239]
    s_waitcnt vmcnt(2)
    v_mfma_f32_32x32x16_bf16 v[224:239], a[200:203], v[20:23], v[224:239]
    s_waitcnt vmcnt(1)
    v_mfma_f32_32x32x16_bf16 v[224:239], a[208:211], v[24:27], v[224:239]
    s_waitcnt vmcnt(0)
    v_mfma_f32_32x32x16_bf16 v[224:239], a[216:219], v[28:31], v[224:239]
    v_mfma_f32_32x32x16_bf16 v[240:255], a[196:199], v[16:19], v[240:255]
    s_nop 4
    v_mfma_f32_32x32x16_bf16 v[240:255], a[204:207], v[20:23], v[240:255]
    s_nop 4
    v_mfma_f32_32x32x16_bf16 v[240:255], a[212:215], v[24:27], v[240:255]
    ds_write_b128 v2, v[224:227] offset:0
    ds_write_b128 v2, v[228:231] offset:4352
    v_mfma_f32_32x32x16_bf16 v[240:255], a[220:223], v[28:31], v[240:255]
    ds_write_b128 v2, v[232:235] offset:1088
    ds_write_b128 v2, v[236:239] offset:5440
    s_nop 9
    ds_write_b128 v2, v[240:243] offset:2176
    ds_write_b128 v2, v[244:247] offset:6528
    ds_write_b128 v2, v[248:251] offset:3264
    ds_write_b128 v2, v[252:255] offset:7616
    s_waitcnt lgkmcnt(0)
    s_barrier
    ds_read_b128 v[16:19], v10 offset:0
    ds_read_b128 v[20:23], v10 offset:4352
    ds_read_b128 v[24:27], v10 offset:8704
    ds_read_b128 v[28:31], v10 offset:13056
    ds_read_b128 v[32:35], v10 offset:17408
    ds_read_b128 v[36:39], v10 offset:21760
    ds_read_b128 v[40:43], v10 offset:26112
    ds_read_b128 v[44:47], v10 offset:30464
    s_waitcnt lgkmcnt(4)
    v_pk_add_f32 v[16:17], v[16:17], v[24:25]
    v_pk_add_f32 v[18:19], v[18:19], v[26:27]
    v_pk_add_f32 v[20:21], v[20:21], v[28:29]
    v_pk_add_f32 v[22:23], v[22:23], v[30:31]
    s_waitcnt lgkmcnt(0)
    v_pk_add_f32 v[32:33], v[32:33], v[40:41]
    v_pk_add_f32 v[34:35], v[34:35], v[42:43]
    v_pk_add_f32 v[36:37], v[36:37], v[44:45]
    v_pk_add_f32 v[38:39], v[38:39], v[46:47]
    v_pk_add_f32 v[16:17], v[16:17], v[32:33]
    v_pk_add_f32 v[18:19], v[18:19], v[34:35]
    v_pk_add_f32 v[20:21], v[20:21], v[36:37]
    v_pk_add_f32 v[22:23], v[22:23], v[38:39]
    v_pk_fma_f32 v[100:101], v[16:17], v[116:117], v[100:101] op_sel_hi:[1,0,1]
    v_pk_fma_f32 v[102:103], v[18:19], v[116:117], v[102:103] op_sel_hi:[1,0,1]
    v_pk_fma_f32 v[104:105], v[20:21], v[116:117], v[104:105] op_sel_hi:[1,0,1]
    v_pk_fma_f32 v[106:107], v[22:23], v[116:117], v[106:107] op_sel_hi:[1,0,1]
    v_cvt_pk_bf16_f32 v124, v100, v101
    v_cvt_pk_bf16_f32 v125, v102, v103
    v_cvt_pk_bf16_f32 v126, v104, v105
    v_cvt_pk_bf16_f32 v127, v106, v107
    buffer_store_dwordx4 v[124:127], v12, s[56:59], s47 offen offset:1024
    s_endpgm
SWAIT_13:
    s_mov_b32 s40, 200000
SX_14:
    buffer_load_dwordx2 v[92:93], v5, s[52:55], s7 offen offset:0 sc1
    s_waitcnt vmcnt(0)
    s_sub_u32 s40, s40, 1
    s_cbranch_scc1 SOK_12
    v_cmp_gt_i32 vcc, 0, v93
    s_cbranch_vccnz SX_14
    s_branch SOK_12
SWAIT_16:
    s_mov_b32 s40, 200000
SX_17:
    buffer_load_dwordx2 v[120:121], v5, s[52:55], s7 offen offset:1024 sc1
    s_waitcnt vmcnt(0)
    s_sub_u32 s40, s40, 1
    s_cbranch_scc1 SOK_15
    v_cmp_gt_i32 vcc, 0, v121
    s_cbranch_vccnz SX_17
    s_branch SOK_15
SWAIT_28:
    s_mov_b32 s40, 200000
SX_29:
    buffer_load_dwordx2 v[92:93], v5, s[52:55], s7 offen offset:0 sc1
    s_waitcnt vmcnt(0)
    s_sub_u32 s40, s40, 1
    s_cbranch_scc1 SOK_27
    v_cmp_gt_i32 vcc, 0, v93
    s_cbranch_vccnz SX_29
    s_branch SOK_27
SWAIT_31:
    s_mov_b32 s40, 200000
SX_32:
    buffer_load_dwordx2 v[120:121], v5, s[52:55], s7 offen offset:1024 sc1
    s_waitcnt vmcnt(0)
    s_sub_u32 s40, s40, 1
    s_cbranch_scc1 SOK_30
    v_cmp_gt_i32 vcc, 0, v121
    s_cbranch_vccnz SX_32
    s_branch SOK_30
FWAIT_38:
    s_mov_b32 s40, 200000
POLL_70:
    buffer_load_dword v14, v13, s[52:55], s69 offen offset:512 sc1
    s_sub_u32 s40, s40, 1
    s_cbranch_scc1 POLLX_71
    s_waitcnt vmcnt(0)
    v_cmp_gt_u32 vcc, 2, v14
    s_cbranch_vccnz POLL_70
POLLX_71:
    s_waitcnt vmcnt(0)
    s_branch FOK_37
SWAIT_41:
    s_mov_b32 s40, 200000
SX_42:
    buffer_load_dwordx4 v[68:71], v4, s[52:55], s8 offen offset:0 sc1
    s_waitcnt vmcnt(0)
    s_sub_u32 s40, s40, 1
    s_cbranch_scc1 SOK_40
    v_or_b32 v64, v69, v71
    v_cmp_gt_i32 vcc, 0, v64
    s_cbranch_vccnz SX_42
    s_branch SOK_40
SWAIT_44:
    s_mov_b32 s40, 200000
SX_45:
    buffer_load_dwordx4 v[68:71], v4, s[52:55], s8 offen offset:1024 sc1
    s_waitcnt vmcnt(0)
    s_sub_u32 s40, s40, 1
    s_cbranch_scc1 SOK_43
    v_or_b32 v66, v69, v71
    v_cmp_gt_i32 vcc, 0, v66
    s_cbranch_vccnz SX_45
    s_branch SOK_43
FWAIT_47:
    s_mov_b32 s40, 200000
POLL_72:
    buffer_load_dword v14, v13, s[52:55], s75 offen offset:0 sc1
    s_sub_u32 s40, s40, 1
    s_cbranch_scc1 POLLX_73
    s_waitcnt vmcnt(0)
    v_cmp_gt_u32 vcc, 1, v14
    s_cbranch_vccnz POLL_72
POLLX_73:
    s_waitcnt vmcnt(0)
    s_branch FOK_46
FWAIT_49:
    s_mov_b32 s40, 200000
POLL_74:
    buffer_load_dword v14, v13, s[52:55], s75 offen offset:0 sc1
    s_sub_u32 s40, s40, 1
    s_cbranch_scc1 POLLX_75
    s_waitcnt vmcnt(0)
    v_cmp_gt_u32 vcc, 2, v14
    s_cbranch_vccnz POLL_74
POLLX_75:
    s_waitcnt vmcnt(0)
    s_branch FOK_48
SWAIT_51:
    s_mov_b32 s40, 200000
SX_52:
    buffer_load_dwordx2 v[92:93], v5, s[52:55], s7 offen offset:0 sc1
    s_waitcnt vmcnt(0)
    s_sub_u32 s40, s40, 1
    s_cbranch_scc1 SOK_50
    v_cmp_gt_i32 vcc, 0, v93
    s_cbranch_vccnz SX_52
    s_branch SOK_50
FWAIT_54:
    s_mov_b32 s40, 200000
POLL_76:
    buffer_load_dword v14, v13, s[52:55], s69 offen offset:512 sc1
    s_sub_u32 s40, s40, 1
    s_cbranch_scc1 POLLX_77
    s_waitcnt vmcnt(0)
    v_cmp_gt_u32 vcc, 3, v14
    s_cbranch_vccnz POLL_76
POLLX_77:
    s_waitcnt vmcnt(0)
    s_branch FOK_53
SWAIT_56:
    s_mov_b32 s40, 200000
SX_57:
    buffer_load_dwordx2 v[120:121], v5, s[52:55], s7 offen offset:1024 sc1
    s_waitcnt vmcnt(0)
    s_sub_u32 s40, s40, 1
    s_cbranch_scc1 SOK_55
    v_cmp_gt_i32 vcc, 0, v121
    s_cbranch_vccnz SX_57
    s_branch SOK_55
FWAIT_59:
    s_mov_b32 s40, 200000
POLL_78:
    buffer_load_dword v14, v13, s[52:55], s69 offen offset:512 sc1
    s_sub_u32 s40, s40, 1
    s_cbranch_scc1 POLLX_79
    s_waitcnt vmcnt(0)
    v_cmp_gt_u32 vcc, 4, v14
    s_cbranch_vccnz POLL_78
POLLX_79:
    s_waitcnt vmcnt(0)
    s_branch FOK_58
SWAIT_61:
    s_mov_b32 s40, 200000
SX_62:
    buffer_load_dwordx4 v[68:71], v4, s[52:55], s8 offen offset:0 sc1
    s_waitcnt vmcnt(0)
    s_sub_u32 s40, s40, 1
    s_cbranch_scc1 SOK_60
    v_or_b32 v64, v69, v71
    v_cmp_gt_i32 vcc, 0, v64
    s_cbranch_vccnz SX_62
    s_branch SOK_60
SWAIT_64:
    s_mov_b32 s40, 200000
SX_65:
    buffer_load_dwordx4 v[68:71], v4, s[52:55], s8 offen offset:1024 sc1
    s_waitcnt vmcnt(0)
    s_sub_u32 s40, s40, 1
    s_cbranch_scc1 SOK_63
    v_or_b32 v66, v69, v71
    v_cmp_gt_i32 vcc, 0, v66
    s_cbranch_vccnz SX_65
    s_branch SOK_63
FWAIT_67:
    s_mov_b32 s40, 200000
POLL_80:
    buffer_load_dword v14, v13, s[52:55], s75 offen offset:256 sc1
    s_sub_u32 s40, s40, 1
    s_cbranch_scc1 POLLX_81
    s_waitcnt vmcnt(0)
    v_cmp_gt_u32 vcc, 1, v14
    s_cbranch_vccnz POLL_80
POLLX_81:
    s_waitcnt vmcnt(0)
    s_branch FOK_66
FWAIT_69:
    s_mov_b32 s40, 200000
POLL_82:
    buffer_load_dword v14, v13, s[52:55], s75 offen offset:256 sc1
    s_sub_u32 s40, s40, 1
    s_cbranch_scc1 POLLX_83
    s_waitcnt vmcnt(0)
    v_cmp_gt_u32 vcc, 2, v14
    s_cbranch_vccnz POLL_82
POLLX_83:
    s_waitcnt vmcnt(0)
    s_branch FOK_68
K_FAST_END:
K_SLOW:
    buffer_store_dwordx4 v[96:99], v12, s[52:55], s28 offen sc0 sc1
    buffer_store_dwordx4 v[124:127], v12, s[52:55], s33 offen sc0 sc1
    v_lshlrev_b32 v72, 16, v96
    v_and_b32 v76, 0xffff0000, v96
    v_lshlrev_b32 v73, 16, v97
    v_and_b32 v77, 0xffff0000, v97
    v_lshlrev_b32 v74, 16, v98
    v_and_b32 v78, 0xffff0000, v98
    v_lshlrev_b32 v75, 16, v99
    v_and_b32 v79, 0xffff0000, v99
    v_pk_add_f32 v[92:93], v[72:73], v[74:75]
    v_pk_mul_f32 v[94:95], v[72:73], v[72:73]
    v_pk_fma_f32 v[94:95], v[74:75], v[74:75], v[94:95]
    v_pk_add_f32 v[92:93], v[92:93], v[76:77]
    v_pk_fma_f32 v[94:95], v[76:77], v[76:77], v[94:95]
    v_pk_add_f32 v[92:93], v[92:93], v[78:79]
    v_pk_fma_f32 v[94:95], v[78:79], v[78:79], v[94:95]
    v_add_f32 v90, v92, v93
    v_add_f32 v91, v94, v95
    s_nop 0
    v_add_f32_dpp v90, v90, v90 quad_perm:[1,0,3,2] row_mask:0xf bank_mask:0xf
    v_add_f32_dpp v91, v91, v91 quad_perm:[1,0,3,2] row_mask:0xf bank_mask:0xf
    s_nop 0
    v_add_f32_dpp v90, v90, v90 quad_perm:[2,3,0,1] row_mask:0xf bank_mask:0xf
    v_add_f32_dpp v91, v91, v91 quad_perm:[2,3,0,1] row_mask:0xf bank_mask:0xf
    s_nop 0
    v_add_f32_dpp v90, v90, v90 row_half_mirror row_mask:0xf bank_mask:0xf
    v_add_f32_dpp v91, v91, v91 row_half_mirror row_mask:0xf bank_mask:0xf
    v_and_b32 v91, 0x7fffffff, v91
    buffer_store_dwordx2 v[90:91], v11, s[52:55], s9 offen offset:0 sc0 sc1
    v_accvgpr_write_b32 a224, v96
    v_accvgpr_write_b32 a225, v97
    v_accvgpr_write_b32 a226, v98
    v_accvgpr_write_b32 a227, v99
    v_mov_b32 v7, 2
    s_waitcnt vmcnt(1)
    buffer_store_dword v7, v9, s[52:55], s68 offen offset:512 sc0 sc1
    buffer_load_dword v14, v13, s[52:55], s69 offen offset:512 sc1
    v_lshlrev_b32 v100, 16, v124
    v_and_b32 v104, 0xffff0000, v124
    v_lshlrev_b32 v101, 16, v125
    v_and_b32 v105, 0xffff0000, v125
    v_lshlrev_b32 v102, 16, v126
    v_and_b32 v106, 0xffff0000, v126
    v_lshlrev_b32 v103, 16, v127
    v_and_b32 v107, 0xffff0000, v127
    v_pk_add_f32 v[120:121], v[100:101], v[102:103]
    v_pk_mul_f32 v[122:123], v[100:101], v[100:101]
    v_pk_fma_f32 v[122:123], v[102:103], v[102:103], v[122:123]
    v_pk_add_f32 v[120:121], v[120:121], v[104:105]
    v_pk_fma_f32 v[122:123], v[104:105], v[104:105], v[122:123]
    v_pk_add_f32 v[120:121], v[120:121], v[106:107]
    v_pk_fma_f32 v[122:123], v[106:107], v[106:107], v[122:123]
    v_add_f32 v118, v120, v121
    v_add_f32 v119, v122, v123
    s_nop 0
    v_add_f32_dpp v118, v118, v118 quad_perm:[1,0,3,2] row_mask:0xf bank_mask:0xf
    v_add_f32_dpp v119, v119, v119 quad_perm:[1,0,3,2] row_mask:0xf bank_mask:0xf
    s_nop 0
    v_add_f32_dpp v118, v118, v118 quad_perm:[2,3,0,1] row_mask:0xf bank_mask:0xf
    v_add_f32_dpp v119, v119, v119 quad_perm:[2,3,0,1] row_mask:0xf bank_mask:0xf
    s_nop 0
    v_add_f32_dpp v118, v118, v118 row_half_mirror row_mask:0xf bank_mask:0xf
    v_add_f32_dpp v119, v119, v119 row_half_mirror row_mask:0xf bank_mask:0xf
    v_and_b32 v119, 0x7fffffff, v119
    buffer_store_dwordx2 v[118:119], v11, s[52:55], s9 offen offset:1024 sc0 sc1
    v_accvgpr_write_b32 a228, v124
    v_accvgpr_write_b32 a229, v125
    v_accvgpr_write_b32 a230, v126
    v_accvgpr_write_b32 a231, v127
    v_accvgpr_write_b32 a232, v164
    v_accvgpr_write_b32 a233, v165
    v_accvgpr_write_b32 a234, v166
    v_accvgpr_write_b32 a235, v167
    v_accvgpr_write_b32 a236, v168
    v_accvgpr_write_b32 a237, v169
    v_accvgpr_write_b32 a238, v170
    v_accvgpr_write_b32 a239, v171
    s_add_u32 s9, s9, 0x20000
    ds_read_b64_tr_b16 a[160:161], v223 offset:0
    ds_read_b64_tr_b16 a[162:163], v223 offset:512
    ds_read_b64_tr_b16 a[164:165], v223 offset:64
    ds_read_b64_tr_b16 a[166:167], v223 offset:576
    ds_read_b64_tr_b16 a[168:169], v223 offset:2048
    ds_read_b64_tr_b16 a[170:171], v223 offset:2560
    ds_read_b64_tr_b16 a[172:173], v223 offset:2112
    ds_read_b64_tr_b16 a[174:175], v223 offset:2624
    ds_read_b64_tr_b16 a[176:177], v223 offset:4096
    ds_read_b64_tr_b16 a[178:179], v223 offset:4608
    ds_read_b64_tr_b16 a[180:181], v223 offset:4160
    ds_read_b64_tr_b16 a[182:183], v223 offset:4672
    ds_read_b64_tr_b16 a[184:185], v223 offset:6144
    ds_read_b64_tr_b16 a[186:187], v223 offset:6656
    ds_read_b64_tr_b16 a[188:189], v223 offset:6208
    ds_read_b64_tr_b16 a[190:191], v223 offset:6720
    s_waitcnt lgkmcnt(0)
    s_add_u32 m0, s24, 0
    s_nop 0
    buffer_load_dwordx4 v220, s[84:87], s76 offen lds
    s_add_u32 s76, s76, 8192
    s_add_u32 m0, s24, 1024
    s_nop 0
    buffer_load_dwordx4 v220, s[84:87], s76 offen lds
    s_add_u32 s76, s76, 8192
    s_add_u32 m0, s24, 2048
    s_nop 0
    buffer_load_dwordx4 v220, s[84:87], s76 offen lds
    s_add_u32 s76, s76, 8192
    s_add_u32 m0, s24, 3072
    s_nop 0
    buffer_load_dwordx4 v220, s[84:87], s76 offen lds
    s_add_u32 s76, s76, 8192
    s_add_u32 m0, s24, 4096
    s_nop 0
    buffer_load_dwordx4 v220, s[84:87], s76 offen lds
    s_add_u32 s76, s76, 8192
    s_add_u32 m0, s24, 5120
    s_nop 0
    buffer_load_dwordx4 v220, s[84:87], s76 offen lds
    s_add_u32 s76, s76, 8192
    s_add_u32 m0, s24, 6144
    s_nop 0
    buffer_load_dwordx4 v220, s[84:87], s76 offen lds
    s_add_u32 s76, s76, 8192
    s_add_u32 m0, s24, 7168
    s_nop 0
    buffer_load_dwordx4 v220, s[84:87], s76 offen lds
    s_add_u32 s76, s76, 8192
    s_waitcnt vmcnt(0)
    ds_read_b64_tr_b16 a[192:193], v223 offset:0
    ds_read_b64_tr_b16 a[194:195], v223 offset:512
    ds_read_b64_tr_b16 a[196:197], v223 offset:64
    ds_read_b64_tr_b16 a[198:199], v223 offset:576
    ds_read_b64_tr_b16 a[200:201], v223 offset:2048
    ds_read_b64_tr_b16 a[202:203], v223 offset:2560
    ds_read_b64_tr_b16 a[204:205], v223 offset:2112
    ds_read_b64_tr_b16 a[206:207], v223 offset:2624
    ds_read_b64_tr_b16 a[208:209], v223 offset:4096
    ds_read_b64_tr_b16 a[210:211], v223 offset:4608
    ds_read_b64_tr_b16 a[212:213], v223 offset:4160
    ds_read_b64_tr_b16 a[214:215], v223 offset:4672
    ds_read_b64_tr_b16 a[216:217], v223 offset:6144
    ds_read_b64_tr_b16 a[218:219], v223 offset:6656
    ds_read_b64_tr_b16 a[220:221], v223 offset:6208
    ds_read_b64_tr_b16 a[222:223], v223 offset:6720
    v_cmp_gt_u32 vcc, 2, v14
    s_cbranch_vccnz FWAIT_85
FOK_84:
    s_add_u32 s26, s2, s18
    s_cmp_lg_u32 s26, 0
    s_cbranch_scc1 NOEP_86
    v_mov_b32 v254, s48
    s_mov_b32 s26, 0x80f000
    buffer_store_dwordx2 v[254:255], v9, s[52:55], s26 offen sc0 sc1
NOEP_86:
    s_add_u32 s30, s46, 0
    buffer_load_dwordx4 v[128:131], v3, s[52:55], s30 offen offset:0 sc1
    buffer_load_dwordx4 v[132:135], v3, s[52:55], s30 offen offset:1024 sc1
    buffer_load_dwordx4 v[136:139], v3, s[52:55], s30 offen offset:2048 sc1
    buffer_load_dwordx4 v[140:143], v3, s[52:55], s30 offen offset:3072 sc1
    ds_read_b128 v[16:19], v3 offset:0
    ds_read_b128 v[20:23], v3 offset:1024
    ds_read_b128 v[24:27], v3 offset:2048
    ds_read_b128 v[28:31], v3 offset:3072
    ds_read_b128 v[32:35], v3 offset:4096
    ds_read_b128 v[36:39], v3 offset:5120
    ds_read_b128 v[40:43], v3 offset:6144
    ds_read_b128 v[44:47], v3 offset:7168
    ds_read_b128 v[48:51], v3 offset:8192
    ds_read_b128 v[52:55], v3 offset:9216
    ds_read_b128 v[56:59], v3 offset:10240
    s_waitcnt vmcnt(3) lgkmcnt(7)
    v_mfma_f32_16x16x32_bf16 v[72:75], v[16:19], v[128:131], 0
    ds_read_b128 v[60:63], v3 offset:11264
    v_mfma_f32_16x16x32_bf16 v[76:79], v[20:23], v[128:131], 0
    ds_read_b128 v[16:19], v3 offset:12288
    s_add_u32 s30, s46, 4096
    buffer_load_dwordx4 v[144:147], v3, s[52:55], s30 offen offset:0 sc1
    v_mfma_f32_16x16x32_bf16 v[80:83], v[24:27], v[128:131], 0
    ds_read_b128 v[20:23], v3 offset:13312
    v_mfma_f32_16x16x32_bf16 v[84:87], v[28:31], v[128:131], 0
    ds_read_b128 v[24:27], v3 offset:14336
    s_waitcnt lgkmcnt(7)
    v_mfma_f32_16x16x32_bf16 v[88:91], v[32:35], v[128:131], 0
    ds_read_b128 v[28:31], v3 offset:15360
    buffer_load_dwordx4 v[148:151], v3, s[52:55], s30 offen offset:1024 sc1
    v_mfma_f32_16x16x32_bf16 v[92:95], v[36:39], v[128:131], 0
    ds_read_b128 v[32:35], v3 offset:16384
    v_mfma_f32_16x16x32_bf16 v[96:99], v[40:43], v[128:131], 0
    ds_read_b128 v[36:39], v3 offset:17408
    s_waitcnt vmcnt(4)
    v_mfma_f32_16x16x32_bf16 v[72:75], v[44:47], v[132:135], v[72:75]
    ds_read_b128 v[40:43], v3 offset:18432
    s_waitcnt lgkmcnt(7)
    v_mfma_f32_16x16x32_bf16 v[76:79], v[48:51], v[132:135], v[76:79]
    ds_read_b128 v[44:47], v3 offset:19456
    buffer_load_dwordx4 v[152:155], v3, s[52:55], s30 offen offset:2048 sc1
    v_mfma_f32_16x16x32_bf16 v[80:83], v[52:55], v[132:135], v[80:83]
    ds_read_b128 v[48:51], v3 offset:20480
    v_mfma_f32_16x16x32_bf16 v[84:87], v[56:59], v[132:135], v[84:87]
    ds_read_b128 v[52:55], v3 offset:21504
    v_mfma_f32_16x16x32_bf16 v[88:91], v[60:63], v[132:135], v[88:91]
    ds_read_b128 v[56:59], v3 offset:22528
    s_waitcnt lgkmcnt(7)
    v_mfma_f32_16x16x32_bf16 v[92:95], v[16:19], v[132:135], v[92:95]
    ds_read_b128 v[60:63], v3 offset:23552
    buffer_load_dwordx4 v[156:159], v3, s[52:55], s30 offen offset:3072 sc1
    v_mfma_f32_16x16x32_bf16 v[96:99], v[20:23], v[132:135], v[96:99]
    ds_read_b128 v[16:19], v3 offset:24576
    s_waitcnt vmcnt(5)
    v_mfma_f32_16x16x32_bf16 v[72:75], v[24:27], v[136:139], v[72:75]
    ds_read_b128 v[20:23], v3 offset:25600
    v_mfma_f32_16x16x32_bf16 v[76:79], v[28:31], v[136:139], v[76:79]
    ds_read_b128 v[24:27], v3 offset:26624
    s_waitcnt lgkmcnt(7)
    v_mfma_f32_16x16x32_bf16 v[80:83], v[32:35], v[136:139], v[80:83]
    ds_read_b128 v[28:31], v3 offset:27648
    s_add_u32 s30, s46, 8192
    buffer_load_dwordx4 v[160:163], v3, s[52:55], s30 offen offset:0 sc1
    v_mfma_f32_16x16x32_bf16 v[84:87], v[36:39], v[136:139], v[84:87]
    ds_read_b128 v[32:35], v3 offset:28672
    v_mfma_f32_16x16x32_bf16 v[88:91], v[40:43], v[136:139], v[88:91]
    ds_read_b128 v[36:39], v3 offset:29696
    v_mfma_f32_16x16x32_bf16 v[92:95], v[44:47], v[136:139], v[92:95]
    ds_read_b128 v[40:43], v3 offset:30720
    s_waitcnt lgkmcnt(7)
    v_mfma_f32_16x16x32_bf16 v[96:99], v[48:51], v[136:139], v[96:99]
    ds_read_b128 v[44:47], v3 offset:31744
    buffer_load_dwordx4 v[164:167], v3, s[52:55], s30 offen offset:1024 sc1
    s_waitcnt vmcnt(6)
    v_mfma_f32_16x16x32_bf16 v[72:75], v[52:55], v[140:143], v[72:75]
    ds_read_b128 v[48:51], v3 offset:32768
    v_mfma_f32_16x16x32_bf16 v[76:79], v[56:59], v[140:143], v[76:79]
    ds_read_b128 v[52:55], v3 offset:33792
    v_mfma_f32_16x16x32_bf16 v[80:83], v[60:63], v[140:143], v[80:83]
    ds_read_b128 v[56:59], v3 offset:34816
    s_waitcnt lgkmcnt(7)
    v_mfma_f32_16x16x32_bf16 v[84:87], v[16:19], v[140:143], v[84:87]
    ds_read_b128 v[60:63], v3 offset:35840
    buffer_load_dwordx4 v[168:171], v3, s[52:55], s30 offen offset:2048 sc1
    v_mfma_f32_16x16x32_bf16 v[88:91], v[20:23], v[140:143], v[88:91]
    ds_read_b128 v[16:19], v3 offset:36864
    buffer_load_dwordx4 v[68:71], v4, s[52:55], s8 offen offset:0 sc1
    v_mfma_f32_16x16x32_bf16 v[92:95], v[24:27], v[140:143], v[92:95]
    ds_read_b128 v[20:23], v3 offset:37888
    v_mfma_f32_16x16x32_bf16 v[96:99], v[28:31], v[140:143], v[96:99]
    ds_read_b128 v[24:27], v3 offset:38912
    s_waitcnt vmcnt(7) lgkmcnt(7)
    v_mfma_f32_16x16x32_bf16 v[72:75], v[32:35], v[144:147], v[72:75]
    ds_read_b128 v[28:31], v3 offset:39936
    buffer_load_dwordx4 v[172:175], v3, s[52:55], s30 offen offset:3072 sc1
    v_mfma_f32_16x16x32_bf16 v[76:79], v[36:39], v[144:147], v[76:79]
    ds_read_b128 v[32:35], v3 offset:40960
    v_mfma_f32_16x16x32_bf16 v[80:83], v[40:43], v[144:147], v[80:83]
    ds_read_b128 v[36:39], v3 offset:41984
    v_mfma_f32_16x16x32_bf16 v[84:87], v[44:47], v[144:147], v[84:87]
    ds_read_b128 v[40:43], v3 offset:43008
    s_waitcnt lgkmcnt(7)
    v_mfma_f32_16x16x32_bf16 v[88:91], v[48:51], v[144:147], v[88:91]
    ds_read_b128 v[44:47], v3 offset:44032
    s_add_u32 s30, s46, 12288
    buffer_load_dwordx4 v[176:179], v3, s[52:55], s30 offen offset:0 sc1
    v_mfma_f32_16x16x32_bf16 v[92:95], v[52:55], v[144:147], v[92:95]
    ds_read_b128 v[48:51], v3 offset:45056
    v_mfma_f32_16x16x32_bf16 v[96:99], v[56:59], v[144:147], v[96:99]
    ds_read_b128 v[52:55], v3 offset:46080
    s_waitcnt vmcnt(8)
    v_mfma_f32_16x16x32_bf16 v[72:75], v[60:63], v[148:151], v[72:75]
    ds_read_b128 v[56:59], v3 offset:47104
    s_waitcnt lgkmcnt(7)
    v_mfma_f32_16x16x32_bf16 v[76:79], v[16:19], v[148:151], v[76:79]
    ds_read_b128 v[60:63], v3 offset:48128
    buffer_load_dwordx4 v[180:183], v3, s[52:55], s30 offen offset:1024 sc1
    v_mfma_f32_16x16x32_bf16 v[80:83], v[20:23], v[148:151], v[80:83]
    ds_read_b128 v[16:19], v3 offset:49152
    v_mfma_f32_16x16x32_bf16 v[84:87], v[24:27], v[148:151], v[84:87]
    ds_read_b128 v[20:23], v3 offset:50176
    v_mfma_f32_16x16x32_bf16 v[88:91], v[28:31], v[148:151], v[88:91]
    ds_read_b128 v[24:27], v3 offset:51200
    s_waitcnt lgkmcnt(7)
    v_mfma_f32_16x16x32_bf16 v[92:95], v[32:35], v[148:151], v[92:95]
    ds_read_b128 v[28:31], v3 offset:52224
    buffer_load_dwordx4 v[184:187], v3, s[52:55], s30 offen offset:2048 sc1
    v_mfma_f32_16x16x32_bf16 v[96:99], v[36:39], v[148:151], v[96:99]
    ds_read_b128 v[32:35], v3 offset:53248
    s_waitcnt vmcnt(9)
    v_mfma_f32_16x16x32_bf16 v[72:75], v[40:43], v[152:155], v[72:75]
    ds_read_b128 v[36:39], v3 offset:54272
    v_mfma_f32_16x16x32_bf16 v[76:79], v[44:47], v[152:155], v[76:79]
    ds_read_b128 v[40:43], v3 offset:55296
    buffer_load_dwordx4 v[188:191], v3, s[52:55], s30 offen offset:3072 sc1
    s_waitcnt lgkmcnt(7)
    v_mfma_f32_16x16x32_bf16 v[80:83], v[48:51], v[152:155], v[80:83]
    ds_read_b128 v[44:47], v3 offset:56320
    v_mfma_f32_16x16x32_bf16 v[84:87], v[52:55], v[152:155], v[84:87]
    ds_read_b128 v[48:51], v6 offset:0
    v_mfma_f32_16x16x32_bf16 v[88:91], v[56:59], v[152:155], v[88:91]
    ds_read_b128 v[52:55], v6 offset:1024
    v_mfma_f32_16x16x32_bf16 v[92:95], v[60:63], v[152:155], v[92:95]
    ds_read_b128 v[56:59], v6 offset:2048
    s_add_u32 s31, s46, 16384
    buffer_load_dwordx4 v[192:195], v3, s[52:55], s31 offen offset:0 sc1
    s_waitcnt lgkmcnt(7)
    v_mfma_f32_16x16x32_bf16 v[96:99], v[16:19], v[152:155], v[96:99]
    ds_read_b128 v[60:63], v6 offset:3072
    s_waitcnt vmcnt(10)
    v_mfma_f32_16x16x32_bf16 v[72:75], v[20:23], v[156:159], v[72:75]
    ds_read_b128 v[16:19], v6 offset:4096
    v_mfma_f32_16x16x32_bf16 v[76:79], v[24:27], v[156:159], v[76:79]
    ds_read_b128 v[20:23], v6 offset:5120
    v_mfma_f32_16x16x32_bf16 v[80:83], v[28:31], v[156:159], v[80:83]
    ds_read_b128 v[24:27], v6 offset:6144
    buffer_load_dwordx4 v[196:199], v3, s[52:55], s31 offen offset:1024 sc1
    s_waitcnt lgkmcnt(7)
    v_mfma_f32_16x16x32_bf16 v[84:87], v[32:35], v[156:159], v[84:87]
    ds_read_b128 v[28:31], v6 offset:7168
    v_mfma_f32_16x16x32_bf16 v[88:91], v[36:39], v[156:159], v[88:91]
    ds_read_b128 v[32:35], v6 offset:8192
    v_mfma_f32_16x16x32_bf16 v[92:95], v[40:43], v[156:159], v[92:95]
    ds_read_b128 v[36:39], v6 offset:9216
    v_mfma_f32_16x16x32_bf16 v[96:99], v[44:47], v[156:159], v[96:99]
    ds_read_b128 v[40:43], v6 offset:10240
    buffer_load_dwordx4 v[200:203], v3, s[52:55], s31 offen offset:2048 sc1
    s_waitcnt vmcnt(11) lgkmcnt(7)
    v_mfma_f32_16x16x32_bf16 v[72:75], v[48:51], v[160:163], v[72:75]
    ds_read_b128 v[44:47], v6 offset:11264
    v_mfma_f32_16x16x32_bf16 v[76:79], v[52:55], v[160:163], v[76:79]
    ds_read_b128 v[48:51], v6 offset:12288
    v_mfma_f32_16x16x32_bf16 v[80:83], v[56:59], v[160:163], v[80:83]
    ds_read_b128 v[52:55], v6 offset:13312
    v_mfma_f32_16x16x32_bf16 v[84:87], v[60:63], v[160:163], v[84:87]
    ds_read_b128 v[56:59], v6 offset:14336
    buffer_load_dwordx4 v[204:207], v3, s[52:55], s31 offen offset:3072 sc1
    s_waitcnt lgkmcnt(7)
    v_mfma_f32_16x16x32_bf16 v[88:91], v[16:19], v[160:163], v[88:91]
    ds_read_b128 v[60:63], v6 offset:15360
    v_mfma_f32_16x16x32_bf16 v[92:95], v[20:23], v[160:163], v[92:95]
    ds_read_b128 v[16:19], v6 offset:16384
    v_mfma_f32_16x16x32_bf16 v[96:99], v[24:27], v[160:163], v[96:99]
    ds_read_b128 v[20:23], v6 offset:17408
    s_waitcnt vmcnt(11)
    v_mfma_f32_16x16x32_bf16 v[72:75], v[28:31], v[164:167], v[72:75]
    ds_read_b128 v[24:27], v6 offset:18432
    s_add_u32 s31, s46, 20480
    buffer_load_dwordx4 v[208:211], v3, s[52:55], s31 offen offset:0 sc1
    s_waitcnt lgkmcnt(7)
    v_mfma_f32_16x16x32_bf16 v[76:79], v[32:35], v[164:167], v[76:79]
    ds_read_b128 v[28:31], v6 offset:19456
    s_waitcnt vmcnt(10)
    v_or_b32 v64, v69, v71
    v_cmp_gt_i32 vcc, 0, v64
    s_cbranch_vccnz SWAIT_88
SOK_87:
    v_mfma_f32_16x16x32_bf16 v[80:83], v[36:39], v[164:167], v[80:83]
    ds_read_b128 v[32:35], v6 offset:20480
    v_add_f32 v68, v68, v70
    v_mfma_f32_16x16x32_bf16 v[84:87], v[40:43], v[164:167], v[84:87]
    ds_read_b128 v[36:39], v6 offset:21504
    v_add_f32 v69, v69, v71
    v_mfma_f32_16x16x32_bf16 v[88:91], v[44:47], v[164:167], v[88:91]
    ds_read_b128 v[40:43], v6 offset:22528
    buffer_load_dwordx4 v[212:215], v3, s[52:55], s31 offen offset:1024 sc1
    s_waitcnt lgkmcnt(7)
    v_mfma_f32_16x16x32_bf16 v[92:95], v[48:51], v[164:167], v[92:95]
    ds_read_b128 v[44:47], v6 offset:23552
    v_mov_b32 v70, v68
    v_mfma_f32_16x16x32_bf16 v[96:99], v[52:55], v[164:167], v[96:99]
    ds_read_b128 v[48:51], v6 offset:24576
    v_mfma_f32_16x16x32_bf16 v[72:75], v[56:59], v[168:171], v[72:75]
    ds_read_b128 v[52:55], v6 offset:25600
    v_mov_b32 v71, v69
    v_mfma_f32_16x16x32_bf16 v[76:79], v[60:63], v[168:171], v[76:79]
    ds_read_b128 v[56:59], v6 offset:26624
    buffer_load_dwordx4 v[216:219], v3, s[52:55], s31 offen offset:2048 sc1
    s_waitcnt lgkmcnt(7)
    v_mfma_f32_16x16x32_bf16 v[80:83], v[16:19], v[168:171], v[80:83]
    ds_read_b128 v[60:63], v6 offset:27648
    s_nop 0
    v_mfma_f32_16x16x32_bf16 v[84:87], v[20:23], v[168:171], v[84:87]
    ds_read_b128 v[16:19], v6 offset:28672
    v_permlane16_swap_b32 v68, v70
    v_mfma_f32_16x16x32_bf16 v[88:91], v[24:27], v[168:171], v[88:91]
    ds_read_b128 v[20:23], v6 offset:29696
    v_permlane16_swap_b32 v69, v71
    v_mfma_f32_16x16x32_bf16 v[92:95], v[28:31], v[168:171], v[92:95]
    ds_read_b128 v[24:27], v6 offset:30720
    buffer_load_dwordx4 v[220:223], v3, s[52:55], s31 offen offset:3072 sc1
    s_waitcnt lgkmcnt(7)
    v_mfma_f32_16x16x32_bf16 v[96:99], v[32:35], v[168:171], v[96:99]
    ds_read_b128 v[28:31], v6 offset:31744
    s_waitcnt vmcnt(12)
    v_mfma_f32_16x16x32_bf16 v[72:75], v[36:39], v[172:175], v[72:75]
    ds_read_b128 v[32:35], v6 offset:32768
    s_nop 0
    v_mfma_f32_16x16x32_bf16 v[76:79], v[40:43], v[172:175], v[76:79]
    ds_read_b128 v[36:39], v6 offset:33792
    v_add_f32 v68, v68, v70
    v_mfma_f32_16x16x32_bf16 v[80:83], v[44:47], v[172:175], v[80:83]
    ds_read_b128 v[40:43], v6 offset:34816
    s_add_u32 s31, s46, 24576
    buffer_load_dwordx4 v[224:227], v3, s[52:55], s31 offen offset:0 sc1
    s_waitcnt lgkmcnt(7)
    v_mfma_f32_16x16x32_bf16 v[84:87], v[48:51], v[172:175], v[84:87]
    ds_read_b128 v[44:47], v6 offset:35840
    v_add_f32 v69, v69, v71
    v_mfma_f32_16x16x32_bf16 v[88:91], v[52:55], v[172:175], v[88:91]
    ds_read_b128 v[48:51], v6 offset:36864
    v_mov_b32 v70, v68
    v_mfma_f32_16x16x32_bf16 v[92:95], v[56:59], v[172:175], v[92:95]
    ds_read_b128 v[52:55], v6 offset:37888
    buffer_load_dwordx4 v[228:231], v3, s[52:55], s31 offen offset:1024 sc1
    v_mfma_f32_16x16x32_bf16 v[96:99], v[60:63], v[172:175], v[96:99]
    ds_read_b128 v[56:59], v6 offset:38912
    s_waitcnt vmcnt(13) lgkmcnt(7)
    v_mfma_f32_16x16x32_bf16 v[72:75], v[16:19], v[176:179], v[72:75]
    ds_read_b128 v[60:63], v6 offset:39936
    v_mov_b32 v71, v69
    v_mfma_f32_16x16x32_bf16 v[76:79], v[20:23], v[176:179], v[76:79]
    ds_read_b128 v[16:19], v6 offset:40960
    s_nop 0
    v_mfma_f32_16x16x32_bf16 v[80:83], v[24:27], v[176:179], v[80:83]
    ds_read_b128 v[20:23], v6 offset:41984
    buffer_load_dwordx4 v[232:235], v3, s[52:55], s31 offen offset:2048 sc1
    v_mfma_f32_16x16x32_bf16 v[84:87], v[28:31], v[176:179], v[84:87]
    ds_read_b128 v[24:27], v6 offset:43008
    s_waitcnt lgkmcnt(7)
    v_mfma_f32_16x16x32_bf16 v[88:91], v[32:35], v[176:179], v[88:91]
    ds_read_b128 v[28:31], v6 offset:44032
    v_permlane32_swap_b32 v68, v70
    v_mfma_f32_16x16x32_bf16 v[92:95], v[36:39], v[176:179], v[92:95]
    ds_read_b128 v[32:35], v6 offset:45056
    v_permlane32_swap_b32 v69, v71
    v_mfma_f32_16x16x32_bf16 v[96:99], v[40:43], v[176:179], v[96:99]
    ds_read_b128 v[36:39], v6 offset:46080
    buffer_load_dwordx4 v[236:239], v3, s[52:55], s31 offen offset:3072 sc1
    s_waitcnt vmcnt(14)
    v_mfma_f32_16x16x32_bf16 v[72:75], v[44:47], v[180:183], v[72:75]
    ds_read_b128 v[40:43], v6 offset:47104
    s_waitcnt lgkmcnt(7)
    v_mfma_f32_16x16x32_bf16 v[76:79], v[48:51], v[180:183], v[76:79]
    ds_read_b128 v[44:47], v6 offset:48128
    s_nop 0
    v_mfma_f32_16x16x32_bf16 v[80:83], v[52:55], v[180:183], v[80:83]
    ds_read_b128 v[48:51], v6 offset:49152
    v_add_f32 v68, v68, v70
    v_mfma_f32_16x16x32_bf16 v[84:87], v[56:59], v[180:183], v[84:87]
    ds_read_b128 v[52:55], v6 offset:50176
    s_add_u32 s31, s46, 28672
    buffer_load_dwordx4 v[240:243], v3, s[52:55], s31 offen offset:0 sc1
    v_mfma_f32_16x16x32_bf16 v[88:91], v[60:63], v[180:183], v[88:91]
    ds_read_b128 v[56:59], v6 offset:51200
    s_waitcnt lgkmcnt(7)
    v_mfma_f32_16x16x32_bf16 v[92:95], v[16:19], v[180:183], v[92:95]
    ds_read_b128 v[60:63], v6 offset:52224
    v_add_f32 v69, v69, v71
    v_mfma_f32_16x16x32_bf16 v[96:99], v[20:23], v[180:183], v[96:99]
    ds_read_b128 v[16:19], v6 offset:53248
    s_waitcnt vmcnt(14)
    v_mfma_f32_16x16x32_bf16 v[72:75], v[24:27], v[184:187], v[72:75]
    ds_read_b128 v[20:23], v6 offset:54272
    buffer_load_dwordx4 v[244:247], v3, s[52:55], s31 offen offset:1024 sc1
    v_mfma_f32_16x16x32_bf16 v[76:79], v[28:31], v[184:187], v[76:79]
    ds_read_b128 v[24:27], v6 offset:55296
    s_waitcnt lgkmcnt(7)
    v_mfma_f32_16x16x32_bf16 v[80:83], v[32:35], v[184:187], v[80:83]
    ds_read_b128 v[28:31], v6 offset:56320
    v_mul_f32 v68, 0x3b000000, v68
    v_mfma_f32_16x16x32_bf16 v[84:87], v[36:39], v[184:187], v[84:87]
    ds_read_b128 v[32:35], v3 offset:0
    v_mul_f32 v69, 0x3b000000, v69
    v_mfma_f32_16x16x32_bf16 v[88:91], v[40:43], v[184:187], v[88:91]
    ds_read_b128 v[36:39], v3 offset:1024
    buffer_load_dwordx4 v[248:251], v3, s[52:55], s31 offen offset:2048 sc1
    v_mfma_f32_16x16x32_bf16 v[92:95], v[44:47], v[184:187], v[92:95]
    ds_read_b128 v[40:43], v3 offset:2048
    s_waitcnt lgkmcnt(7)
    v_mfma_f32_16x16x32_bf16 v[96:99], v[48:51], v[184:187], v[96:99]
    ds_read_b128 v[44:47], v3 offset:3072
    s_waitcnt vmcnt(15)
    v_mfma_f32_16x16x32_bf16 v[72:75], v[52:55], v[188:191], v[72:75]
    ds_read_b128 v[48:51], v3 offset:4096
    v_fma_f32 v69, -v68, v68, v69
    v_mfma_f32_16x16x32_bf16 v[76:79], v[56:59], v[188:191], v[76:79]
    ds_read_b128 v[52:55], v3 offset:5120
    buffer_load_dwordx4 v[252:255], v3, s[52:55], s31 offen offset:3072 sc1
    v_mfma_f32_16x16x32_bf16 v[80:83], v[60:63], v[188:191], v[80:83]
    ds_read_b128 v[56:59], v3 offset:6144
    s_waitcnt lgkmcnt(7)
    v_mfma_f32_16x16x32_bf16 v[84:87], v[16:19], v[188:191], v[84:87]
    ds_read_b128 v[60:63], v3 offset:7168
    v_max_f32 v69, 0, v69
    v_mfma_f32_16x16x32_bf16 v[88:91], v[20:23], v[188:191], v[88:91]
    ds_read_b128 v[16:19], v3 offset:8192
    v_cvt_pk_bf16_f32 v71, v68, v69
    v_mfma_f32_16x16x32_bf16 v[92:95], v[24:27], v[188:191], v[92:95]
    ds_read_b128 v[20:23], v3 offset:9216
    v_lshlrev_b32 v68, 16, v71
    v_mfma_f32_16x16x32_bf16 v[96:99], v[28:31], v[188:191], v[96:99]
    ds_read_b128 v[24:27], v3 offset:10240
    v_and_b32 v69, 0xffff0000, v71
    v_add_f32 v69, 0x3727c5ac, v69
    v_cvt_pk_bf16_f32 v71, v69, v69
    v_lshlrev_b32 v69, 16, v71
    v_sqrt_f32 v69, v69
    s_nop 0
    v_cvt_pk_bf16_f32 v71, v69, v69
    v_lshlrev_b32 v70, 16, v71
    v_rcp_f32 v69, v70
    s_nop 0
    v_cvt_pk_bf16_f32 v64, -v68, -v68
    v_cvt_pk_bf16_f32 v65, -v68, v70
    v_mul_f32 v69, v69, v69
    v_cndmask_b32 v64, 0, v64, s[34:35]
    v_cndmask_b32 v65, 0, v65, s[34:35]
    buffer_store_dword v69, v8, s[52:55], s13 offen offset:0 sc0 sc1
    buffer_load_dwordx4 v[68:71], v4, s[52:55], s8 offen offset:1024 sc1
    v_lshrrev_b32 v13, 2, v3
    v_and_b32 v13, 28, v13
    s_nop 1
    v_mfma_f32_16x16x16_bf16 v[72:75], a[240:241], v[64:65], v[72:75]
    v_mfma_f32_16x16x16_bf16 v[76:79], a[242:243], v[64:65], v[76:79]
    v_mfma_f32_16x16x16_bf16 v[80:83], a[244:245], v[64:65], v[80:83]
    v_mfma_f32_16x16x16_bf16 v[84:87], a[246:247], v[64:65], v[84:87]
    v_mfma_f32_16x16x16_bf16 v[88:91], a[248:249], v[64:65], v[88:91]
    v_mfma_f32_16x16x16_bf16 v[92:95], a[250:251], v[64:65], v[92:95]
    v_mfma_f32_16x16x16_bf16 v[96:99], a[252:253], v[64:65], v[96:99]
    s_waitcnt vmcnt(17) lgkmcnt(7)
    v_mfma_f32_16x16x32_bf16 v[100:103], v[32:35], v[192:195], 0
    ds_read_b128 v[28:31], v3 offset:11264
    v_mfma_f32_16x16x32_bf16 v[104:107], v[36:39], v[192:195], 0
    ds_read_b128 v[32:35], v3 offset:12288
    v_mfma_f32_16x16x32_bf16 v[108:111], v[40:43], v[192:195], 0
    ds_read_b128 v[36:39], v3 offset:13312
    v_mfma_f32_16x16x32_bf16 v[112:115], v[44:47], v[192:195], 0
    ds_read_b128 v[40:43], v3 offset:14336
    v_mul_f32 v72, v72, abs(v72)
    v_mul_f32 v73, v73, abs(v73)
    v_mul_f32 v74, v74, abs(v74)
    v_mul_f32 v75, v75, abs(v75)
    v_mul_f32 v76, v76, abs(v76)
    v_mul_f32 v77, v77, abs(v77)
    s_waitcnt lgkmcnt(7)
    v_mfma_f32_16x16x32_bf16 v[116:119], v[48:51], v[192:195], 0
    ds_read_b128 v[44:47], v3 offset:15360
    v_mul_f32 v78, v78, abs(v78)
    v_mul_f32 v79, v79, abs(v79)
    v_cvt_pk_bf16_f32 v72, v72, v73
    v_cvt_pk_bf16_f32 v73, v74, v75
    v_cvt_pk_bf16_f32 v74, v76, v77
    v_cvt_pk_bf16_f32 v75, v78, v79
    v_mfma_f32_16x16x32_bf16 v[120:123], v[52:55], v[192:195], 0
    ds_read_b128 v[48:51], v3 offset:16384
    v_pk_max_i16 v72, v72, 0
    v_pk_max_i16 v73, v73, 0
    v_pk_max_i16 v74, v74, 0
    v_pk_max_i16 v75, v75, 0
    buffer_store_dwordx4 v[72:75], v0, s[52:55], s10 offen offset:0 sc0 sc1
    v_mul_f32 v80, v80, abs(v80)
    v_mfma_f32_16x16x32_bf16 v[124:127], v[56:59], v[192:195], 0
    ds_read_b128 v[52:55], v3 offset:17408
    v_mul_f32 v81, v81, abs(v81)
    v_mul_f32 v82, v82, abs(v82)
    v_mul_f32 v83, v83, abs(v83)
    v_mul_f32 v84, v84, abs(v84)
    v_mul_f32 v85, v85, abs(v85)
    v_mul_f32 v86, v86, abs(v86)
    s_waitcnt vmcnt(17)
    v_mfma_f32_16x16x32_bf16 v[100:103], v[60:63], v[196:199], v[100:103]
    ds_read_b128 v[56:59], v3 offset:18432
    v_mul_f32 v87, v87, abs(v87)
    v_cvt_pk_bf16_f32 v80, v80, v81
    v_cvt_pk_bf16_f32 v81, v82, v83
    v_cvt_pk_bf16_f32 v82, v84, v85
    v_cvt_pk_bf16_f32 v83, v86, v87
    v_pk_max_i16 v80, v80, 0
    s_waitcnt lgkmcnt(7)
    v_mfma_f32_16x16x32_bf16 v[104:107], v[16:19], v[196:199], v[104:107]
    ds_read_b128 v[60:63], v3 offset:19456
    v_pk_max_i16 v81, v81, 0
    v_pk_max_i16 v82, v82, 0
    v_pk_max_i16 v83, v83, 0
    buffer_store_dwordx4 v[80:83], v0, s[52:55], s10 offen offset:2048 sc0 sc1
    v_mul_f32 v88, v88, abs(v88)
    v_mul_f32 v89, v89, abs(v89)
    v_mfma_f32_16x16x32_bf16 v[108:111], v[20:23], v[196:199], v[108:111]
    ds_read_b128 v[16:19], v3 offset:20480
    v_mul_f32 v90, v90, abs(v90)
    v_mul_f32 v91, v91, abs(v91)
    v_mul_f32 v92, v92, abs(v92)
    v_mul_f32 v93, v93, abs(v93)
    v_mul_f32 v94, v94, abs(v94)
    v_mul_f32 v95, v95, abs(v95)
    v_mfma_f32_16x16x32_bf16 v[112:115], v[24:27], v[196:199], v[112:115]
    ds_read_b128 v[20:23], v3 offset:21504
    v_cvt_pk_bf16_f32 v88, v88, v89
    v_cvt_pk_bf16_f32 v89, v90, v91
    v_cvt_pk_bf16_f32 v90, v92, v93
    v_cvt_pk_bf16_f32 v91, v94, v95
    v_pk_max_i16 v88, v88, 0
    v_pk_max_i16 v89, v89, 0
    v_mfma_f32_16x16x32_bf16 v[116:119], v[28:31], v[196:199], v[116:119]
    ds_read_b128 v[24:27], v3 offset:22528
    v_pk_max_i16 v90, v90, 0
    v_pk_max_i16 v91, v91, 0
    buffer_store_dwordx4 v[88:91], v0, s[52:55], s11 offen offset:0 sc0 sc1
    v_mul_f32 v96, v96, abs(v96)
    v_mul_f32 v97, v97, abs(v97)
    v_mul_f32 v98, v98, abs(v98)
    s_waitcnt lgkmcnt(7)
    v_mfma_f32_16x16x32_bf16 v[120:123], v[32:35], v[196:199], v[120:123]
    ds_read_b128 v[28:31], v3 offset:23552
    v_mul_f32 v99, v99, abs(v99)
    v_cvt_pk_bf16_f32 v96, v96, v97
    v_cvt_pk_bf16_f32 v97, v98, v99
    v_pk_max_i16 v96, v96, 0
    v_pk_max_i16 v97, v97, 0
    buffer_store_dwordx2 v[96:97], v1, s[52:55], s11 offen offset:2048 sc0 sc1
    v_mfma_f32_16x16x32_bf16 v[124:127], v[36:39], v[196:199], v[124:127]
    ds_read_b128 v[32:35], v3 offset:24576
    s_waitcnt vmcnt(4)
    v_or_b32 v66, v69, v71
    v_cmp_gt_i32 vcc, 0, v66
    s_cbranch_vccnz SWAIT_91
SOK_90:
    v_mfma_f32_16x16x32_bf16 v[100:103], v[40:43], v[200:203], v[100:103]
    ds_read_b128 v[36:39], v3 offset:25600
    v_add_f32 v68, v68, v70
    v_mfma_f32_16x16x32_bf16 v[104:107], v[44:47], v[200:203], v[104:107]
    ds_read_b128 v[40:43], v3 offset:26624
    v_add_f32 v69, v69, v71
    s_waitcnt lgkmcnt(7)
    v_mfma_f32_16x16x32_bf16 v[108:111], v[48:51], v[200:203], v[108:111]
    ds_read_b128 v[44:47], v3 offset:27648
    v_mov_b32 v70, v68
    v_mfma_f32_16x16x32_bf16 v[112:115], v[52:55], v[200:203], v[112:115]
    ds_read_b128 v[48:51], v3 offset:28672
    v_mov_b32 v71, v69
    v_mfma_f32_16x16x32_bf16 v[116:119], v[56:59], v[200:203], v[116:119]
    ds_read_b128 v[52:55], v3 offset:29696
    s_nop 0
    v_mfma_f32_16x16x32_bf16 v[120:123], v[60:63], v[200:203], v[120:123]
    ds_read_b128 v[56:59], v3 offset:30720
    v_permlane16_swap_b32 v68, v70
    s_waitcnt lgkmcnt(7)
    v_mfma_f32_16x16x32_bf16 v[124:127], v[16:19], v[200:203], v[124:127]
    ds_read_b128 v[60:63], v3 offset:31744
    v_permlane16_swap_b32 v69, v71
    v_mfma_f32_16x16x32_bf16 v[100:103], v[20:23], v[204:207], v[100:103]
    ds_read_b128 v[16:19], v3 offset:32768
    s_nop 0
    v_mfma_f32_16x16x32_bf16 v[104:107], v[24:27], v[204:207], v[104:107]
    ds_read_b128 v[20:23], v3 offset:33792
    v_add_f32 v68, v68, v70
    v_mfma_f32_16x16x32_bf16 v[108:111], v[28:31], v[204:207], v[108:111]
    ds_read_b128 v[24:27], v3 offset:34816
    v_add_f32 v69, v69, v71
    s_waitcnt lgkmcnt(7)
    v_mfma_f32_16x16x32_bf16 v[112:115], v[32:35], v[204:207], v[112:115]
    ds_read_b128 v[28:31], v3 offset:35840
    v_mov_b32 v70, v68
    v_mfma_f32_16x16x32_bf16 v[116:119], v[36:39], v[204:207], v[116:119]
    ds_read_b128 v[32:35], v3 offset:36864
    v_mov_b32 v71, v69
    v_mfma_f32_16x16x32_bf16 v[120:123], v[40:43], v[204:207], v[120:123]
    ds_read_b128 v[36:39], v3 offset:37888
    s_nop 0
    v_mfma_f32_16x16x32_bf16 v[124:127], v[44:47], v[204:207], v[124:127]
    ds_read_b128 v[40:43], v3 offset:38912
    v_permlane32_swap_b32 v68, v70
    s_waitcnt lgkmcnt(7)
    v_mfma_f32_16x16x32_bf16 v[100:103], v[48:51], v[208:211], v[100:103]
    ds_read_b128 v[44:47], v3 offset:39936
    v_permlane32_swap_b32 v69, v71
    v_mfma_f32_16x16x32_bf16 v[104:107], v[52:55], v[208:211], v[104:107]
    ds_read_b128 v[48:51], v3 offset:40960
    s_nop 0
    v_mfma_f32_16x16x32_bf16 v[108:111], v[56:59], v[208:211], v[108:111]
    ds_read_b128 v[52:55], v3 offset:41984
    v_add_f32 v68, v68, v70
    v_mfma_f32_16x16x32_bf16 v[112:115], v[60:63], v[208:211], v[112:115]
    ds_read_b128 v[56:59], v3 offset:43008
    v_add_f32 v69, v69, v71
    s_waitcnt lgkmcnt(7)
    v_mfma_f32_16x16x32_bf16 v[116:119], v[16:19], v[208:211], v[116:119]
    ds_read_b128 v[60:63], v3 offset:44032
    v_mul_f32 v68, 0x3b000000, v68
    v_mfma_f32_16x16x32_bf16 v[120:123], v[20:23], v[208:211], v[120:123]
    ds_read_b128 v[16:19], v3 offset:45056
    v_mul_f32 v69, 0x3b000000, v69
    v_mfma_f32_16x16x32_bf16 v[124:127], v[24:27], v[208:211], v[124:127]
    ds_read_b128 v[20:23], v3 offset:46080
    v_fma_f32 v69, -v68, v68, v69
    v_mfma_f32_16x16x32_bf16 v[100:103], v[28:31], v[212:215], v[100:103]
    ds_read_b128 v[24:27], v3 offset:47104
    v_max_f32 v69, 0, v69
    s_waitcnt lgkmcnt(7)
    v_mfma_f32_16x16x32_bf16 v[104:107], v[32:35], v[212:215], v[104:107]
    ds_read_b128 v[28:31], v3 offset:48128
    v_cvt_pk_bf16_f32 v71, v68, v69
    v_mfma_f32_16x16x32_bf16 v[108:111], v[36:39], v[212:215], v[108:111]
    ds_read_b128 v[32:35], v3 offset:49152
    v_lshlrev_b32 v68, 16, v71
    v_mfma_f32_16x16x32_bf16 v[112:115], v[40:43], v[212:215], v[112:115]
    ds_read_b128 v[36:39], v3 offset:50176
    v_and_b32 v69, 0xffff0000, v71
    v_mfma_f32_16x16x32_bf16 v[116:119], v[44:47], v[212:215], v[116:119]
    ds_read_b128 v[40:43], v3 offset:51200
    v_add_f32 v69, 0x3727c5ac, v69
    s_waitcnt lgkmcnt(7)
    v_mfma_f32_16x16x32_bf16 v[120:123], v[48:51], v[212:215], v[120:123]
    ds_read_b128 v[44:47], v3 offset:52224
    v_cvt_pk_bf16_f32 v71, v69, v69
    v_mfma_f32_16x16x32_bf16 v[124:127], v[52:55], v[212:215], v[124:127]
    ds_read_b128 v[48:51], v3 offset:53248
    v_lshlrev_b32 v69, 16, v71
    v_mfma_f32_16x16x32_bf16 v[100:103], v[56:59], v[216:219], v[100:103]
    ds_read_b128 v[52:55], v3 offset:54272
    v_sqrt_f32 v69, v69
    v_mfma_f32_16x16x32_bf16 v[104:107], v[60:63], v[216:219], v[104:107]
    ds_read_b128 v[56:59], v3 offset:55296
    s_nop 0
    s_waitcnt lgkmcnt(7)
    v_mfma_f32_16x16x32_bf16 v[108:111], v[16:19], v[216:219], v[108:111]
    ds_read_b128 v[60:63], v3 offset:56320
    v_cvt_pk_bf16_f32 v71, v69, v69
    v_mfma_f32_16x16x32_bf16 v[112:115], v[20:23], v[216:219], v[112:115]
    ds_read_b128 v[16:19], v6 offset:0
    v_lshlrev_b32 v70, 16, v71
    v_mfma_f32_16x16x32_bf16 v[116:119], v[24:27], v[216:219], v[116:119]
    ds_read_b128 v[20:23], v6 offset:1024
    v_rcp_f32 v69, v70
    v_mfma_f32_16x16x32_bf16 v[120:123], v[28:31], v[216:219], v[120:123]
    ds_read_b128 v[24:27], v6 offset:2048
    s_nop 0
    s_waitcnt lgkmcnt(7)
    v_mfma_f32_16x16x32_bf16 v[124:127], v[32:35], v[216:219], v[124:127]
    ds_read_b128 v[28:31], v6 offset:3072
    v_cvt_pk_bf16_f32 v66, -v68, -v68
    v_mfma_f32_16x16x32_bf16 v[100:103], v[36:39], v[220:223], v[100:103]
    ds_read_b128 v[32:35], v6 offset:4096
    v_cvt_pk_bf16_f32 v67, -v68, v70
    v_mfma_f32_16x16x32_bf16 v[104:107], v[40:43], v[220:223], v[104:107]
    ds_read_b128 v[36:39], v6 offset:5120
    v_mul_f32 v69, v69, v69
    v_mfma_f32_16x16x32_bf16 v[108:111], v[44:47], v[220:223], v[108:111]
    ds_read_b128 v[40:43], v6 offset:6144
    v_cndmask_b32 v66, 0, v66, s[34:35]
    s_waitcnt lgkmcnt(7)
    v_mfma_f32_16x16x32_bf16 v[112:115], v[48:51], v[220:223], v[112:115]
    ds_read_b128 v[44:47], v6 offset:7168
    v_cndmask_b32 v67, 0, v67, s[34:35]
    v_mfma_f32_16x16x32_bf16 v[116:119], v[52:55], v[220:223], v[116:119]
    ds_read_b128 v[48:51], v6 offset:8192
    buffer_store_dword v69, v8, s[52:55], s13 offen offset:64 sc0 sc1
    v_mfma_f32_16x16x32_bf16 v[120:123], v[56:59], v[220:223], v[120:123]
    ds_read_b128 v[52:55], v6 offset:9216
    v_mfma_f32_16x16x32_bf16 v[124:127], v[60:63], v[220:223], v[124:127]
    ds_read_b128 v[56:59], v6 offset:10240
    v_mov_b32 v7, 1
    s_waitcnt lgkmcnt(7)
    v_mfma_f32_16x16x32_bf16 v[100:103], v[16:19], v[224:227], v[100:103]
    ds_read_b128 v[60:63], v6 offset:11264
    s_waitcnt vmcnt(1)
    buffer_store_dword v7, v9, s[52:55], s74 offen offset:0 sc0 sc1
    v_mfma_f32_16x16x32_bf16 v[104:107], v[20:23], v[224:227], v[104:107]
    ds_read_b128 v[16:19], v6 offset:12288
    v_mfma_f32_16x16x32_bf16 v[108:111], v[24:27], v[224:227], v[108:111]
    ds_read_b128 v[20:23], v6 offset:13312
    v_mfma_f32_16x16x32_bf16 v[112:115], v[28:31], v[224:227], v[112:115]
    ds_read_b128 v[24:27], v6 offset:14336
    s_waitcnt lgkmcnt(7)
    v_mfma_f32_16x16x32_bf16 v[116:119], v[32:35], v[224:227], v[116:119]
    ds_read_b128 v[28:31], v6 offset:15360
    v_mfma_f32_16x16x32_bf16 v[120:123], v[36:39], v[224:227], v[120:123]
    ds_read_b128 v[32:35], v6 offset:16384
    v_mfma_f32_16x16x32_bf16 v[124:127], v[40:43], v[224:227], v[124:127]
    ds_read_b128 v[36:39], v6 offset:17408
    v_mfma_f32_16x16x32_bf16 v[100:103], v[44:47], v[228:231], v[100:103]
    ds_read_b128 v[40:43], v6 offset:18432
    s_waitcnt lgkmcnt(7)
    v_mfma_f32_16x16x32_bf16 v[104:107], v[48:51], v[228:231], v[104:107]
    ds_read_b128 v[44:47], v6 offset:19456
    v_mfma_f32_16x16x32_bf16 v[108:111], v[52:55], v[228:231], v[108:111]
    ds_read_b128 v[48:51], v6 offset:20480
    v_mfma_f32_16x16x32_bf16 v[112:115], v[56:59], v[228:231], v[112:115]
    ds_read_b128 v[52:55], v6 offset:21504
    v_mfma_f32_16x16x32_bf16 v[116:119], v[60:63], v[228:231], v[116:119]
    ds_read_b128 v[56:59], v6 offset:22528
    s_waitcnt lgkmcnt(7)
    v_mfma_f32_16x16x32_bf16 v[120:123], v[16:19], v[228:231], v[120:123]
    ds_read_b128 v[60:63], v6 offset:23552
    v_mfma_f32_16x16x32_bf16 v[124:127], v[20:23], v[228:231], v[124:127]
    ds_read_b128 v[16:19], v6 offset:24576
    v_mfma_f32_16x16x32_bf16 v[100:103], v[24:27], v[232:235], v[100:103]
    ds_read_b128 v[20:23], v6 offset:25600
    buffer_load_dword v14, v13, s[52:55], s75 offen offset:0 sc1
    v_mfma_f32_16x16x32_bf16 v[104:107], v[28:31], v[232:235], v[104:107]
    ds_read_b128 v[24:27], v6 offset:26624
    s_waitcnt lgkmcnt(7)
    v_mfma_f32_16x16x32_bf16 v[108:111], v[32:35], v[232:235], v[108:111]
    ds_read_b128 v[28:31], v6 offset:27648
    v_mfma_f32_16x16x32_bf16 v[112:115], v[36:39], v[232:235], v[112:115]
    ds_read_b128 v[32:35], v6 offset:28672
    v_mfma_f32_16x16x32_bf16 v[116:119], v[40:43], v[232:235], v[116:119]
    ds_read_b128 v[36:39], v6 offset:29696
    v_mfma_f32_16x16x32_bf16 v[120:123], v[44:47], v[232:235], v[120:123]
    ds_read_b128 v[40:43], v6 offset:30720
    s_waitcnt lgkmcnt(7)
    v_mfma_f32_16x16x32_bf16 v[124:127], v[48:51], v[232:235], v[124:127]
    ds_read_b128 v[44:47], v6 offset:31744
    v_mfma_f32_16x16x32_bf16 v[100:103], v[52:55], v[236:239], v[100:103]
    ds_read_b128 v[48:51], v6 offset:32768
    v_mfma_f32_16x16x32_bf16 v[104:107], v[56:59], v[236:239], v[104:107]
    ds_read_b128 v[52:55], v6 offset:33792
    v_mfma_f32_16x16x32_bf16 v[108:111], v[60:63], v[236:239], v[108:111]
    ds_read_b128 v[56:59], v6 offset:34816
    s_waitcnt lgkmcnt(7)
    v_mfma_f32_16x16x32_bf16 v[112:115], v[16:19], v[236:239], v[112:115]
    ds_read_b128 v[60:63], v6 offset:35840
    v_mfma_f32_16x16x32_bf16 v[116:119], v[20:23], v[236:239], v[116:119]
    ds_read_b128 v[16:19], v6 offset:36864
    v_mfma_f32_16x16x32_bf16 v[120:123], v[24:27], v[236:239], v[120:123]
    ds_read_b128 v[20:23], v6 offset:37888
    v_mfma_f32_16x16x32_bf16 v[124:127], v[28:31], v[236:239], v[124:127]
    ds_read_b128 v[24:27], v6 offset:38912
    s_waitcnt lgkmcnt(7)
    v_mfma_f32_16x16x32_bf16 v[100:103], v[32:35], v[240:243], v[100:103]
    ds_read_b128 v[28:31], v6 offset:39936
    s_waitcnt vmcnt(0)
    v_cmp_gt_u32 vcc, 1, v14
    s_cbranch_vccnz FWAIT_94
FOK_93:
    v_mfma_f32_16x16x32_bf16 v[104:107], v[36:39], v[240:243], v[104:107]
    ds_read_b128 v[32:35], v6 offset:40960
    buffer_load_dwordx4 v[128:131], v3, s[52:55], s88 offen offset:0 sc1
    v_mfma_f32_16x16x32_bf16 v[108:111], v[40:43], v[240:243], v[108:111]
    ds_read_b128 v[36:39], v6 offset:41984
    v_mfma_f32_16x16x32_bf16 v[112:115], v[44:47], v[240:243], v[112:115]
    ds_read_b128 v[40:43], v6 offset:43008
    s_waitcnt lgkmcnt(7)
    v_mfma_f32_16x16x32_bf16 v[116:119], v[48:51], v[240:243], v[116:119]
    ds_read_b128 v[44:47], v6 offset:44032
    buffer_load_dwordx4 v[132:135], v3, s[52:55], s88 offen offset:1024 sc1
    v_mfma_f32_16x16x32_bf16 v[120:123], v[52:55], v[240:243], v[120:123]
    ds_read_b128 v[48:51], v6 offset:45056
    v_mfma_f32_16x16x32_bf16 v[124:127], v[56:59], v[240:243], v[124:127]
    ds_read_b128 v[52:55], v6 offset:46080
    v_mfma_f32_16x16x32_bf16 v[100:103], v[60:63], v[244:247], v[100:103]
    ds_read_b128 v[56:59], v6 offset:47104
    buffer_load_dwordx4 v[136:139], v3, s[52:55], s88 offen offset:2048 sc1
    s_waitcnt lgkmcnt(7)
    v_mfma_f32_16x16x32_bf16 v[104:107], v[16:19], v[244:247], v[104:107]
    ds_read_b128 v[60:63], v6 offset:48128
    v_mfma_f32_16x16x32_bf16 v[108:111], v[20:23], v[244:247], v[108:111]
    ds_read_b128 v[16:19], v6 offset:49152
    v_mfma_f32_16x16x32_bf16 v[112:115], v[24:27], v[244:247], v[112:115]
    ds_read_b128 v[20:23], v6 offset:50176
    buffer_load_dwordx4 v[140:143], v3, s[52:55], s88 offen offset:3072 sc1
    v_mfma_f32_16x16x32_bf16 v[116:119], v[28:31], v[244:247], v[116:119]
    ds_read_b128 v[24:27], v6 offset:51200
    s_waitcnt lgkmcnt(7)
    v_mfma_f32_16x16x32_bf16 v[120:123], v[32:35], v[244:247], v[120:123]
    ds_read_b128 v[28:31], v6 offset:52224
    v_mfma_f32_16x16x32_bf16 v[124:127], v[36:39], v[244:247], v[124:127]
    ds_read_b128 v[32:35], v6 offset:53248
    buffer_load_dwordx4 v[144:147], v3, s[52:55], s89 offen offset:0 sc1
    v_mfma_f32_16x16x32_bf16 v[100:103], v[40:43], v[248:251], v[100:103]
    ds_read_b128 v[36:39], v6 offset:54272
    v_mfma_f32_16x16x32_bf16 v[104:107], v[44:47], v[248:251], v[104:107]
    ds_read_b128 v[40:43], v6 offset:55296
    s_waitcnt lgkmcnt(7)
    v_mfma_f32_16x16x32_bf16 v[108:111], v[48:51], v[248:251], v[108:111]
    ds_read_b128 v[44:47], v6 offset:56320
    buffer_load_dwordx4 v[148:151], v3, s[52:55], s89 offen offset:1024 sc1
    v_mfma_f32_16x16x32_bf16 v[112:115], v[52:55], v[248:251], v[112:115]
    v_mfma_f32_16x16x32_bf16 v[116:119], v[56:59], v[248:251], v[116:119]
    v_mfma_f32_16x16x32_bf16 v[120:123], v[60:63], v[248:251], v[120:123]
    buffer_load_dwordx4 v[152:155], v3, s[52:55], s89 offen offset:2048 sc1
    s_waitcnt lgkmcnt(4)
    v_mfma_f32_16x16x32_bf16 v[124:127], v[16:19], v[248:251], v[124:127]
    v_mfma_f32_16x16x32_bf16 v[100:103], v[20:23], v[252:255], v[100:103]
    v_mfma_f32_16x16x32_bf16 v[104:107], v[24:27], v[252:255], v[104:107]
    buffer_load_dwordx4 v[156:159], v3, s[52:55], s89 offen offset:3072 sc1
    v_mfma_f32_16x16x32_bf16 v[108:111], v[28:31], v[252:255], v[108:111]
    s_waitcnt lgkmcnt(0)
    v_mfma_f32_16x16x32_bf16 v[112:115], v[32:35], v[252:255], v[112:115]
    v_mfma_f32_16x16x32_bf16 v[116:119], v[36:39], v[252:255], v[116:119]
    buffer_load_dwordx4 v[160:163], v3, s[52:55], s90 offen offset:0 sc1
    v_mfma_f32_16x16x32_bf16 v[120:123], v[40:43], v[252:255], v[120:123]
    v_mfma_f32_16x16x32_bf16 v[124:127], v[44:47], v[252:255], v[124:127]
    buffer_load_dwordx4 v[164:167], v3, s[52:55], s90 offen offset:1024 sc1
    buffer_load_dwordx4 v[168:171], v3, s[52:55], s90 offen offset:2048 sc1
    buffer_load_dwordx4 v[172:175], v3, s[52:55], s90 offen offset:3072 sc1
    buffer_load_dwordx4 v[176:179], v3, s[52:55], s91 offen offset:0 sc1
    buffer_load_dwordx4 v[180:183], v3, s[52:55], s91 offen offset:1024 sc1
    buffer_load_dwordx4 v[184:187], v3, s[52:55], s91 offen offset:2048 sc1
    buffer_load_dwordx4 v[188:191], v3, s[52:55], s91 offen offset:3072 sc1
    s_nop 1
    v_mfma_f32_16x16x16_bf16 v[100:103], a[240:241], v[66:67], v[100:103]
    v_mfma_f32_16x16x16_bf16 v[104:107], a[242:243], v[66:67], v[104:107]
    v_mfma_f32_16x16x16_bf16 v[108:111], a[244:245], v[66:67], v[108:111]
    v_mfma_f32_16x16x16_bf16 v[112:115], a[246:247], v[66:67], v[112:115]
    v_mfma_f32_16x16x16_bf16 v[116:119], a[248:249], v[66:67], v[116:119]
    v_mfma_f32_16x16x16_bf16 v[120:123], a[250:251], v[66:67], v[120:123]
    v_mfma_f32_16x16x16_bf16 v[124:127], a[252:253], v[66:67], v[124:127]
    s_waitcnt vmcnt(15)
    v_mfma_f32_32x32x16_bf16 v[192:207], a[0:3], v[128:131], 0
    v_and_b32 v90, 0x70, v3
    s_lshl_b32 s26, s20, 7
    buffer_load_dwordx4 v[96:99], v90, s[60:63], s26 offen
    v_lshrrev_b32 v91, 7, v3
    v_lshlrev_b32 v91, 2, v91
    buffer_load_dword v88, v91, s[52:55], s43 offen offset:0 sc1
    v_mfma_f32_32x32x16_bf16 v[208:223], a[4:7], v[128:131], 0
    v_mul_f32 v100, v100, abs(v100)
    v_mul_f32 v101, v101, abs(v101)
    v_mul_f32 v102, v102, abs(v102)
    v_mul_f32 v103, v103, abs(v103)
    v_mul_f32 v104, v104, abs(v104)
    v_mul_f32 v105, v105, abs(v105)
    s_waitcnt vmcnt(16)
    v_mfma_f32_32x32x16_bf16 v[192:207], a[8:11], v[132:135], v[192:207]
    v_mul_f32 v106, v106, abs(v106)
    v_mul_f32 v107, v107, abs(v107)
    v_cvt_pk_bf16_f32 v100, v100, v101
    v_cvt_pk_bf16_f32 v101, v102, v103
    v_cvt_pk_bf16_f32 v102, v104, v105
    v_cvt_pk_bf16_f32 v103, v106, v107
    v_mfma_f32_32x32x16_bf16 v[208:223], a[12:15], v[132:135], v[208:223]
    v_pk_max_i16 v100, v100, 0
    v_pk_max_i16 v101, v101, 0
    v_pk_max_i16 v102, v102, 0
    v_pk_max_i16 v103, v103, 0
    buffer_store_dwordx4 v[100:103], v0, s[52:55], s4 offen offset:0 sc0 sc1
    v_mul_f32 v108, v108, abs(v108)
    s_waitcnt vmcnt(16)
    v_mfma_f32_32x32x16_bf16 v[192:207], a[16:19], v[136:139], v[192:207]
    v_mul_f32 v109, v109, abs(v109)
    v_mul_f32 v110, v110, abs(v110)
    v_mul_f32 v111, v111, abs(v111)
    v_mul_f32 v112, v112, abs(v112)
    v_mul_f32 v113, v113, abs(v113)
    v_mul_f32 v114, v114, abs(v114)
    v_mfma_f32_32x32x16_bf16 v[208:223], a[20:23], v[136:139], v[208:223]
    v_mul_f32 v115, v115, abs(v115)
    v_cvt_pk_bf16_f32 v108, v108, v109
    v_cvt_pk_bf16_f32 v109, v110, v111
    v_cvt_pk_bf16_f32 v110, v112, v113
    v_cvt_pk_bf16_f32 v111, v114, v115
    v_pk_max_i16 v108, v108, 0
    s_waitcnt vmcnt(15)
    v_mfma_f32_32x32x16_bf16 v[192:207], a[24:27], v[140:143], v[192:207]
    v_pk_max_i16 v109, v109, 0
    v_pk_max_i16 v110, v110, 0
    v_pk_max_i16 v111, v111, 0
    buffer_store_dwordx4 v[108:111], v0, s[52:55], s4 offen offset:2048 sc0 sc1
    v_mul_f32 v116, v116, abs(v116)
    v_mul_f32 v117, v117, abs(v117)
    v_mfma_f32_32x32x16_bf16 v[208:223], a[28:31], v[140:143], v[208:223]
    v_mul_f32 v118, v118, abs(v118)
    v_mul_f32 v119, v119, abs(v119)
    v_mul_f32 v120, v120, abs(v120)
    v_mul_f32 v121, v121, abs(v121)
    v_mul_f32 v122, v122, abs(v122)
    v_mul_f32 v123, v123, abs(v123)
    s_waitcnt vmcnt(15)
    v_mfma_f32_32x32x16_bf16 v[192:207], a[32:35], v[144:147], v[192:207]
    v_cvt_pk_bf16_f32 v116, v116, v117
    v_cvt_pk_bf16_f32 v117, v118, v119
    v_cvt_pk_bf16_f32 v118, v120, v121
    v_cvt_pk_bf16_f32 v119, v122, v123
    v_pk_max_i16 v116, v116, 0
    v_pk_max_i16 v117, v117, 0
    v_mfma_f32_32x32x16_bf16 v[208:223], a[36:39], v[144:147], v[208:223]
    v_pk_max_i16 v118, v118, 0
    v_pk_max_i16 v119, v119, 0
    buffer_store_dwordx4 v[116:119], v0, s[52:55], s5 offen offset:0 sc0 sc1
    v_mul_f32 v124, v124, abs(v124)
    v_mul_f32 v125, v125, abs(v125)
    v_mul_f32 v126, v126, abs(v126)
    s_waitcnt vmcnt(15)
    v_mfma_f32_32x32x16_bf16 v[192:207], a[40:43], v[148:151], v[192:207]
    v_mul_f32 v127, v127, abs(v127)
    v_cvt_pk_bf16_f32 v124, v124, v125
    v_cvt_pk_bf16_f32 v125, v126, v127
    v_pk_max_i16 v124, v124, 0
    v_pk_max_i16 v125, v125, 0
    buffer_store_dwordx2 v[124:125], v1, s[52:55], s5 offen offset:2048 sc0 sc1
    v_mfma_f32_32x32x16_bf16 v[208:223], a[44:47], v[148:151], v[208:223]
    v_and_b32 v118, 0x70, v3
    s_lshl_b32 s26, s20, 7
    buffer_load_dwordx4 v[124:127], v118, s[60:63], s26 offen
    s_waitcnt vmcnt(16)
    v_mfma_f32_32x32x16_bf16 v[192:207], a[48:51], v[152:155], v[192:207]
    v_mfma_f32_32x32x16_bf16 v[208:223], a[52:55], v[152:155], v[208:223]
    buffer_load_dwordx4 v[16:19], v3, s[52:55], s92 offen offset:0 sc1
    s_waitcnt vmcnt(16)
    v_mfma_f32_32x32x16_bf16 v[192:207], a[56:59], v[156:159], v[192:207]
    v_mfma_f32_32x32x16_bf16 v[208:223], a[60:63], v[156:159], v[208:223]
    buffer_load_dwordx4 v[20:23], v3, s[52:55], s92 offen offset:1024 sc1
    s_waitcnt vmcnt(16)
    v_mfma_f32_32x32x16_bf16 v[192:207], a[64:67], v[160:163], v[192:207]
    v_mfma_f32_32x32x16_bf16 v[208:223], a[68:71], v[160:163], v[208:223]
    buffer_load_dwordx4 v[24:27], v3, s[52:55], s92 offen offset:2048 sc1
    s_waitcnt vmcnt(16)
    v_mfma_f32_32x32x16_bf16 v[192:207], a[72:75], v[164:167], v[192:207]
    v_mfma_f32_32x32x16_bf16 v[208:223], a[76:79], v[164:167], v[208:223]
    buffer_load_dwordx4 v[28:31], v3, s[52:55], s92 offen offset:3072 sc1
    s_waitcnt vmcnt(16)
    v_mfma_f32_32x32x16_bf16 v[192:207], a[80:83], v[168:171], v[192:207]
    v_mfma_f32_32x32x16_bf16 v[208:223], a[84:87], v[168:171], v[208:223]
    buffer_load_dwordx4 v[32:35], v3, s[52:55], s93 offen offset:0 sc1
    s_waitcnt vmcnt(16)
    v_mfma_f32_32x32x16_bf16 v[192:207], a[88:91], v[172:175], v[192:207]
    v_mfma_f32_32x32x16_bf16 v[208:223], a[92:95], v[172:175], v[208:223]
    buffer_load_dwordx4 v[36:39], v3, s[52:55], s93 offen offset:1024 sc1
    v_mov_b32 v7, 2
    s_waitcnt vmcnt(7)
    buffer_store_dword v7, v9, s[52:55], s74 offen offset:0 sc0 sc1
    v_mfma_f32_32x32x16_bf16 v[192:207], a[96:99], v[176:179], v[192:207]
    v_mfma_f32_32x32x16_bf16 v[208:223], a[100:103], v[176:179], v[208:223]
    buffer_load_dwordx4 v[40:43], v3, s[52:55], s93 offen offset:2048 sc1
    v_mfma_f32_32x32x16_bf16 v[192:207], a[104:107], v[180:183], v[192:207]
    v_mfma_f32_32x32x16_bf16 v[208:223], a[108:111], v[180:183], v[208:223]
    buffer_load_dwordx4 v[44:47], v3, s[52:55], s93 offen offset:3072 sc1
    v_mfma_f32_32x32x16_bf16 v[192:207], a[112:115], v[184:187], v[192:207]
    v_mfma_f32_32x32x16_bf16 v[208:223], a[116:119], v[184:187], v[208:223]
    buffer_load_dwordx4 v[48:51], v3, s[52:55], s94 offen offset:0 sc1
    v_accvgpr_read_b32 v92, a224
    v_lshlrev_b32 v93, 16, v96
    v_and_b32 v94, 0xffff0000, v96
    v_lshlrev_b32 v72, 16, v92
    v_and_b32 v73, 0xffff0000, v92
    v_mfma_f32_32x32x16_bf16 v[192:207], a[120:123], v[188:191], v[192:207]
    v_add_f32 v72, v72, v93
    v_add_f32 v73, v73, v94
    v_accvgpr_read_b32 v92, a225
    v_lshlrev_b32 v93, 16, v97
    v_and_b32 v94, 0xffff0000, v97
    v_lshlrev_b32 v74, 16, v92
    v_mfma_f32_32x32x16_bf16 v[208:223], a[124:127], v[188:191], v[208:223]
    buffer_load_dwordx4 v[52:55], v3, s[52:55], s94 offen offset:1024 sc1
    v_and_b32 v75, 0xffff0000, v92
    v_add_f32 v74, v74, v93
    v_add_f32 v75, v75, v94
    v_accvgpr_read_b32 v92, a226
    v_lshlrev_b32 v93, 16, v98
    s_waitcnt vmcnt(10)
    v_mfma_f32_32x32x16_bf16 v[192:207], a[128:131], v[16:19], v[192:207]
    buffer_load_dword v14, v13, s[52:55], s75 offen offset:0 sc1
    v_and_b32 v94, 0xffff0000, v98
    v_lshlrev_b32 v76, 16, v92
    v_and_b32 v77, 0xffff0000, v92
    v_add_f32 v76, v76, v93
    v_add_f32 v77, v77, v94
    v_mfma_f32_32x32x16_bf16 v[208:223], a[132:135], v[16:19], v[208:223]
    buffer_load_dwordx4 v[56:59], v3, s[52:55], s94 offen offset:2048 sc1
    v_accvgpr_read_b32 v92, a227
    v_lshlrev_b32 v93, 16, v99
    v_and_b32 v94, 0xffff0000, v99
    v_lshlrev_b32 v78, 16, v92
    v_and_b32 v79, 0xffff0000, v92
    s_waitcnt vmcnt(11)
    v_mfma_f32_32x32x16_bf16 v[192:207], a[136:139], v[20:23], v[192:207]
    v_add_f32 v78, v78, v93
    v_add_f32 v79, v79, v94
    v_accvgpr_read_b32 v80, a232
    v_lshlrev_b32 v80, 16, v80
    v_accvgpr_read_b32 v81, a233
    v_lshlrev_b32 v81, 16, v81
    v_mfma_f32_32x32x16_bf16 v[208:223], a[140:143], v[20:23], v[208:223]
    buffer_load_dwordx4 v[60:63], v3, s[52:55], s94 offen offset:3072 sc1
    v_accvgpr_read_b32 v82, a234
    v_lshlrev_b32 v82, 16, v82
    v_accvgpr_read_b32 v83, a235
    v_lshlrev_b32 v83, 16, v83
    v_accvgpr_read_b32 v84, a236
    s_waitcnt vmcnt(11)
    v_mfma_f32_32x32x16_bf16 v[192:207], a[144:147], v[24:27], v[192:207]
    v_lshlrev_b32 v84, 16, v84
    v_accvgpr_read_b32 v85, a237
    v_lshlrev_b32 v85, 16, v85
    v_accvgpr_read_b32 v86, a238
    v_lshlrev_b32 v86, 16, v86
    v_accvgpr_read_b32 v87, a239
    v_mfma_f32_32x32x16_bf16 v[208:223], a[148:151], v[24:27], v[208:223]
    v_lshlrev_b32 v87, 16, v87
    v_accvgpr_read_b32 v120, a228
    v_lshlrev_b32 v121, 16, v124
    v_and_b32 v122, 0xffff0000, v124
    v_lshlrev_b32 v100, 16, v120
    v_and_b32 v101, 0xffff0000, v120
    s_waitcnt vmcnt(10)
    v_mfma_f32_32x32x16_bf16 v[192:207], a[152:155], v[28:31], v[192:207]
    v_add_f32 v100, v100, v121
    v_add_f32 v101, v101, v122
    v_accvgpr_read_b32 v120, a229
    v_lshlrev_b32 v121, 16, v125
    v_and_b32 v122, 0xffff0000, v125
    v_lshlrev_b32 v102, 16, v120
    v_mfma_f32_32x32x16_bf16 v[208:223], a[156:159], v[28:31], v[208:223]
    v_and_b32 v103, 0xffff0000, v120
    v_add_f32 v102, v102, v121
    v_add_f32 v103, v103, v122
    v_accvgpr_read_b32 v120, a230
    v_lshlrev_b32 v121, 16, v126
    v_and_b32 v122, 0xffff0000, v126
    s_waitcnt vmcnt(9)
    v_mfma_f32_32x32x16_bf16 v[192:207], a[160:163], v[32:35], v[192:207]
    s_waitcnt vmcnt(2)
    v_cmp_gt_u32 vcc, 2, v14
    s_cbranch_vccnz FWAIT_96
FOK_95:
    buffer_load_dwordx4 v[16:19], v3, s[52:55], s95 offen offset:0 sc1
    v_lshlrev_b32 v104, 16, v120
    v_mfma_f32_32x32x16_bf16 v[208:223], a[164:167], v[32:35], v[208:223]
    buffer_load_dwordx4 v[20:23], v3, s[52:55], s95 offen offset:1024 sc1
    v_and_b32 v105, 0xffff0000, v120
    v_add_f32 v104, v104, v121
    v_add_f32 v105, v105, v122
    v_accvgpr_read_b32 v120, a231
    v_lshlrev_b32 v121, 16, v127
    v_mfma_f32_32x32x16_bf16 v[192:207], a[168:171], v[36:39], v[192:207]
    buffer_load_dwordx4 v[24:27], v3, s[52:55], s95 offen offset:2048 sc1
    v_and_b32 v122, 0xffff0000, v127
    v_lshlrev_b32 v106, 16, v120
    v_and_b32 v107, 0xffff0000, v120
    v_add_f32 v106, v106, v121
    v_add_f32 v107, v107, v122
    v_mfma_f32_32x32x16_bf16 v[208:223], a[172:175], v[36:39], v[208:223]
    buffer_load_dwordx4 v[28:31], v3, s[52:55], s95 offen offset:3072 sc1
    v_accvgpr_read_b32 v108, a232
    v_and_b32 v108, 0xffff0000, v108
    v_accvgpr_read_b32 v109, a233
    v_and_b32 v109, 0xffff0000, v109
    v_accvgpr_read_b32 v110, a234
    v_mfma_f32_32x32x16_bf16 v[192:207], a[176:179], v[40:43], v[192:207]
    v_and_b32 v110, 0xffff0000, v110
    v_accvgpr_read_b32 v111, a235
    v_and_b32 v111, 0xffff0000, v111
    v_accvgpr_read_b32 v112, a236
    v_and_b32 v112, 0xffff0000, v112
    v_accvgpr_read_b32 v113, a237
    v_mfma_f32_32x32x16_bf16 v[208:223], a[180:183], v[40:43], v[208:223]
    buffer_load_dwordx4 v[32:35], v3, s[52:55], s96 offen offset:0 sc1
    v_and_b32 v113, 0xffff0000, v113
    v_accvgpr_read_b32 v114, a238
    v_and_b32 v114, 0xffff0000, v114
    v_accvgpr_read_b32 v115, a239
    v_and_b32 v115, 0xffff0000, v115
    v_mfma_f32_32x32x16_bf16 v[192:207], a[184:187], v[44:47], v[192:207]
    v_mfma_f32_32x32x16_bf16 v[208:223], a[188:191], v[44:47], v[208:223]
    buffer_load_dwordx4 v[36:39], v3, s[52:55], s96 offen offset:1024 sc1
    v_mfma_f32_32x32x16_bf16 v[192:207], a[192:195], v[48:51], v[192:207]
    v_mfma_f32_32x32x16_bf16 v[208:223], a[196:199], v[48:51], v[208:223]
    buffer_load_dwordx4 v[40:43], v3, s[52:55], s96 offen offset:2048 sc1
    v_mfma_f32_32x32x16_bf16 v[192:207], a[200:203], v[52:55], v[192:207]
    v_mfma_f32_32x32x16_bf16 v[208:223], a[204:207], v[52:55], v[208:223]
    buffer_load_dwordx4 v[44:47], v3, s[52:55], s96 offen offset:3072 sc1
    s_waitcnt vmcnt(9)
    v_mfma_f32_32x32x16_bf16 v[192:207], a[208:211], v[56:59], v[192:207]
    v_mfma_f32_32x32x16_bf16 v[208:223], a[212:215], v[56:59], v[208:223]
    buffer_load_dwordx4 v[48:51], v3, s[52:55], s97 offen offset:0 sc1
    s_waitcnt vmcnt(9)
    v_mfma_f32_32x32x16_bf16 v[192:207], a[216:219], v[60:63], v[192:207]
    v_mfma_f32_32x32x16_bf16 v[208:223], a[220:223], v[60:63], v[208:223]
    buffer_load_dwordx4 v[52:55], v3, s[52:55], s97 offen offset:1024 sc1
    s_add_u32 s8, s8, 0x20000
    s_waitcnt vmcnt(9)
    v_mfma_f32_32x32x16_bf16 v[224:239], a[0:3], v[16:19], 0
    v_lshrrev_b32 v119, 7, v3
    v_lshlrev_b32 v119, 2, v119
    buffer_load_dword v116, v119, s[52:55], s43 offen offset:64 sc1
    s_nop 1
    v_mfma_f32_32x32x16_bf16 v[240:255], a[4:7], v[16:19], 0
    buffer_load_dwordx4 v[56:59], v3, s[52:55], s97 offen offset:2048 sc1
    s_waitcnt vmcnt(10)
    v_mfma_f32_32x32x16_bf16 v[224:239], a[8:11], v[20:23], v[224:239]
    ds_write_b128 v2, v[192:195] offset:0
    v_mfma_f32_32x32x16_bf16 v[240:255], a[12:15], v[20:23], v[240:255]
    buffer_load_dwordx4 v[60:63], v3, s[52:55], s97 offen offset:3072 sc1
    ds_write_b128 v2, v[196:199] offset:4352
    s_waitcnt vmcnt(10)
    v_mfma_f32_32x32x16_bf16 v[224:239], a[16:19], v[24:27], v[224:239]
    ds_write_b128 v2, v[200:203] offset:1088
    v_mfma_f32_32x32x16_bf16 v[240:255], a[20:23], v[24:27], v[240:255]
    buffer_load_dwordx4 v[16:19], v3, s[52:55], s98 offen offset:0 sc1
    ds_write_b128 v2, v[204:207] offset:5440
    s_waitcnt vmcnt(10)
    v_mfma_f32_32x32x16_bf16 v[224:239], a[24:27], v[28:31], v[224:239]
    ds_write_b128 v2, v[208:211] offset:2176
    v_mfma_f32_32x32x16_bf16 v[240:255], a[28:31], v[28:31], v[240:255]
    buffer_load_dwordx4 v[20:23], v3, s[52:55], s98 offen offset:1024 sc1
    ds_write_b128 v2, v[212:215] offset:6528
    s_waitcnt vmcnt(10)
    v_mfma_f32_32x32x16_bf16 v[224:239], a[32:35], v[32:35], v[224:239]
    ds_write_b128 v2, v[216:219] offset:3264
    v_mfma_f32_32x32x16_bf16 v[240:255], a[36:39], v[32:35], v[240:255]
    buffer_load_dwordx4 v[24:27], v3, s[52:55], s98 offen offset:2048 sc1
    ds_write_b128 v2, v[220:223] offset:7616
    s_waitcnt vmcnt(10)
    v_mfma_f32_32x32x16_bf16 v[224:239], a[40:43], v[36:39], v[224:239]
    v_mfma_f32_32x32x16_bf16 v[240:255], a[44:47], v[36:39], v[240:255]
    buffer_load_dwordx4 v[28:31], v3, s[52:55], s98 offen offset:3072 sc1
    s_waitcnt vmcnt(10)
    v_mfma_f32_32x32x16_bf16 v[224:239], a[48:51], v[40:43], v[224:239]
    v_mfma_f32_32x32x16_bf16 v[240:255], a[52:55], v[40:43], v[240:255]
    buffer_load_dwordx4 v[32:35], v3, s[52:55], s99 offen offset:0 sc1
    s_waitcnt lgkmcnt(0)
    s_barrier
    ds_read_b128 v[160:163], v10 offset:0
    ds_read_b128 v[164:167], v10 offset:4352
    ds_read_b128 v[168:171], v10 offset:8704
    s_waitcnt vmcnt(10)
    v_mfma_f32_32x32x16_bf16 v[224:239], a[56:59], v[44:47], v[224:239]
    ds_read_b128 v[172:175], v10 offset:13056
    ds_read_b128 v[176:179], v10 offset:17408
    ds_read_b128 v[180:183], v10 offset:21760
    ds_read_b128 v[184:187], v10 offset:26112
    ds_read_b128 v[188:191], v10 offset:30464
    v_mfma_f32_32x32x16_bf16 v[240:255], a[60:63], v[44:47], v[240:255]
    buffer_load_dwordx4 v[36:39], v3, s[52:55], s99 offen offset:1024 sc1
    s_waitcnt vmcnt(10)
    v_mfma_f32_32x32x16_bf16 v[224:239], a[64:67], v[48:51], v[224:239]
    v_mfma_f32_32x32x16_bf16 v[240:255], a[68:71], v[48:51], v[240:255]
    buffer_load_dwordx4 v[40:43], v3, s[52:55], s99 offen offset:2048 sc1
    s_waitcnt lgkmcnt(4)
    v_add_f32 v160, v160, v168
    v_add_f32 v161, v161, v169
    v_add_f32 v162, v162, v170
    v_add_f32 v163, v163, v171
    s_waitcnt vmcnt(10)
    v_mfma_f32_32x32x16_bf16 v[224:239], a[72:75], v[52:55], v[224:239]
    v_add_f32 v164, v164, v172
    v_add_f32 v165, v165, v173
    v_add_f32 v166, v166, v174
    v_add_f32 v167, v167, v175
    s_waitcnt lgkmcnt(0)
    v_add_f32 v176, v176, v184
    v_mfma_f32_32x32x16_bf16 v[240:255], a[76:79], v[52:55], v[240:255]
    buffer_load_dwordx4 v[44:47], v3, s[52:55], s99 offen offset:3072 sc1
    v_add_f32 v177, v177, v185
    v_add_f32 v178, v178, v186
    v_add_f32 v179, v179, v187
    v_add_f32 v180, v180, v188
    v_add_f32 v181, v181, v189
    s_waitcnt vmcnt(9)
    v_mfma_f32_32x32x16_bf16 v[224:239], a[80:83], v[56:59], v[224:239]
    v_add_f32 v182, v182, v190
    v_add_f32 v183, v183, v191
    v_add_f32 v160, v160, v176
    v_add_f32 v161, v161, v177
    v_add_f32 v162, v162, v178
    v_add_f32 v163, v163, v179
    v_mfma_f32_32x32x16_bf16 v[240:255], a[84:87], v[56:59], v[240:255]
    buffer_load_dwordx4 v[48:51], v3, s[52:55], s100 offen offset:0 sc1
    v_add_f32 v164, v164, v180
    v_add_f32 v165, v165, v181
    v_add_f32 v166, v166, v182
    v_add_f32 v167, v167, v183
    v_fmac_f32 v72, v160, v88
    s_waitcnt vmcnt(9)
    v_mfma_f32_32x32x16_bf16 v[224:239], a[88:91], v[60:63], v[224:239]
    v_fmac_f32 v73, v161, v88
    v_fmac_f32 v74, v162, v88
    v_fmac_f32 v75, v163, v88
    v_fmac_f32 v76, v164, v88
    v_fmac_f32 v77, v165, v88
    v_fmac_f32 v78, v166, v88
    v_mfma_f32_32x32x16_bf16 v[240:255], a[92:95], v[60:63], v[240:255]
    buffer_load_dwordx4 v[52:55], v3, s[52:55], s100 offen offset:1024 sc1
    v_fmac_f32 v79, v167, v88
    v_add_f32 v90, v72, v73
    v_mul_f32 v91, v72, v72
    v_fmac_f32 v91, v73, v73
    v_add_f32 v90, v90, v74
    s_waitcnt vmcnt(9)
    v_mfma_f32_32x32x16_bf16 v[224:239], a[96:99], v[16:19], v[224:239]
    v_fmac_f32 v91, v74, v74
    v_add_f32 v90, v90, v75
    v_fmac_f32 v91, v75, v75
    v_add_f32 v90, v90, v76
    v_fmac_f32 v91, v76, v76
    v_add_f32 v90, v90, v77
    v_mfma_f32_32x32x16_bf16 v[240:255], a[100:103], v[16:19], v[240:255]
    buffer_load_dwordx4 v[56:59], v3, s[52:55], s100 offen offset:2048 sc1
    v_fmac_f32 v91, v77, v77
    v_add_f32 v90, v90, v78
    v_fmac_f32 v91, v78, v78
    v_add_f32 v90, v90, v79
    v_fmac_f32 v91, v79, v79
    s_waitcnt vmcnt(9)
    v_mfma_f32_32x32x16_bf16 v[224:239], a[104:107], v[20:23], v[224:239]
    s_nop 0
    v_add_f32_dpp v90, v90, v90 quad_perm:[1,0,3,2] row_mask:0xf bank_mask:0xf
    v_add_f32_dpp v91, v91, v91 quad_perm:[1,0,3,2] row_mask:0xf bank_mask:0xf
    s_nop 0
    v_add_f32_dpp v90, v90, v90 quad_perm:[2,3,0,1] row_mask:0xf bank_mask:0xf
    v_add_f32_dpp v91, v91, v91 quad_perm:[2,3,0,1] row_mask:0xf bank_mask:0xf
    v_mfma_f32_32x32x16_bf16 v[240:255], a[108:111], v[20:23], v[240:255]
    buffer_load_dwordx4 v[60:63], v3, s[52:55], s100 offen offset:3072 sc1
    s_nop 0
    v_add_f32_dpp v90, v90, v90 row_half_mirror row_mask:0xf bank_mask:0xf
    v_add_f32_dpp v91, v91, v91 row_half_mirror row_mask:0xf bank_mask:0xf
    v_and_b32 v91, 0x7fffffff, v91
    buffer_store_dwordx2 v[90:91], v11, s[52:55], s7 offen offset:0 sc0 sc1
    s_waitcnt vmcnt(10)
    v_mfma_f32_32x32x16_bf16 v[224:239], a[112:115], v[24:27], v[224:239]
    v_mfma_f32_32x32x16_bf16 v[240:255], a[116:119], v[24:27], v[240:255]
    buffer_load_dwordx4 v[16:19], v3, s[52:55], s101 offen offset:0 sc1
    s_waitcnt vmcnt(10)
    v_mfma_f32_32x32x16_bf16 v[224:239], a[120:123], v[28:31], v[224:239]
    v_mfma_f32_32x32x16_bf16 v[240:255], a[124:127], v[28:31], v[240:255]
    buffer_load_dwordx4 v[20:23], v3, s[52:55], s101 offen offset:1024 sc1
    s_waitcnt vmcnt(10)
    v_mfma_f32_32x32x16_bf16 v[224:239], a[128:131], v[32:35], v[224:239]
    buffer_load_dwordx2 v[92:93], v5, s[52:55], s7 offen offset:0 sc1
    s_barrier
    v_mfma_f32_32x32x16_bf16 v[240:255], a[132:135], v[32:35], v[240:255]
    buffer_load_dwordx4 v[24:27], v3, s[52:55], s101 offen offset:2048 sc1
    s_waitcnt vmcnt(11)
    v_mfma_f32_32x32x16_bf16 v[224:239], a[136:139], v[36:39], v[224:239]
    v_mfma_f32_32x32x16_bf16 v[240:255], a[140:143], v[36:39], v[240:255]
    buffer_load_dwordx4 v[28:31], v3, s[52:55], s101 offen offset:3072 sc1
    s_waitcnt vmcnt(11)
    v_mfma_f32_32x32x16_bf16 v[224:239], a[144:147], v[40:43], v[224:239]
    v_mfma_f32_32x32x16_bf16 v[240:255], a[148:151], v[40:43], v[240:255]
    s_waitcnt vmcnt(10)
    v_mfma_f32_32x32x16_bf16 v[224:239], a[152:155], v[44:47], v[224:239]
    v_mfma_f32_32x32x16_bf16 v[240:255], a[156:159], v[44:47], v[240:255]
    s_waitcnt vmcnt(9)
    v_mfma_f32_32x32x16_bf16 v[224:239], a[160:163], v[48:51], v[224:239]
    v_mfma_f32_32x32x16_bf16 v[240:255], a[164:167], v[48:51], v[240:255]
    s_waitcnt vmcnt(8)
    v_mfma_f32_32x32x16_bf16 v[224:239], a[168:171], v[52:55], v[224:239]
    v_mfma_f32_32x32x16_bf16 v[240:255], a[172:175], v[52:55], v[240:255]
    s_waitcnt vmcnt(7)
    v_mfma_f32_32x32x16_bf16 v[224:239], a[176:179], v[56:59], v[224:239]
    s_waitcnt vmcnt(2)
    v_cmp_gt_i32 vcc, 0, v93
    s_cbranch_vccnz SWAIT_98
SOK_97:
    s_nop 0
    v_add_f32_dpp v92, v92, v92 quad_perm:[1,0,3,2] row_mask:0xf bank_mask:0xf
    v_add_f32_dpp v93, v93, v93 quad_perm:[1,0,3,2] row_mask:0xf bank_mask:0xf
    v_mfma_f32_32x32x16_bf16 v[240:255], a[180:183], v[56:59], v[240:255]
    s_nop 0
    v_add_f32_dpp v92, v92, v92 quad_perm:[2,3,0,1] row_mask:0xf bank_mask:0xf
    v_add_f32_dpp v93, v93, v93 quad_perm:[2,3,0,1] row_mask:0xf bank_mask:0xf
    s_nop 0
    v_add_f32_dpp v92, v92, v92 row_half_mirror row_mask:0xf bank_mask:0xf
    v_add_f32_dpp v93, v93, v93 row_half_mirror row_mask:0xf bank_mask:0xf
    v_mfma_f32_32x32x16_bf16 v[224:239], a[184:187], v[60:63], v[224:239]
    v_mul_f32 v92, 0x3b000000, v92
    v_mul_f32 v93, 0x3b000000, v93
    v_fma_f32 v93, -v92, v92, v93
    v_max_f32 v93, 0, v93
    v_cvt_pk_bf16_f32 v94, v92, v93
    v_lshlrev_b32 v92, 16, v94
    v_mfma_f32_32x32x16_bf16 v[240:255], a[188:191], v[60:63], v[240:255]
    v_and_b32 v93, 0xffff0000, v94
    v_add_f32 v93, 0x3727c5ac, v93
    v_cvt_pk_bf16_f32 v94, v93, v93
    v_lshlrev_b32 v93, 16, v94
    v_sqrt_f32 v93, v93
    s_nop 0
    v_mfma_f32_32x32x16_bf16 v[224:239], a[192:195], v[16:19], v[224:239]
    v_cvt_pk_bf16_f32 v94, v93, v93
    v_lshlrev_b32 v93, 16, v94
    v_rcp_f32 v93, v93
    s_nop 0
    v_mul_f32 v92, -v92, v93
    v_fma_f32 v96, v72, v93, v92
    v_mfma_f32_32x32x16_bf16 v[224:239], a[200:203], v[20:23], v[224:239]
    v_fma_f32 v97, v73, v93, v92
    v_fma_f32 v98, v74, v93, v92
    v_fma_f32 v99, v75, v93, v92
    v_fmac_f32 v72, v96, v80
    v_fmac_f32 v73, v97, v81
    v_fmac_f32 v74, v98, v82
    s_waitcnt vmcnt(1)
    v_mfma_f32_32x32x16_bf16 v[224:239], a[208:211], v[24:27], v[224:239]
    v_fmac_f32 v75, v99, v83
    v_fma_f32 v96, v76, v93, v92
    v_fma_f32 v97, v77, v93, v92
    v_fma_f32 v98, v78, v93, v92
    v_fma_f32 v99, v79, v93, v92
    v_fmac_f32 v76, v96, v84
    s_waitcnt vmcnt(0)
    v_mfma_f32_32x32x16_bf16 v[224:239], a[216:219], v[28:31], v[224:239]
    v_fmac_f32 v77, v97, v85
    v_fmac_f32 v78, v98, v86
    v_fmac_f32 v79, v99, v87
    v_cvt_pk_bf16_f32 v96, v72, v73
    v_cvt_pk_bf16_f32 v97, v74, v75
    v_cvt_pk_bf16_f32 v98, v76, v77
    v_mfma_f32_32x32x16_bf16 v[240:255], a[196:199], v[16:19], v[240:255]
    v_cvt_pk_bf16_f32 v99, v78, v79
    buffer_store_dwordx4 v[96:99], v12, s[52:55], s28 offen sc0 sc1
    v_lshlrev_b32 v72, 16, v96
    v_and_b32 v76, 0xffff0000, v96
    v_lshlrev_b32 v73, 16, v97
    v_mfma_f32_32x32x16_bf16 v[240:255], a[204:207], v[20:23], v[240:255]
    v_and_b32 v77, 0xffff0000, v97
    v_lshlrev_b32 v74, 16, v98
    v_and_b32 v78, 0xffff0000, v98
    v_lshlrev_b32 v75, 16, v99
    v_and_b32 v79, 0xffff0000, v99
    v_mfma_f32_32x32x16_bf16 v[240:255], a[212:215], v[24:27], v[240:255]
    ds_write_b128 v2, v[224:227] offset:0
    ds_write_b128 v2, v[228:231] offset:4352
    v_mfma_f32_32x32x16_bf16 v[240:255], a[220:223], v[28:31], v[240:255]
    ds_write_b128 v2, v[232:235] offset:1088
    ds_write_b128 v2, v[236:239] offset:5440
    v_add_f32 v90, v72, v73
    v_mul_f32 v91, v72, v72
    v_fmac_f32 v91, v73, v73
    v_add_f32 v90, v90, v74
    v_fmac_f32 v91, v74, v74
    v_add_f32 v90, v90, v75
    v_fmac_f32 v91, v75, v75
    v_add_f32 v90, v90, v76
    v_fmac_f32 v91, v76, v76
    v_add_f32 v90, v90, v77
    s_nop 0
    ds_write_b128 v2, v[240:243] offset:2176
    ds_write_b128 v2, v[244:247] offset:6528
    ds_write_b128 v2, v[248:251] offset:3264
    ds_write_b128 v2, v[252:255] offset:7616
    v_fmac_f32 v91, v77, v77
    v_add_f32 v90, v90, v78
    v_mov_b32 v7, 3
    s_waitcnt vmcnt(0)
    buffer_store_dword v7, v9, s[52:55], s68 offen offset:512 sc0 sc1
    v_lshrrev_b32 v13, 2, v3
    v_and_b32 v13, 60, v13
    s_waitcnt lgkmcnt(0)
    s_barrier
    ds_read_b128 v[16:19], v10 offset:0
    ds_read_b128 v[20:23], v10 offset:4352
    ds_read_b128 v[24:27], v10 offset:8704
    ds_read_b128 v[28:31], v10 offset:13056
    ds_read_b128 v[32:35], v10 offset:17408
    ds_read_b128 v[36:39], v10 offset:21760
    ds_read_b128 v[40:43], v10 offset:26112
    ds_read_b128 v[44:47], v10 offset:30464
    buffer_load_dword v14, v13, s[52:55], s69 offen offset:512 sc1
    v_fmac_f32 v91, v78, v78
    v_add_f32 v90, v90, v79
    v_fmac_f32 v91, v79, v79
    s_nop 0
    v_add_f32_dpp v90, v90, v90 quad_perm:[1,0,3,2] row_mask:0xf bank_mask:0xf
    v_add_f32_dpp v91, v91, v91 quad_perm:[1,0,3,2] row_mask:0xf bank_mask:0xf
    s_nop 0
    v_add_f32_dpp v90, v90, v90 quad_perm:[2,3,0,1] row_mask:0xf bank_mask:0xf
    v_add_f32_dpp v91, v91, v91 quad_perm:[2,3,0,1] row_mask:0xf bank_mask:0xf
    s_nop 0
    v_add_f32_dpp v90, v90, v90 row_half_mirror row_mask:0xf bank_mask:0xf
    v_add_f32_dpp v91, v91, v91 row_half_mirror row_mask:0xf bank_mask:0xf
    v_and_b32 v91, 0x7fffffff, v91
    buffer_store_dwordx2 v[90:91], v11, s[52:55], s9 offen offset:0 sc0 sc1
    v_accvgpr_write_b32 a224, v96
    v_accvgpr_write_b32 a225, v97
    v_accvgpr_write_b32 a226, v98
    v_accvgpr_write_b32 a227, v99
    s_waitcnt lgkmcnt(4)
    v_pk_add_f32 v[16:17], v[16:17], v[24:25]
    v_pk_add_f32 v[18:19], v[18:19], v[26:27]
    v_pk_add_f32 v[20:21], v[20:21], v[28:29]
    v_pk_add_f32 v[22:23], v[22:23], v[30:31]
    s_waitcnt lgkmcnt(0)
    v_pk_add_f32 v[32:33], v[32:33], v[40:41]
    v_pk_add_f32 v[34:35], v[34:35], v[42:43]
    v_pk_add_f32 v[36:37], v[36:37], v[44:45]
    v_pk_add_f32 v[38:39], v[38:39], v[46:47]
    v_pk_add_f32 v[16:17], v[16:17], v[32:33]
    v_pk_add_f32 v[18:19], v[18:19], v[34:35]
    v_pk_add_f32 v[20:21], v[20:21], v[36:37]
    v_pk_add_f32 v[22:23], v[22:23], v[38:39]
    v_pk_fma_f32 v[100:101], v[16:17], v[116:117], v[100:101] op_sel_hi:[1,0,1]
    v_pk_fma_f32 v[102:103], v[18:19], v[116:117], v[102:103] op_sel_hi:[1,0,1]
    v_pk_fma_f32 v[104:105], v[20:21], v[116:117], v[104:105] op_sel_hi:[1,0,1]
    v_pk_fma_f32 v[106:107], v[22:23], v[116:117], v[106:107] op_sel_hi:[1,0,1]
    v_pk_add_f32 v[120:121], v[100:101], v[102:103]
    v_pk_mul_f32 v[122:123], v[100:101], v[100:101]
    v_pk_fma_f32 v[122:123], v[102:103], v[102:103], v[122:123]
    v_pk_add_f32 v[120:121], v[120:121], v[104:105]
    v_pk_fma_f32 v[122:123], v[104:105], v[104:105], v[122:123]
    v_pk_add_f32 v[120:121], v[120:121], v[106:107]
    v_pk_fma_f32 v[122:123], v[106:107], v[106:107], v[122:123]
    v_add_f32 v118, v120, v121
    v_add_f32 v119, v122, v123
    s_nop 0
    v_add_f32_dpp v118, v118, v118 quad_perm:[1,0,3,2] row_mask:0xf bank_mask:0xf
    v_add_f32_dpp v119, v119, v119 quad_perm:[1,0,3,2] row_mask:0xf bank_mask:0xf
    s_nop 0
    v_add_f32_dpp v118, v118, v118 quad_perm:[2,3,0,1] row_mask:0xf bank_mask:0xf
    v_add_f32_dpp v119, v119, v119 quad_perm:[2,3,0,1] row_mask:0xf bank_mask:0xf
    s_nop 0
    v_add_f32_dpp v118, v118, v118 row_half_mirror row_mask:0xf bank_mask:0xf
    v_add_f32_dpp v119, v119, v119 row_half_mirror row_mask:0xf bank_mask:0xf
    v_and_b32 v119, 0x7fffffff, v119
    buffer_store_dwordx2 v[118:119], v11, s[52:55], s7 offen offset:1024 sc0 sc1
    s_waitcnt vmcnt(2)
    v_cmp_gt_u32 vcc, 3, v14
    s_cbranch_vccnz FWAIT_101
FOK_100:
    buffer_load_dwordx2 v[120:121], v5, s[52:55], s7 offen offset:1024 sc1
    s_add_u32 s30, s46, 0
    buffer_load_dwordx4 v[128:131], v3, s[52:55], s30 offen offset:0 sc1
    buffer_load_dwordx4 v[132:135], v3, s[52:55], s30 offen offset:1024 sc1
    buffer_load_dwordx4 v[136:139], v3, s[52:55], s30 offen offset:2048 sc1
    buffer_load_dwordx4 v[140:143], v3, s[52:55], s30 offen offset:3072 sc1
    s_add_u32 s30, s46, 4096
    buffer_load_dwordx4 v[144:147], v3, s[52:55], s30 offen offset:0 sc1
    buffer_load_dwordx4 v[148:151], v3, s[52:55], s30 offen offset:1024 sc1
    ds_read_b128 v[16:19], v3 offset:0
    ds_read_b128 v[20:23], v3 offset:1024
    ds_read_b128 v[24:27], v3 offset:2048
    ds_read_b128 v[28:31], v3 offset:3072
    ds_read_b128 v[32:35], v3 offset:4096
    ds_read_b128 v[36:39], v3 offset:5120
    ds_read_b128 v[40:43], v3 offset:6144
    ds_read_b128 v[44:47], v3 offset:7168
    ds_read_b128 v[48:51], v3 offset:8192
    ds_read_b128 v[52:55], v3 offset:9216
    ds_read_b128 v[56:59], v3 offset:10240
    s_waitcnt vmcnt(6)
    v_cmp_gt_i32 vcc, 0, v121
    s_cbranch_vccnz SWAIT_103
SOK_102:
    s_nop 0
    v_add_f32_dpp v120, v120, v120 quad_perm:[1,0,3,2] row_mask:0xf bank_mask:0xf
    v_add_f32_dpp v121, v121, v121 quad_perm:[1,0,3,2] row_mask:0xf bank_mask:0xf
    s_nop 0
    v_add_f32_dpp v120, v120, v120 quad_perm:[2,3,0,1] row_mask:0xf bank_mask:0xf
    v_add_f32_dpp v121, v121, v121 quad_perm:[2,3,0,1] row_mask:0xf bank_mask:0xf
    s_nop 0
    v_add_f32_dpp v120, v120, v120 row_half_mirror row_mask:0xf bank_mask:0xf
    v_add_f32_dpp v121, v121, v121 row_half_mirror row_mask:0xf bank_mask:0xf
    v_mul_f32 v120, 0x3b000000, v120
    v_mul_f32 v121, 0x3b000000, v121
    v_fma_f32 v121, -v120, v120, v121
    v_max_f32 v121, 0, v121
    v_cvt_pk_bf16_f32 v122, v120, v121
    v_lshlrev_b32 v120, 16, v122
    v_and_b32 v121, 0xffff0000, v122
    v_add_f32 v121, 0x3727c5ac, v121
    v_cvt_pk_bf16_f32 v122, v121, v121
    v_lshlrev_b32 v121, 16, v122
    v_sqrt_f32 v121, v121
    s_nop 0
    v_cvt_pk_bf16_f32 v122, v121, v121
    v_lshlrev_b32 v121, 16, v122
    v_rcp_f32 v121, v121
    s_nop 0
    v_mul_f32 v120, -v120, v121
    v_pk_fma_f32 v[124:125], v[100:101], v[120:121], v[120:121] op_sel:[0,1,0] op_sel_hi:[1,1,0]
    v_pk_fma_f32 v[126:127], v[102:103], v[120:121], v[120:121] op_sel:[0,1,0] op_sel_hi:[1,1,0]
    v_pk_fma_f32 v[100:101], v[124:125], v[108:109], v[100:101]
    v_pk_fma_f32 v[102:103], v[126:127], v[110:111], v[102:103]
    v_pk_fma_f32 v[124:125], v[104:105], v[120:121], v[120:121] op_sel:[0,1,0] op_sel_hi:[1,1,0]
    v_pk_fma_f32 v[126:127], v[106:107], v[120:121], v[120:121] op_sel:[0,1,0] op_sel_hi:[1,1,0]
    v_pk_fma_f32 v[104:105], v[124:125], v[112:113], v[104:105]
    v_pk_fma_f32 v[106:107], v[126:127], v[114:115], v[106:107]
    v_cvt_pk_bf16_f32 v124, v100, v101
    v_cvt_pk_bf16_f32 v125, v102, v103
    v_cvt_pk_bf16_f32 v126, v104, v105
    v_cvt_pk_bf16_f32 v127, v106, v107
    buffer_store_dwordx4 v[124:127], v12, s[52:55], s33 offen sc0 sc1
    s_waitcnt vmcnt(6) lgkmcnt(7)
    v_mfma_f32_16x16x32_bf16 v[72:75], v[16:19], v[128:131], 0
    ds_read_b128 v[60:63], v3 offset:11264
    v_lshlrev_b32 v100, 16, v124
    v_mfma_f32_16x16x32_bf16 v[76:79], v[20:23], v[128:131], 0
    ds_read_b128 v[16:19], v3 offset:12288
    buffer_load_dwordx4 v[152:155], v3, s[52:55], s30 offen offset:2048 sc1
    v_and_b32 v104, 0xffff0000, v124
    v_mfma_f32_16x16x32_bf16 v[80:83], v[24:27], v[128:131], 0
    ds_read_b128 v[20:23], v3 offset:13312
    v_lshlrev_b32 v101, 16, v125
    v_mfma_f32_16x16x32_bf16 v[84:87], v[28:31], v[128:131], 0
    ds_read_b128 v[24:27], v3 offset:14336
    v_and_b32 v105, 0xffff0000, v125
    s_waitcnt lgkmcnt(7)
    v_mfma_f32_16x16x32_bf16 v[88:91], v[32:35], v[128:131], 0
    ds_read_b128 v[28:31], v3 offset:15360
    v_lshlrev_b32 v102, 16, v126
    v_mfma_f32_16x16x32_bf16 v[92:95], v[36:39], v[128:131], 0
    ds_read_b128 v[32:35], v3 offset:16384
    buffer_load_dwordx4 v[156:159], v3, s[52:55], s30 offen offset:3072 sc1
    v_and_b32 v106, 0xffff0000, v126
    v_mfma_f32_16x16x32_bf16 v[96:99], v[40:43], v[128:131], 0
    ds_read_b128 v[36:39], v3 offset:17408
    v_lshlrev_b32 v103, 16, v127
    s_waitcnt vmcnt(7)
    v_mfma_f32_16x16x32_bf16 v[72:75], v[44:47], v[132:135], v[72:75]
    ds_read_b128 v[40:43], v3 offset:18432
    v_and_b32 v107, 0xffff0000, v127
    s_waitcnt lgkmcnt(7)
    v_mfma_f32_16x16x32_bf16 v[76:79], v[48:51], v[132:135], v[76:79]
    ds_read_b128 v[44:47], v3 offset:19456
    v_add_f32 v118, v100, v101
    v_mfma_f32_16x16x32_bf16 v[80:83], v[52:55], v[132:135], v[80:83]
    ds_read_b128 v[48:51], v3 offset:20480
    s_add_u32 s30, s46, 8192
    buffer_load_dwordx4 v[160:163], v3, s[52:55], s30 offen offset:0 sc1
    v_mul_f32 v119, v100, v100
    v_mfma_f32_16x16x32_bf16 v[84:87], v[56:59], v[132:135], v[84:87]
    ds_read_b128 v[52:55], v3 offset:21504
    v_fmac_f32 v119, v101, v101
    v_mfma_f32_16x16x32_bf16 v[88:91], v[60:63], v[132:135], v[88:91]
    ds_read_b128 v[56:59], v3 offset:22528
    v_add_f32 v118, v118, v102
    s_waitcnt lgkmcnt(7)
    v_mfma_f32_16x16x32_bf16 v[92:95], v[16:19], v[132:135], v[92:95]
    ds_read_b128 v[60:63], v3 offset:23552
    v_fmac_f32 v119, v102, v102
    v_mfma_f32_16x16x32_bf16 v[96:99], v[20:23], v[132:135], v[96:99]
    ds_read_b128 v[16:19], v3 offset:24576
    buffer_load_dwordx4 v[164:167], v3, s[52:55], s30 offen offset:1024 sc1
    v_add_f32 v118, v118, v103
    s_waitcnt vmcnt(8)
    v_mfma_f32_16x16x32_bf16 v[72:75], v[24:27], v[136:139], v[72:75]
    ds_read_b128 v[20:23], v3 offset:25600
    v_mov_b32 v7, 4
    v_mfma_f32_16x16x32_bf16 v[76:79], v[28:31], v[136:139], v[76:79]
    ds_read_b128 v[24:27], v3 offset:26624
    s_waitcnt vmcnt(4)
    s_waitcnt lgkmcnt(7)
    v_mfma_f32_16x16x32_bf16 v[80:83], v[32:35], v[136:139], v[80:83]
    ds_read_b128 v[28:31], v3 offset:27648
    buffer_store_dword v7, v9, s[52:55], s68 offen offset:512 sc0 sc1
    v_mfma_f32_16x16x32_bf16 v[84:87], v[36:39], v[136:139], v[84:87]
    ds_read_b128 v[32:35], v3 offset:28672
    buffer_load_dwordx4 v[168:171], v3, s[52:55], s30 offen offset:2048 sc1
    v_fmac_f32 v119, v103, v103
    v_mfma_f32_16x16x32_bf16 v[88:91], v[40:43], v[136:139], v[88:91]
    ds_read_b128 v[36:39], v3 offset:29696
    v_add_f32 v118, v118, v104
    v_mfma_f32_16x16x32_bf16 v[92:95], v[44:47], v[136:139], v[92:95]
    ds_read_b128 v[40:43], v3 offset:30720
    v_fmac_f32 v119, v104, v104
    s_waitcnt lgkmcnt(7)
    v_mfma_f32_16x16x32_bf16 v[96:99], v[48:51], v[136:139], v[96:99]
    ds_read_b128 v[44:47], v3 offset:31744
    v_add_f32 v118, v118, v105
    v_mfma_f32_16x16x32_bf16 v[72:75], v[52:55], v[140:143], v[72:75]
    ds_read_b128 v[48:51], v3 offset:32768
    buffer_load_dwordx4 v[172:175], v3, s[52:55], s30 offen offset:3072 sc1
    v_fmac_f32 v119, v105, v105
    v_mfma_f32_16x16x32_bf16 v[76:79], v[56:59], v[140:143], v[76:79]
    ds_read_b128 v[52:55], v3 offset:33792
    v_add_f32 v118, v118, v106
    v_mfma_f32_16x16x32_bf16 v[80:83], v[60:63], v[140:143], v[80:83]
    ds_read_b128 v[56:59], v3 offset:34816
    v_fmac_f32 v119, v106, v106
    s_waitcnt lgkmcnt(7)
    v_mfma_f32_16x16x32_bf16 v[84:87], v[16:19], v[140:143], v[84:87]
    ds_read_b128 v[60:63], v3 offset:35840
    v_add_f32 v118, v118, v107
    v_mfma_f32_16x16x32_bf16 v[88:91], v[20:23], v[140:143], v[88:91]
    ds_read_b128 v[16:19], v3 offset:36864
    s_add_u32 s30, s46, 12288
    buffer_load_dwordx4 v[176:179], v3, s[52:55], s30 offen offset:0 sc1
    v_fmac_f32 v119, v107, v107
    v_mfma_f32_16x16x32_bf16 v[92:95], v[24:27], v[140:143], v[92:95]
    ds_read_b128 v[20:23], v3 offset:37888
    s_nop 0
    v_mfma_f32_16x16x32_bf16 v[96:99], v[28:31], v[140:143], v[96:99]
    ds_read_b128 v[24:27], v3 offset:38912
    v_add_f32_dpp v118, v118, v118 quad_perm:[1,0,3,2] row_mask:0xf bank_mask:0xf
    s_waitcnt lgkmcnt(7)
    v_mfma_f32_16x16x32_bf16 v[72:75], v[32:35], v[144:147], v[72:75]
    ds_read_b128 v[28:31], v3 offset:39936
    v_add_f32_dpp v119, v119, v119 quad_perm:[1,0,3,2] row_mask:0xf bank_mask:0xf
    v_mfma_f32_16x16x32_bf16 v[76:79], v[36:39], v[144:147], v[76:79]
    ds_read_b128 v[32:35], v3 offset:40960
    buffer_load_dwordx4 v[180:183], v3, s[52:55], s30 offen offset:1024 sc1
    s_nop 0
    v_mfma_f32_16x16x32_bf16 v[80:83], v[40:43], v[144:147], v[80:83]
    ds_read_b128 v[36:39], v3 offset:41984
    v_add_f32_dpp v118, v118, v118 quad_perm:[2,3,0,1] row_mask:0xf bank_mask:0xf
    v_mfma_f32_16x16x32_bf16 v[84:87], v[44:47], v[144:147], v[84:87]
    ds_read_b128 v[40:43], v3 offset:43008
    v_add_f32_dpp v119, v119, v119 quad_perm:[2,3,0,1] row_mask:0xf bank_mask:0xf
    s_waitcnt lgkmcnt(7)
    v_mfma_f32_16x16x32_bf16 v[88:91], v[48:51], v[144:147], v[88:91]
    ds_read_b128 v[44:47], v3 offset:44032
    s_nop 0
    v_mfma_f32_16x16x32_bf16 v[92:95], v[52:55], v[144:147], v[92:95]
    ds_read_b128 v[48:51], v3 offset:45056
    buffer_load_dwordx4 v[184:187], v3, s[52:55], s30 offen offset:2048 sc1
    v_add_f32_dpp v118, v118, v118 row_half_mirror row_mask:0xf bank_mask:0xf
    v_mfma_f32_16x16x32_bf16 v[96:99], v[56:59], v[144:147], v[96:99]
    ds_read_b128 v[52:55], v3 offset:46080
    v_add_f32_dpp v119, v119, v119 row_half_mirror row_mask:0xf bank_mask:0xf
    v_mfma_f32_16x16x32_bf16 v[72:75], v[60:63], v[148:151], v[72:75]
    ds_read_b128 v[56:59], v3 offset:47104
    v_and_b32 v119, 0x7fffffff, v119
    s_waitcnt lgkmcnt(7)
    v_mfma_f32_16x16x32_bf16 v[76:79], v[16:19], v[148:151], v[76:79]
    ds_read_b128 v[60:63], v3 offset:48128
    buffer_store_dwordx2 v[118:119], v11, s[52:55], s9 offen offset:1024 sc0 sc1
    v_mfma_f32_16x16x32_bf16 v[80:83], v[20:23], v[148:151], v[80:83]
    ds_read_b128 v[16:19], v3 offset:49152
    buffer_load_dwordx4 v[188:191], v3, s[52:55], s30 offen offset:3072 sc1
    v_accvgpr_write_b32 a228, v124
    v_mfma_f32_16x16x32_bf16 v[84:87], v[24:27], v[148:151], v[84:87]
    ds_read_b128 v[20:23], v3 offset:50176
    v_accvgpr_write_b32 a229, v125
    v_mfma_f32_16x16x32_bf16 v[88:91], v[28:31], v[148:151], v[88:91]
    ds_read_b128 v[24:27], v3 offset:51200
    v_accvgpr_write_b32 a230, v126
    s_waitcnt lgkmcnt(7)
    v_mfma_f32_16x16x32_bf16 v[92:95], v[32:35], v[148:151], v[92:95]
    ds_read_b128 v[28:31], v3 offset:52224
    v_accvgpr_write_b32 a231, v127
    v_mfma_f32_16x16x32_bf16 v[96:99], v[36:39], v[148:151], v[96:99]
    ds_read_b128 v[32:35], v3 offset:53248
    buffer_load_dwordx4 v[68:71], v4, s[52:55], s8 offen offset:0 sc1
    s_waitcnt vmcnt(12)
    v_mfma_f32_16x16x32_bf16 v[72:75], v[40:43], v[152:155], v[72:75]
    ds_read_b128 v[36:39], v3 offset:54272
    v_mfma_f32_16x16x32_bf16 v[76:79], v[44:47], v[152:155], v[76:79]
    ds_read_b128 v[40:43], v3 offset:55296
    s_waitcnt lgkmcnt(7)
    v_mfma_f32_16x16x32_bf16 v[80:83], v[48:51], v[152:155], v[80:83]
    ds_read_b128 v[44:47], v3 offset:56320
    v_mfma_f32_16x16x32_bf16 v[84:87], v[52:55], v[152:155], v[84:87]
    ds_read_b128 v[48:51], v6 offset:0
    v_mfma_f32_16x16x32_bf16 v[88:91], v[56:59], v[152:155], v[88:91]
    ds_read_b128 v[52:55], v6 offset:1024
    v_mfma_f32_16x16x32_bf16 v[92:95], v[60:63], v[152:155], v[92:95]
    ds_read_b128 v[56:59], v6 offset:2048
    s_waitcnt lgkmcnt(7)
    v_mfma_f32_16x16x32_bf16 v[96:99], v[16:19], v[152:155], v[96:99]
    ds_read_b128 v[60:63], v6 offset:3072
    s_waitcnt vmcnt(11)
    v_mfma_f32_16x16x32_bf16 v[72:75], v[20:23], v[156:159], v[72:75]
    ds_read_b128 v[16:19], v6 offset:4096
    v_mfma_f32_16x16x32_bf16 v[76:79], v[24:27], v[156:159], v[76:79]
    ds_read_b128 v[20:23], v6 offset:5120
    v_mfma_f32_16x16x32_bf16 v[80:83], v[28:31], v[156:159], v[80:83]
    ds_read_b128 v[24:27], v6 offset:6144
    s_waitcnt lgkmcnt(7)
    v_mfma_f32_16x16x32_bf16 v[84:87], v[32:35], v[156:159], v[84:87]
    ds_read_b128 v[28:31], v6 offset:7168
    v_mfma_f32_16x16x32_bf16 v[88:91], v[36:39], v[156:159], v[88:91]
    ds_read_b128 v[32:35], v6 offset:8192
    v_mfma_f32_16x16x32_bf16 v[92:95], v[40:43], v[156:159], v[92:95]
    ds_read_b128 v[36:39], v6 offset:9216
    v_mfma_f32_16x16x32_bf16 v[96:99], v[44:47], v[156:159], v[96:99]
    ds_read_b128 v[40:43], v6 offset:10240
    s_waitcnt vmcnt(10) lgkmcnt(7)
    v_mfma_f32_16x16x32_bf16 v[72:75], v[48:51], v[160:163], v[72:75]
    ds_read_b128 v[44:47], v6 offset:11264
    v_mfma_f32_16x16x32_bf16 v[76:79], v[52:55], v[160:163], v[76:79]
    ds_read_b128 v[48:51], v6 offset:12288
    v_mfma_f32_16x16x32_bf16 v[80:83], v[56:59], v[160:163], v[80:83]
    ds_read_b128 v[52:55], v6 offset:13312
    v_mfma_f32_16x16x32_bf16 v[84:87], v[60:63], v[160:163], v[84:87]
    ds_read_b128 v[56:59], v6 offset:14336
    s_waitcnt lgkmcnt(7)
    v_mfma_f32_16x16x32_bf16 v[88:91], v[16:19], v[160:163], v[88:91]
    ds_read_b128 v[60:63], v6 offset:15360
    v_mfma_f32_16x16x32_bf16 v[92:95], v[20:23], v[160:163], v[92:95]
    ds_read_b128 v[16:19], v6 offset:16384
    v_mfma_f32_16x16x32_bf16 v[96:99], v[24:27], v[160:163], v[96:99]
    ds_read_b128 v[20:23], v6 offset:17408
    s_waitcnt vmcnt(9)
    v_mfma_f32_16x16x32_bf16 v[72:75], v[28:31], v[164:167], v[72:75]
    ds_read_b128 v[24:27], v6 offset:18432
    s_waitcnt lgkmcnt(7)
    v_mfma_f32_16x16x32_bf16 v[76:79], v[32:35], v[164:167], v[76:79]
    ds_read_b128 v[28:31], v6 offset:19456
    v_mfma_f32_16x16x32_bf16 v[80:83], v[36:39], v[164:167], v[80:83]
    ds_read_b128 v[32:35], v6 offset:20480
    v_mfma_f32_16x16x32_bf16 v[84:87], v[40:43], v[164:167], v[84:87]
    ds_read_b128 v[36:39], v6 offset:21504
    buffer_load_dword v14, v13, s[52:55], s69 offen offset:512 sc1
    v_mfma_f32_16x16x32_bf16 v[88:91], v[44:47], v[164:167], v[88:91]
    ds_read_b128 v[40:43], v6 offset:22528
    s_waitcnt lgkmcnt(7)
    v_mfma_f32_16x16x32_bf16 v[92:95], v[48:51], v[164:167], v[92:95]
    ds_read_b128 v[44:47], v6 offset:23552
    v_mfma_f32_16x16x32_bf16 v[96:99], v[52:55], v[164:167], v[96:99]
    ds_read_b128 v[48:51], v6 offset:24576
    s_waitcnt vmcnt(8)
    v_mfma_f32_16x16x32_bf16 v[72:75], v[56:59], v[168:171], v[72:75]
    ds_read_b128 v[52:55], v6 offset:25600
    v_mfma_f32_16x16x32_bf16 v[76:79], v[60:63], v[168:171], v[76:79]
    ds_read_b128 v[56:59], v6 offset:26624
    s_waitcnt lgkmcnt(7)
    v_mfma_f32_16x16x32_bf16 v[80:83], v[16:19], v[168:171], v[80:83]
    ds_read_b128 v[60:63], v6 offset:27648
    v_mfma_f32_16x16x32_bf16 v[84:87], v[20:23], v[168:171], v[84:87]
    ds_read_b128 v[16:19], v6 offset:28672
    v_mfma_f32_16x16x32_bf16 v[88:91], v[24:27], v[168:171], v[88:91]
    ds_read_b128 v[20:23], v6 offset:29696
    v_mfma_f32_16x16x32_bf16 v[92:95], v[28:31], v[168:171], v[92:95]
    ds_read_b128 v[24:27], v6 offset:30720
    s_waitcnt lgkmcnt(7)
    v_mfma_f32_16x16x32_bf16 v[96:99], v[32:35], v[168:171], v[96:99]
    ds_read_b128 v[28:31], v6 offset:31744
    s_waitcnt vmcnt(7)
    v_mfma_f32_16x16x32_bf16 v[72:75], v[36:39], v[172:175], v[72:75]
    ds_read_b128 v[32:35], v6 offset:32768
    v_mfma_f32_16x16x32_bf16 v[76:79], v[40:43], v[172:175], v[76:79]
    ds_read_b128 v[36:39], v6 offset:33792
    v_mfma_f32_16x16x32_bf16 v[80:83], v[44:47], v[172:175], v[80:83]
    ds_read_b128 v[40:43], v6 offset:34816
    s_waitcnt lgkmcnt(7)
    v_mfma_f32_16x16x32_bf16 v[84:87], v[48:51], v[172:175], v[84:87]
    ds_read_b128 v[44:47], v6 offset:35840
    v_mfma_f32_16x16x32_bf16 v[88:91], v[52:55], v[172:175], v[88:91]
    ds_read_b128 v[48:51], v6 offset:36864
    s_waitcnt vmcnt(0)
    v_cmp_gt_u32 vcc, 4, v14
    s_cbranch_vccnz FWAIT_106
FOK_105:
    v_mfma_f32_16x16x32_bf16 v[92:95], v[56:59], v[172:175], v[92:95]
    ds_read_b128 v[52:55], v6 offset:37888
    s_add_u32 s31, s46, 16384
    buffer_load_dwordx4 v[192:195], v3, s[52:55], s31 offen offset:0 sc1
    v_mfma_f32_16x16x32_bf16 v[96:99], v[60:63], v[172:175], v[96:99]
    ds_read_b128 v[56:59], v6 offset:38912
    v_or_b32 v64, v69, v71
    v_cmp_gt_i32 vcc, 0, v64
    s_cbranch_vccnz SWAIT_108
SOK_107:
    s_waitcnt lgkmcnt(7)
    v_mfma_f32_16x16x32_bf16 v[72:75], v[16:19], v[176:179], v[72:75]
    ds_read_b128 v[60:63], v6 offset:39936
    v_add_f32 v68, v68, v70
    v_mfma_f32_16x16x32_bf16 v[76:79], v[20:23], v[176:179], v[76:79]
    ds_read_b128 v[16:19], v6 offset:40960
    v_add_f32 v69, v69, v71
    v_mfma_f32_16x16x32_bf16 v[80:83], v[24:27], v[176:179], v[80:83]
    ds_read_b128 v[20:23], v6 offset:41984
    v_mov_b32 v70, v68
    v_mfma_f32_16x16x32_bf16 v[84:87], v[28:31], v[176:179], v[84:87]
    ds_read_b128 v[24:27], v6 offset:43008
    buffer_load_dwordx4 v[196:199], v3, s[52:55], s31 offen offset:1024 sc1
    s_waitcnt lgkmcnt(7)
    v_mfma_f32_16x16x32_bf16 v[88:91], v[32:35], v[176:179], v[88:91]
    ds_read_b128 v[28:31], v6 offset:44032
    v_mov_b32 v71, v69
    v_mfma_f32_16x16x32_bf16 v[92:95], v[36:39], v[176:179], v[92:95]
    ds_read_b128 v[32:35], v6 offset:45056
    s_nop 0
    v_mfma_f32_16x16x32_bf16 v[96:99], v[40:43], v[176:179], v[96:99]
    ds_read_b128 v[36:39], v6 offset:46080
    v_permlane16_swap_b32 v68, v70
    v_mfma_f32_16x16x32_bf16 v[72:75], v[44:47], v[180:183], v[72:75]
    ds_read_b128 v[40:43], v6 offset:47104
    v_permlane16_swap_b32 v69, v71
    s_waitcnt lgkmcnt(7)
    v_mfma_f32_16x16x32_bf16 v[76:79], v[48:51], v[180:183], v[76:79]
    ds_read_b128 v[44:47], v6 offset:48128
    buffer_load_dwordx4 v[200:203], v3, s[52:55], s31 offen offset:2048 sc1
    v_mfma_f32_16x16x32_bf16 v[80:83], v[52:55], v[180:183], v[80:83]
    ds_read_b128 v[48:51], v6 offset:49152
    s_nop 0
    v_mfma_f32_16x16x32_bf16 v[84:87], v[56:59], v[180:183], v[84:87]
    ds_read_b128 v[52:55], v6 offset:50176
    v_add_f32 v68, v68, v70
    v_mfma_f32_16x16x32_bf16 v[88:91], v[60:63], v[180:183], v[88:91]
    ds_read_b128 v[56:59], v6 offset:51200
    v_add_f32 v69, v69, v71
    s_waitcnt lgkmcnt(7)
    v_mfma_f32_16x16x32_bf16 v[92:95], v[16:19], v[180:183], v[92:95]
    ds_read_b128 v[60:63], v6 offset:52224
    v_mov_b32 v70, v68
    v_mfma_f32_16x16x32_bf16 v[96:99], v[20:23], v[180:183], v[96:99]
    ds_read_b128 v[16:19], v6 offset:53248
    buffer_load_dwordx4 v[204:207], v3, s[52:55], s31 offen offset:3072 sc1
    v_mfma_f32_16x16x32_bf16 v[72:75], v[24:27], v[184:187], v[72:75]
    ds_read_b128 v[20:23], v6 offset:54272
    v_mov_b32 v71, v69
    v_mfma_f32_16x16x32_bf16 v[76:79], v[28:31], v[184:187], v[76:79]
    ds_read_b128 v[24:27], v6 offset:55296
    s_nop 0
    s_waitcnt lgkmcnt(7)
    v_mfma_f32_16x16x32_bf16 v[80:83], v[32:35], v[184:187], v[80:83]
    ds_read_b128 v[28:31], v6 offset:56320
    v_permlane32_swap_b32 v68, v70
    v_mfma_f32_16x16x32_bf16 v[84:87], v[36:39], v[184:187], v[84:87]
    ds_read_b128 v[32:35], v3 offset:0
    v_permlane32_swap_b32 v69, v71
    v_mfma_f32_16x16x32_bf16 v[88:91], v[40:43], v[184:187], v[88:91]
    ds_read_b128 v[36:39], v3 offset:1024
    s_add_u32 s31, s46, 20480
    buffer_load_dwordx4 v[208:211], v3, s[52:55], s31 offen offset:0 sc1
    v_mfma_f32_16x16x32_bf16 v[92:95], v[44:47], v[184:187], v[92:95]
    ds_read_b128 v[40:43], v3 offset:2048
    s_nop 0
    s_waitcnt lgkmcnt(7)
    v_mfma_f32_16x16x32_bf16 v[96:99], v[48:51], v[184:187], v[96:99]
    ds_read_b128 v[44:47], v3 offset:3072
    v_add_f32 v68, v68, v70
    v_mfma_f32_16x16x32_bf16 v[72:75], v[52:55], v[188:191], v[72:75]
    ds_read_b128 v[48:51], v3 offset:4096
    v_add_f32 v69, v69, v71
    v_mfma_f32_16x16x32_bf16 v[76:79], v[56:59], v[188:191], v[76:79]
    ds_read_b128 v[52:55], v3 offset:5120
    v_mul_f32 v68, 0x3b000000, v68
    v_mfma_f32_16x16x32_bf16 v[80:83], v[60:63], v[188:191], v[80:83]
    ds_read_b128 v[56:59], v3 offset:6144
    buffer_load_dwordx4 v[212:215], v3, s[52:55], s31 offen offset:1024 sc1
    s_waitcnt lgkmcnt(7)
    v_mfma_f32_16x16x32_bf16 v[84:87], v[16:19], v[188:191], v[84:87]
    ds_read_b128 v[60:63], v3 offset:7168
    v_mul_f32 v69, 0x3b000000, v69
    v_mfma_f32_16x16x32_bf16 v[88:91], v[20:23], v[188:191], v[88:91]
    ds_read_b128 v[16:19], v3 offset:8192
    v_fma_f32 v69, -v68, v68, v69
    v_mfma_f32_16x16x32_bf16 v[92:95], v[24:27], v[188:191], v[92:95]
    ds_read_b128 v[20:23], v3 offset:9216
    v_max_f32 v69, 0, v69
    v_mfma_f32_16x16x32_bf16 v[96:99], v[28:31], v[188:191], v[96:99]
    ds_read_b128 v[24:27], v3 offset:10240
    v_cvt_pk_bf16_f32 v71, v68, v69
    buffer_load_dwordx4 v[216:219], v3, s[52:55], s31 offen offset:2048 sc1
    v_lshlrev_b32 v68, 16, v71
    v_and_b32 v69, 0xffff0000, v71
    v_add_f32 v69, 0x3727c5ac, v69
    v_cvt_pk_bf16_f32 v71, v69, v69
    buffer_load_dwordx4 v[220:223], v3, s[52:55], s31 offen offset:3072 sc1
    v_lshlrev_b32 v69, 16, v71
    v_sqrt_f32 v69, v69
    s_nop 0
    v_cvt_pk_bf16_f32 v71, v69, v69
    v_lshlrev_b32 v70, 16, v71
    v_rcp_f32 v69, v70
    s_nop 0
    v_cvt_pk_bf16_f32 v64, -v68, -v68
    v_cvt_pk_bf16_f32 v65, -v68, v70
    v_mul_f32 v69, v69, v69
    v_cndmask_b32 v64, 0, v64, s[34:35]
    v_cndmask_b32 v65, 0, v65, s[34:35]
    buffer_store_dword v69, v8, s[52:55], s13 offen offset:0 sc0 sc1
    s_nop 1
    v_mfma_f32_16x16x16_bf16 v[72:75], a[240:241], v[64:65], v[72:75]
    v_mfma_f32_16x16x16_bf16 v[76:79], a[242:243], v[64:65], v[76:79]
    v_mfma_f32_16x16x16_bf16 v[80:83], a[244:245], v[64:65], v[80:83]
    v_mfma_f32_16x16x16_bf16 v[84:87], a[246:247], v[64:65], v[84:87]
    v_mfma_f32_16x16x16_bf16 v[88:91], a[248:249], v[64:65], v[88:91]
    v_mfma_f32_16x16x16_bf16 v[92:95], a[250:251], v[64:65], v[92:95]
    v_mfma_f32_16x16x16_bf16 v[96:99], a[252:253], v[64:65], v[96:99]
    s_waitcnt vmcnt(8) lgkmcnt(7)
    v_mfma_f32_16x16x32_bf16 v[100:103], v[32:35], v[192:195], 0
    ds_read_b128 v[28:31], v3 offset:11264
    v_mfma_f32_16x16x32_bf16 v[104:107], v[36:39], v[192:195], 0
    ds_read_b128 v[32:35], v3 offset:12288
    s_add_u32 s31, s46, 24576
    buffer_load_dwordx4 v[224:227], v3, s[52:55], s31 offen offset:0 sc1
    v_mfma_f32_16x16x32_bf16 v[108:111], v[40:43], v[192:195], 0
    ds_read_b128 v[36:39], v3 offset:13312
    v_mfma_f32_16x16x32_bf16 v[112:115], v[44:47], v[192:195], 0
    ds_read_b128 v[40:43], v3 offset:14336
    v_mul_f32 v72, v72, abs(v72)
    v_mul_f32 v73, v73, abs(v73)
    v_mul_f32 v74, v74, abs(v74)
    v_mul_f32 v75, v75, abs(v75)
    v_mul_f32 v76, v76, abs(v76)
    v_mul_f32 v77, v77, abs(v77)
    s_waitcnt lgkmcnt(7)
    v_mfma_f32_16x16x32_bf16 v[116:119], v[48:51], v[192:195], 0
    ds_read_b128 v[44:47], v3 offset:15360
    v_mul_f32 v78, v78, abs(v78)
    v_mul_f32 v79, v79, abs(v79)
    v_cvt_pk_bf16_f32 v72, v72, v73
    v_cvt_pk_bf16_f32 v73, v74, v75
    v_cvt_pk_bf16_f32 v74, v76, v77
    v_cvt_pk_bf16_f32 v75, v78, v79
    v_mfma_f32_16x16x32_bf16 v[120:123], v[52:55], v[192:195], 0
    ds_read_b128 v[48:51], v3 offset:16384
    v_pk_max_i16 v72, v72, 0
    v_pk_max_i16 v73, v73, 0
    v_pk_max_i16 v74, v74, 0
    v_pk_max_i16 v75, v75, 0
    buffer_store_dwordx4 v[72:75], v0, s[52:55], s10 offen offset:0 sc0 sc1
    v_mul_f32 v80, v80, abs(v80)
    v_mfma_f32_16x16x32_bf16 v[124:127], v[56:59], v[192:195], 0
    ds_read_b128 v[52:55], v3 offset:17408
    buffer_load_dwordx4 v[228:231], v3, s[52:55], s31 offen offset:1024 sc1
    v_mul_f32 v81, v81, abs(v81)
    v_mul_f32 v82, v82, abs(v82)
    v_mul_f32 v83, v83, abs(v83)
    v_mul_f32 v84, v84, abs(v84)
    v_mul_f32 v85, v85, abs(v85)
    v_mul_f32 v86, v86, abs(v86)
    s_waitcnt vmcnt(10)
    v_mfma_f32_16x16x32_bf16 v[100:103], v[60:63], v[196:199], v[100:103]
    ds_read_b128 v[56:59], v3 offset:18432
    v_mul_f32 v87, v87, abs(v87)
    v_cvt_pk_bf16_f32 v80, v80, v81
    v_cvt_pk_bf16_f32 v81, v82, v83
    v_cvt_pk_bf16_f32 v82, v84, v85
    v_cvt_pk_bf16_f32 v83, v86, v87
    v_pk_max_i16 v80, v80, 0
    s_waitcnt lgkmcnt(7)
    v_mfma_f32_16x16x32_bf16 v[104:107], v[16:19], v[196:199], v[104:107]
    ds_read_b128 v[60:63], v3 offset:19456
    v_pk_max_i16 v81, v81, 0
    v_pk_max_i16 v82, v82, 0
    v_pk_max_i16 v83, v83, 0
    buffer_store_dwordx4 v[80:83], v0, s[52:55], s10 offen offset:2048 sc0 sc1
    v_mul_f32 v88, v88, abs(v88)
    v_mul_f32 v89, v89, abs(v89)
    v_mfma_f32_16x16x32_bf16 v[108:111], v[20:23], v[196:199], v[108:111]
    ds_read_b128 v[16:19], v3 offset:20480
    v_mul_f32 v90, v90, abs(v90)
    v_mul_f32 v91, v91, abs(v91)
    v_mul_f32 v92, v92, abs(v92)
    v_mul_f32 v93, v93, abs(v93)
    v_mul_f32 v94, v94, abs(v94)
    v_mul_f32 v95, v95, abs(v95)
    v_mfma_f32_16x16x32_bf16 v[112:115], v[24:27], v[196:199], v[112:115]
    ds_read_b128 v[20:23], v3 offset:21504
    v_cvt_pk_bf16_f32 v88, v88, v89
    v_cvt_pk_bf16_f32 v89, v90, v91
    v_cvt_pk_bf16_f32 v90, v92, v93
    v_cvt_pk_bf16_f32 v91, v94, v95
    v_pk_max_i16 v88, v88, 0
    v_pk_max_i16 v89, v89, 0
    v_mfma_f32_16x16x32_bf16 v[116:119], v[28:31], v[196:199], v[116:119]
    ds_read_b128 v[24:27], v3 offset:22528
    buffer_load_dwordx4 v[232:235], v3, s[52:55], s31 offen offset:2048 sc1
    v_pk_max_i16 v90, v90, 0
    v_pk_max_i16 v91, v91, 0
    buffer_store_dwordx4 v[88:91], v0, s[52:55], s11 offen offset:0 sc0 sc1
    v_mul_f32 v96, v96, abs(v96)
    v_mul_f32 v97, v97, abs(v97)
    v_mul_f32 v98, v98, abs(v98)
    s_waitcnt lgkmcnt(7)
    v_mfma_f32_16x16x32_bf16 v[120:123], v[32:35], v[196:199], v[120:123]
    ds_read_b128 v[28:31], v3 offset:23552
    v_mul_f32 v99, v99, abs(v99)
    v_cvt_pk_bf16_f32 v96, v96, v97
    v_cvt_pk_bf16_f32 v97, v98, v99
    v_pk_max_i16 v96, v96, 0
    v_pk_max_i16 v97, v97, 0
    buffer_store_dwordx2 v[96:97], v1, s[52:55], s11 offen offset:2048 sc0 sc1
    v_mfma_f32_16x16x32_bf16 v[124:127], v[36:39], v[196:199], v[124:127]
    ds_read_b128 v[32:35], v3 offset:24576
    buffer_load_dwordx4 v[68:71], v4, s[52:55], s8 offen offset:1024 sc1
    s_waitcnt vmcnt(14)
    v_mfma_f32_16x16x32_bf16 v[100:103], v[40:43], v[200:203], v[100:103]
    ds_read_b128 v[36:39], v3 offset:25600
    v_lshrrev_b32 v13, 2, v3
    v_mfma_f32_16x16x32_bf16 v[104:107], v[44:47], v[200:203], v[104:107]
    ds_read_b128 v[40:43], v3 offset:26624
    v_and_b32 v13, 28, v13
    s_waitcnt lgkmcnt(7)
    v_mfma_f32_16x16x32_bf16 v[108:111], v[48:51], v[200:203], v[108:111]
    ds_read_b128 v[44:47], v3 offset:27648
    buffer_load_dwordx4 v[236:239], v3, s[52:55], s31 offen offset:3072 sc1
    v_accvgpr_read_b32 v12, a255
    v_mfma_f32_16x16x32_bf16 v[112:115], v[52:55], v[200:203], v[112:115]
    ds_read_b128 v[48:51], v3 offset:28672
    v_mfma_f32_16x16x32_bf16 v[116:119], v[56:59], v[200:203], v[116:119]
    ds_read_b128 v[52:55], v3 offset:29696
    v_mfma_f32_16x16x32_bf16 v[120:123], v[60:63], v[200:203], v[120:123]
    ds_read_b128 v[56:59], v3 offset:30720
    s_waitcnt lgkmcnt(7)
    v_mfma_f32_16x16x32_bf16 v[124:127], v[16:19], v[200:203], v[124:127]
    ds_read_b128 v[60:63], v3 offset:31744
    s_waitcnt vmcnt(14)
    v_mfma_f32_16x16x32_bf16 v[100:103], v[20:23], v[204:207], v[100:103]
    ds_read_b128 v[16:19], v3 offset:32768
    s_add_u32 s31, s46, 28672
    buffer_load_dwordx4 v[240:243], v3, s[52:55], s31 offen offset:0 sc1
    v_mfma_f32_16x16x32_bf16 v[104:107], v[24:27], v[204:207], v[104:107]
    ds_read_b128 v[20:23], v3 offset:33792
    v_mfma_f32_16x16x32_bf16 v[108:111], v[28:31], v[204:207], v[108:111]
    ds_read_b128 v[24:27], v3 offset:34816
    s_waitcnt lgkmcnt(7)
    v_mfma_f32_16x16x32_bf16 v[112:115], v[32:35], v[204:207], v[112:115]
    ds_read_b128 v[28:31], v3 offset:35840
    v_mfma_f32_16x16x32_bf16 v[116:119], v[36:39], v[204:207], v[116:119]
    ds_read_b128 v[32:35], v3 offset:36864
    v_mfma_f32_16x16x32_bf16 v[120:123], v[40:43], v[204:207], v[120:123]
    ds_read_b128 v[36:39], v3 offset:37888
    buffer_load_dwordx4 v[244:247], v3, s[52:55], s31 offen offset:1024 sc1
    v_mfma_f32_16x16x32_bf16 v[124:127], v[44:47], v[204:207], v[124:127]
    ds_read_b128 v[40:43], v3 offset:38912
    s_waitcnt vmcnt(15) lgkmcnt(7)
    v_mfma_f32_16x16x32_bf16 v[100:103], v[48:51], v[208:211], v[100:103]
    ds_read_b128 v[44:47], v3 offset:39936
    v_mfma_f32_16x16x32_bf16 v[104:107], v[52:55], v[208:211], v[104:107]
    ds_read_b128 v[48:51], v3 offset:40960
    v_mfma_f32_16x16x32_bf16 v[108:111], v[56:59], v[208:211], v[108:111]
    ds_read_b128 v[52:55], v3 offset:41984
    v_mfma_f32_16x16x32_bf16 v[112:115], v[60:63], v[208:211], v[112:115]
    ds_read_b128 v[56:59], v3 offset:43008
    buffer_load_dwordx4 v[248:251], v3, s[52:55], s31 offen offset:2048 sc1
    s_waitcnt lgkmcnt(7)
    v_mfma_f32_16x16x32_bf16 v[116:119], v[16:19], v[208:211], v[116:119]
    ds_read_b128 v[60:63], v3 offset:44032
    v_mfma_f32_16x16x32_bf16 v[120:123], v[20:23], v[208:211], v[120:123]
    ds_read_b128 v[16:19], v3 offset:45056
    v_mfma_f32_16x16x32_bf16 v[124:127], v[24:27], v[208:211], v[124:127]
    ds_read_b128 v[20:23], v3 offset:46080
    s_waitcnt vmcnt(15)
    v_mfma_f32_16x16x32_bf16 v[100:103], v[28:31], v[212:215], v[100:103]
    ds_read_b128 v[24:27], v3 offset:47104
    s_waitcnt lgkmcnt(7)
    v_mfma_f32_16x16x32_bf16 v[104:107], v[32:35], v[212:215], v[104:107]
    ds_read_b128 v[28:31], v3 offset:48128
    buffer_load_dwordx4 v[252:255], v3, s[52:55], s31 offen offset:3072 sc1
    v_mfma_f32_16x16x32_bf16 v[108:111], v[36:39], v[212:215], v[108:111]
    ds_read_b128 v[32:35], v3 offset:49152
    v_mov_b32 v7, 1
    v_mfma_f32_16x16x32_bf16 v[112:115], v[40:43], v[212:215], v[112:115]
    ds_read_b128 v[36:39], v3 offset:50176
    s_waitcnt vmcnt(6)
    buffer_store_dword v7, v9, s[52:55], s74 offen offset:256 sc0 sc1
    v_mfma_f32_16x16x32_bf16 v[116:119], v[44:47], v[212:215], v[116:119]
    ds_read_b128 v[40:43], v3 offset:51200
    s_waitcnt lgkmcnt(7)
    v_mfma_f32_16x16x32_bf16 v[120:123], v[48:51], v[212:215], v[120:123]
    ds_read_b128 v[44:47], v3 offset:52224
    v_mfma_f32_16x16x32_bf16 v[124:127], v[52:55], v[212:215], v[124:127]
    ds_read_b128 v[48:51], v3 offset:53248
    s_waitcnt vmcnt(6)
    v_or_b32 v66, v69, v71
    v_cmp_gt_i32 vcc, 0, v66
    s_cbranch_vccnz SWAIT_111
SOK_110:
    v_mfma_f32_16x16x32_bf16 v[100:103], v[56:59], v[216:219], v[100:103]
    ds_read_b128 v[52:55], v3 offset:54272
    v_add_f32 v68, v68, v70
    v_mfma_f32_16x16x32_bf16 v[104:107], v[60:63], v[216:219], v[104:107]
    ds_read_b128 v[56:59], v3 offset:55296
    v_add_f32 v69, v69, v71
    s_waitcnt lgkmcnt(7)
    v_mfma_f32_16x16x32_bf16 v[108:111], v[16:19], v[216:219], v[108:111]
    ds_read_b128 v[60:63], v3 offset:56320
    v_mov_b32 v70, v68
    v_mfma_f32_16x16x32_bf16 v[112:115], v[20:23], v[216:219], v[112:115]
    ds_read_b128 v[16:19], v6 offset:0
    v_mov_b32 v71, v69
    v_mfma_f32_16x16x32_bf16 v[116:119], v[24:27], v[216:219], v[116:119]
    ds_read_b128 v[20:23], v6 offset:1024
    s_nop 0
    v_mfma_f32_16x16x32_bf16 v[120:123], v[28:31], v[216:219], v[120:123]
    ds_read_b128 v[24:27], v6 offset:2048
    v_permlane16_swap_b32 v68, v70
    s_waitcnt lgkmcnt(7)
    v_mfma_f32_16x16x32_bf16 v[124:127], v[32:35], v[216:219], v[124:127]
    ds_read_b128 v[28:31], v6 offset:3072
    v_permlane16_swap_b32 v69, v71
    v_mfma_f32_16x16x32_bf16 v[100:103], v[36:39], v[220:223], v[100:103]
    ds_read_b128 v[32:35], v6 offset:4096
    s_nop 0
    v_mfma_f32_16x16x32_bf16 v[104:107], v[40:43], v[220:223], v[104:107]
    ds_read_b128 v[36:39], v6 offset:5120
    v_add_f32 v68, v68, v70
    v_mfma_f32_16x16x32_bf16 v[108:111], v[44:47], v[220:223], v[108:111]
    ds_read_b128 v[40:43], v6 offset:6144
    v_add_f32 v69, v69, v71
    s_waitcnt lgkmcnt(7)
    v_mfma_f32_16x16x32_bf16 v[112:115], v[48:51], v[220:223], v[112:115]
    ds_read_b128 v[44:47], v6 offset:7168
    buffer_load_dword v14, v13, s[52:55], s75 offen offset:256 sc1
    v_mov_b32 v70, v68
    v_mfma_f32_16x16x32_bf16 v[116:119], v[52:55], v[220:223], v[116:119]
    ds_read_b128 v[48:51], v6 offset:8192
    v_mov_b32 v71, v69
    v_mfma_f32_16x16x32_bf16 v[120:123], v[56:59], v[220:223], v[120:123]
    ds_read_b128 v[52:55], v6 offset:9216
    s_nop 0
    v_mfma_f32_16x16x32_bf16 v[124:127], v[60:63], v[220:223], v[124:127]
    ds_read_b128 v[56:59], v6 offset:10240
    v_permlane32_swap_b32 v68, v70
    s_waitcnt lgkmcnt(7)
    v_mfma_f32_16x16x32_bf16 v[100:103], v[16:19], v[224:227], v[100:103]
    ds_read_b128 v[60:63], v6 offset:11264
    v_permlane32_swap_b32 v69, v71
    v_mfma_f32_16x16x32_bf16 v[104:107], v[20:23], v[224:227], v[104:107]
    ds_read_b128 v[16:19], v6 offset:12288
    s_nop 0
    v_mfma_f32_16x16x32_bf16 v[108:111], v[24:27], v[224:227], v[108:111]
    ds_read_b128 v[20:23], v6 offset:13312
    v_add_f32 v68, v68, v70
    v_mfma_f32_16x16x32_bf16 v[112:115], v[28:31], v[224:227], v[112:115]
    ds_read_b128 v[24:27], v6 offset:14336
    v_add_f32 v69, v69, v71
    s_waitcnt lgkmcnt(7)
    v_mfma_f32_16x16x32_bf16 v[116:119], v[32:35], v[224:227], v[116:119]
    ds_read_b128 v[28:31], v6 offset:15360
    v_mul_f32 v68, 0x3b000000, v68
    v_mfma_f32_16x16x32_bf16 v[120:123], v[36:39], v[224:227], v[120:123]
    ds_read_b128 v[32:35], v6 offset:16384
    v_mul_f32 v69, 0x3b000000, v69
    v_mfma_f32_16x16x32_bf16 v[124:127], v[40:43], v[224:227], v[124:127]
    ds_read_b128 v[36:39], v6 offset:17408
    v_fma_f32 v69, -v68, v68, v69
    v_mfma_f32_16x16x32_bf16 v[100:103], v[44:47], v[228:231], v[100:103]
    ds_read_b128 v[40:43], v6 offset:18432
    v_max_f32 v69, 0, v69
    s_waitcnt lgkmcnt(7)
    v_mfma_f32_16x16x32_bf16 v[104:107], v[48:51], v[228:231], v[104:107]
    ds_read_b128 v[44:47], v6 offset:19456
    v_cvt_pk_bf16_f32 v71, v68, v69
    v_mfma_f32_16x16x32_bf16 v[108:111], v[52:55], v[228:231], v[108:111]
    ds_read_b128 v[48:51], v6 offset:20480
    v_lshlrev_b32 v68, 16, v71
    v_mfma_f32_16x16x32_bf16 v[112:115], v[56:59], v[228:231], v[112:115]
    ds_read_b128 v[52:55], v6 offset:21504
    s_waitcnt vmcnt(0)
    v_cmp_gt_u32 vcc, 1, v14
    s_cbranch_vccnz FWAIT_114
FOK_113:
    v_and_b32 v69, 0xffff0000, v71
    v_mfma_f32_16x16x32_bf16 v[116:119], v[60:63], v[228:231], v[116:119]
    ds_read_b128 v[56:59], v6 offset:22528
    buffer_load_dwordx4 v[128:131], v3, s[52:55], s88 offen offset:0 sc1
    v_add_f32 v69, 0x3727c5ac, v69
    s_waitcnt lgkmcnt(7)
    v_mfma_f32_16x16x32_bf16 v[120:123], v[16:19], v[228:231], v[120:123]
    ds_read_b128 v[60:63], v6 offset:23552
    v_cvt_pk_bf16_f32 v71, v69, v69
    v_mfma_f32_16x16x32_bf16 v[124:127], v[20:23], v[228:231], v[124:127]
    ds_read_b128 v[16:19], v6 offset:24576
    v_lshlrev_b32 v69, 16, v71
    v_mfma_f32_16x16x32_bf16 v[100:103], v[24:27], v[232:235], v[100:103]
    ds_read_b128 v[20:23], v6 offset:25600
    buffer_load_dwordx4 v[132:135], v3, s[52:55], s88 offen offset:1024 sc1
    v_sqrt_f32 v69, v69
    v_mfma_f32_16x16x32_bf16 v[104:107], v[28:31], v[232:235], v[104:107]
    ds_read_b128 v[24:27], v6 offset:26624
    s_nop 0
    s_waitcnt lgkmcnt(7)
    v_mfma_f32_16x16x32_bf16 v[108:111], v[32:35], v[232:235], v[108:111]
    ds_read_b128 v[28:31], v6 offset:27648
    v_cvt_pk_bf16_f32 v71, v69, v69
    v_mfma_f32_16x16x32_bf16 v[112:115], v[36:39], v[232:235], v[112:115]
    ds_read_b128 v[32:35], v6 offset:28672
    buffer_load_dwordx4 v[136:139], v3, s[52:55], s88 offen offset:2048 sc1
    v_lshlrev_b32 v70, 16, v71
    v_mfma_f32_16x16x32_bf16 v[116:119], v[40:43], v[232:235], v[116:119]
    ds_read_b128 v[36:39], v6 offset:29696
    v_rcp_f32 v69, v70
    v_mfma_f32_16x16x32_bf16 v[120:123], v[44:47], v[232:235], v[120:123]
    ds_read_b128 v[40:43], v6 offset:30720
    s_nop 0
    s_waitcnt lgkmcnt(7)
    v_mfma_f32_16x16x32_bf16 v[124:127], v[48:51], v[232:235], v[124:127]
    ds_read_b128 v[44:47], v6 offset:31744
    buffer_load_dwordx4 v[140:143], v3, s[52:55], s88 offen offset:3072 sc1
    v_cvt_pk_bf16_f32 v66, -v68, -v68
    v_mfma_f32_16x16x32_bf16 v[100:103], v[52:55], v[236:239], v[100:103]
    ds_read_b128 v[48:51], v6 offset:32768
    v_cvt_pk_bf16_f32 v67, -v68, v70
    v_mfma_f32_16x16x32_bf16 v[104:107], v[56:59], v[236:239], v[104:107]
    ds_read_b128 v[52:55], v6 offset:33792
    v_mul_f32 v69, v69, v69
    v_mfma_f32_16x16x32_bf16 v[108:111], v[60:63], v[236:239], v[108:111]
    ds_read_b128 v[56:59], v6 offset:34816
    buffer_load_dwordx4 v[144:147], v3, s[52:55], s89 offen offset:0 sc1
    v_cndmask_b32 v66, 0, v66, s[34:35]
    s_waitcnt lgkmcnt(7)
    v_mfma_f32_16x16x32_bf16 v[112:115], v[16:19], v[236:239], v[112:115]
    ds_read_b128 v[60:63], v6 offset:35840
    v_cndmask_b32 v67, 0, v67, s[34:35]
    v_mfma_f32_16x16x32_bf16 v[116:119], v[20:23], v[236:239], v[116:119]
    ds_read_b128 v[16:19], v6 offset:36864
    buffer_store_dword v69, v8, s[52:55], s13 offen offset:64 sc0 sc1
    v_mfma_f32_16x16x32_bf16 v[120:123], v[24:27], v[236:239], v[120:123]
    ds_read_b128 v[20:23], v6 offset:37888
    buffer_load_dwordx4 v[148:151], v3, s[52:55], s89 offen offset:1024 sc1
    v_mfma_f32_16x16x32_bf16 v[124:127], v[28:31], v[236:239], v[124:127]
    ds_read_b128 v[24:27], v6 offset:38912
    s_waitcnt lgkmcnt(7)
    v_mfma_f32_16x16x32_bf16 v[100:103], v[32:35], v[240:243], v[100:103]
    ds_read_b128 v[28:31], v6 offset:39936
    v_mfma_f32_16x16x32_bf16 v[104:107], v[36:39], v[240:243], v[104:107]
    ds_read_b128 v[32:35], v6 offset:40960
    buffer_load_dwordx4 v[152:155], v3, s[52:55], s89 offen offset:2048 sc1
    v_mfma_f32_16x16x32_bf16 v[108:111], v[40:43], v[240:243], v[108:111]
    ds_read_b128 v[36:39], v6 offset:41984
    v_mfma_f32_16x16x32_bf16 v[112:115], v[44:47], v[240:243], v[112:115]
    ds_read_b128 v[40:43], v6 offset:43008
    s_waitcnt lgkmcnt(7)
    v_mfma_f32_16x16x32_bf16 v[116:119], v[48:51], v[240:243], v[116:119]
    ds_read_b128 v[44:47], v6 offset:44032
    buffer_load_dwordx4 v[156:159], v3, s[52:55], s89 offen offset:3072 sc1
    v_mfma_f32_16x16x32_bf16 v[120:123], v[52:55], v[240:243], v[120:123]
    ds_read_b128 v[48:51], v6 offset:45056
    v_mfma_f32_16x16x32_bf16 v[124:127], v[56:59], v[240:243], v[124:127]
    ds_read_b128 v[52:55], v6 offset:46080
    v_mfma_f32_16x16x32_bf16 v[100:103], v[60:63], v[244:247], v[100:103]
    ds_read_b128 v[56:59], v6 offset:47104
    buffer_load_dwordx4 v[160:163], v3, s[52:55], s90 offen offset:0 sc1
    s_waitcnt lgkmcnt(7)
    v_mfma_f32_16x16x32_bf16 v[104:107], v[16:19], v[244:247], v[104:107]
    ds_read_b128 v[60:63], v6 offset:48128
    v_mfma_f32_16x16x32_bf16 v[108:111], v[20:23], v[244:247], v[108:111]
    ds_read_b128 v[16:19], v6 offset:49152
    v_mfma_f32_16x16x32_bf16 v[112:115], v[24:27], v[244:247], v[112:115]
    ds_read_b128 v[20:23], v6 offset:50176
    buffer_load_dwordx4 v[164:167], v3, s[52:55], s90 offen offset:1024 sc1
    v_mfma_f32_16x16x32_bf16 v[116:119], v[28:31], v[244:247], v[116:119]
    ds_read_b128 v[24:27], v6 offset:51200
    s_waitcnt lgkmcnt(7)
    v_mfma_f32_16x16x32_bf16 v[120:123], v[32:35], v[244:247], v[120:123]
    ds_read_b128 v[28:31], v6 offset:52224
    v_mfma_f32_16x16x32_bf16 v[124:127], v[36:39], v[244:247], v[124:127]
    ds_read_b128 v[32:35], v6 offset:53248
    buffer_load_dwordx4 v[168:171], v3, s[52:55], s90 offen offset:2048 sc1
    v_mfma_f32_16x16x32_bf16 v[100:103], v[40:43], v[248:251], v[100:103]
    ds_read_b128 v[36:39], v6 offset:54272
    v_mfma_f32_16x16x32_bf16 v[104:107], v[44:47], v[248:251], v[104:107]
    ds_read_b128 v[40:43], v6 offset:55296
    s_waitcnt lgkmcnt(7)
    v_mfma_f32_16x16x32_bf16 v[108:111], v[48:51], v[248:251], v[108:111]
    ds_read_b128 v[44:47], v6 offset:56320
    buffer_load_dwordx4 v[172:175], v3, s[52:55], s90 offen offset:3072 sc1
    v_mfma_f32_16x16x32_bf16 v[112:115], v[52:55], v[248:251], v[112:115]
    v_mfma_f32_16x16x32_bf16 v[116:119], v[56:59], v[248:251], v[116:119]
    v_mfma_f32_16x16x32_bf16 v[120:123], v[60:63], v[248:251], v[120:123]
    buffer_load_dwordx4 v[176:179], v3, s[52:55], s91 offen offset:0 sc1
    s_waitcnt lgkmcnt(4)
    v_mfma_f32_16x16x32_bf16 v[124:127], v[16:19], v[248:251], v[124:127]
    v_mfma_f32_16x16x32_bf16 v[100:103], v[20:23], v[252:255], v[100:103]
    v_mfma_f32_16x16x32_bf16 v[104:107], v[24:27], v[252:255], v[104:107]
    buffer_load_dwordx4 v[180:183], v3, s[52:55], s91 offen offset:1024 sc1
    v_mfma_f32_16x16x32_bf16 v[108:111], v[28:31], v[252:255], v[108:111]
    s_waitcnt lgkmcnt(0)
    v_mfma_f32_16x16x32_bf16 v[112:115], v[32:35], v[252:255], v[112:115]
    v_mfma_f32_16x16x32_bf16 v[116:119], v[36:39], v[252:255], v[116:119]
    buffer_load_dwordx4 v[184:187], v3, s[52:55], s91 offen offset:2048 sc1
    v_mfma_f32_16x16x32_bf16 v[120:123], v[40:43], v[252:255], v[120:123]
    v_mfma_f32_16x16x32_bf16 v[124:127], v[44:47], v[252:255], v[124:127]
    buffer_load_dwordx4 v[188:191], v3, s[52:55], s91 offen offset:3072 sc1
    s_nop 1
    v_mfma_f32_16x16x16_bf16 v[100:103], a[240:241], v[66:67], v[100:103]
    v_mfma_f32_16x16x16_bf16 v[104:107], a[242:243], v[66:67], v[104:107]
    v_mfma_f32_16x16x16_bf16 v[108:111], a[244:245], v[66:67], v[108:111]
    v_mfma_f32_16x16x16_bf16 v[112:115], a[246:247], v[66:67], v[112:115]
    v_mfma_f32_16x16x16_bf16 v[116:119], a[248:249], v[66:67], v[116:119]
    v_mfma_f32_16x16x16_bf16 v[120:123], a[250:251], v[66:67], v[120:123]
    v_mfma_f32_16x16x16_bf16 v[124:127], a[252:253], v[66:67], v[124:127]
    s_waitcnt vmcnt(16)
    v_mfma_f32_32x32x16_bf16 v[192:207], a[0:3], v[128:131], 0
    v_and_b32 v90, 0x70, v3
    s_lshl_b32 s26, s20, 7
    buffer_load_dwordx4 v[96:99], v90, s[60:63], s26 offen
    v_lshrrev_b32 v91, 7, v3
    v_lshlrev_b32 v91, 2, v91
    buffer_load_dword v88, v91, s[52:55], s43 offen offset:0 sc1
    v_mfma_f32_32x32x16_bf16 v[208:223], a[4:7], v[128:131], 0
    v_mul_f32 v100, v100, abs(v100)
    v_mul_f32 v101, v101, abs(v101)
    v_mul_f32 v102, v102, abs(v102)
    v_mul_f32 v103, v103, abs(v103)
    v_mul_f32 v104, v104, abs(v104)
    v_mul_f32 v105, v105, abs(v105)
    s_waitcnt vmcnt(17)
    v_mfma_f32_32x32x16_bf16 v[192:207], a[8:11], v[132:135], v[192:207]
    v_mul_f32 v106, v106, abs(v106)
    v_mul_f32 v107, v107, abs(v107)
    v_cvt_pk_bf16_f32 v100, v100, v101
    v_cvt_pk_bf16_f32 v101, v102, v103
    v_cvt_pk_bf16_f32 v102, v104, v105
    v_cvt_pk_bf16_f32 v103, v106, v107
    v_mfma_f32_32x32x16_bf16 v[208:223], a[12:15], v[132:135], v[208:223]
    v_pk_max_i16 v100, v100, 0
    v_pk_max_i16 v101, v101, 0
    v_pk_max_i16 v102, v102, 0
    v_pk_max_i16 v103, v103, 0
    buffer_store_dwordx4 v[100:103], v0, s[52:55], s4 offen offset:0 sc0 sc1
    v_mul_f32 v108, v108, abs(v108)
    s_waitcnt vmcnt(17)
    v_mfma_f32_32x32x16_bf16 v[192:207], a[16:19], v[136:139], v[192:207]
    v_mul_f32 v109, v109, abs(v109)
    v_mul_f32 v110, v110, abs(v110)
    v_mul_f32 v111, v111, abs(v111)
    v_mul_f32 v112, v112, abs(v112)
    v_mul_f32 v113, v113, abs(v113)
    v_mul_f32 v114, v114, abs(v114)
    v_mfma_f32_32x32x16_bf16 v[208:223], a[20:23], v[136:139], v[208:223]
    v_mul_f32 v115, v115, abs(v115)
    v_cvt_pk_bf16_f32 v108, v108, v109
    v_cvt_pk_bf16_f32 v109, v110, v111
    v_cvt_pk_bf16_f32 v110, v112, v113
    v_cvt_pk_bf16_f32 v111, v114, v115
    v_pk_max_i16 v108, v108, 0
    s_waitcnt vmcnt(16)
    v_mfma_f32_32x32x16_bf16 v[192:207], a[24:27], v[140:143], v[192:207]
    v_pk_max_i16 v109, v109, 0
    v_pk_max_i16 v110, v110, 0
    v_pk_max_i16 v111, v111, 0
    buffer_store_dwordx4 v[108:111], v0, s[52:55], s4 offen offset:2048 sc0 sc1
    v_mul_f32 v116, v116, abs(v116)
    v_mul_f32 v117, v117, abs(v117)
    v_mfma_f32_32x32x16_bf16 v[208:223], a[28:31], v[140:143], v[208:223]
    v_mul_f32 v118, v118, abs(v118)
    v_mul_f32 v119, v119, abs(v119)
    v_mul_f32 v120, v120, abs(v120)
    v_mul_f32 v121, v121, abs(v121)
    v_mul_f32 v122, v122, abs(v122)
    v_mul_f32 v123, v123, abs(v123)
    s_waitcnt vmcnt(16)
    v_mfma_f32_32x32x16_bf16 v[192:207], a[32:35], v[144:147], v[192:207]
    v_cvt_pk_bf16_f32 v116, v116, v117
    v_cvt_pk_bf16_f32 v117, v118, v119
    v_cvt_pk_bf16_f32 v118, v120, v121
    v_cvt_pk_bf16_f32 v119, v122, v123
    v_pk_max_i16 v116, v116, 0
    v_pk_max_i16 v117, v117, 0
    v_mfma_f32_32x32x16_bf16 v[208:223], a[36:39], v[144:147], v[208:223]
    v_pk_max_i16 v118, v118, 0
    v_pk_max_i16 v119, v119, 0
    buffer_store_dwordx4 v[116:119], v0, s[52:55], s5 offen offset:0 sc0 sc1
    v_mul_f32 v124, v124, abs(v124)
    v_mul_f32 v125, v125, abs(v125)
    v_mul_f32 v126, v126, abs(v126)
    s_waitcnt vmcnt(15)
    v_mfma_f32_32x32x16_bf16 v[192:207], a[40:43], v[148:151], v[192:207]
    v_mul_f32 v127, v127, abs(v127)
    v_cvt_pk_bf16_f32 v124, v124, v125
    v_cvt_pk_bf16_f32 v125, v126, v127
    v_pk_max_i16 v124, v124, 0
    v_pk_max_i16 v125, v125, 0
    buffer_store_dwordx2 v[124:125], v1, s[52:55], s5 offen offset:2048 sc0 sc1
    v_mfma_f32_32x32x16_bf16 v[208:223], a[44:47], v[148:151], v[208:223]
    v_and_b32 v118, 0x70, v3
    s_lshl_b32 s26, s20, 7
    buffer_load_dwordx4 v[124:127], v118, s[60:63], s26 offen
    s_waitcnt vmcnt(16)
    v_mfma_f32_32x32x16_bf16 v[192:207], a[48:51], v[152:155], v[192:207]
    v_mfma_f32_32x32x16_bf16 v[208:223], a[52:55], v[152:155], v[208:223]
    buffer_load_dwordx4 v[16:19], v3, s[52:55], s92 offen offset:0 sc1
    s_waitcnt vmcnt(16)
    v_mfma_f32_32x32x16_bf16 v[192:207], a[56:59], v[156:159], v[192:207]
    v_mfma_f32_32x32x16_bf16 v[208:223], a[60:63], v[156:159], v[208:223]
    buffer_load_dwordx4 v[20:23], v3, s[52:55], s92 offen offset:1024 sc1
    s_waitcnt vmcnt(16)
    v_mfma_f32_32x32x16_bf16 v[192:207], a[64:67], v[160:163], v[192:207]
    v_mfma_f32_32x32x16_bf16 v[208:223], a[68:71], v[160:163], v[208:223]
    buffer_load_dwordx4 v[24:27], v3, s[52:55], s92 offen offset:2048 sc1
    s_waitcnt vmcnt(16)
    v_mfma_f32_32x32x16_bf16 v[192:207], a[72:75], v[164:167], v[192:207]
    v_mfma_f32_32x32x16_bf16 v[208:223], a[76:79], v[164:167], v[208:223]
    buffer_load_dwordx4 v[28:31], v3, s[52:55], s92 offen offset:3072 sc1
    s_waitcnt vmcnt(16)
    v_mfma_f32_32x32x16_bf16 v[192:207], a[80:83], v[168:171], v[192:207]
    v_mfma_f32_32x32x16_bf16 v[208:223], a[84:87], v[168:171], v[208:223]
    buffer_load_dwordx4 v[32:35], v3, s[52:55], s93 offen offset:0 sc1
    s_waitcnt vmcnt(16)
    v_mfma_f32_32x32x16_bf16 v[192:207], a[88:91], v[172:175], v[192:207]
    v_mfma_f32_32x32x16_bf16 v[208:223], a[92:95], v[172:175], v[208:223]
    buffer_load_dwordx4 v[36:39], v3, s[52:55], s93 offen offset:1024 sc1
    v_mov_b32 v7, 2
    s_waitcnt vmcnt(7)
    buffer_store_dword v7, v9, s[52:55], s74 offen offset:256 sc0 sc1
    v_mfma_f32_32x32x16_bf16 v[192:207], a[96:99], v[176:179], v[192:207]
    v_mfma_f32_32x32x16_bf16 v[208:223], a[100:103], v[176:179], v[208:223]
    buffer_load_dwordx4 v[40:43], v3, s[52:55], s93 offen offset:2048 sc1
    v_mfma_f32_32x32x16_bf16 v[192:207], a[104:107], v[180:183], v[192:207]
    v_mfma_f32_32x32x16_bf16 v[208:223], a[108:111], v[180:183], v[208:223]
    buffer_load_dwordx4 v[44:47], v3, s[52:55], s93 offen offset:3072 sc1
    v_mfma_f32_32x32x16_bf16 v[192:207], a[112:115], v[184:187], v[192:207]
    v_mfma_f32_32x32x16_bf16 v[208:223], a[116:119], v[184:187], v[208:223]
    buffer_load_dwordx4 v[48:51], v3, s[52:55], s94 offen offset:0 sc1
    v_accvgpr_read_b32 v92, a224
    v_lshlrev_b32 v93, 16, v96
    v_and_b32 v94, 0xffff0000, v96
    v_lshlrev_b32 v72, 16, v92
    v_and_b32 v73, 0xffff0000, v92
    v_mfma_f32_32x32x16_bf16 v[192:207], a[120:123], v[188:191], v[192:207]
    v_add_f32 v72, v72, v93
    v_add_f32 v73, v73, v94
    v_accvgpr_read_b32 v92, a225
    v_lshlrev_b32 v93, 16, v97
    v_and_b32 v94, 0xffff0000, v97
    v_lshlrev_b32 v74, 16, v92
    v_mfma_f32_32x32x16_bf16 v[208:223], a[124:127], v[188:191], v[208:223]
    buffer_load_dwordx4 v[52:55], v3, s[52:55], s94 offen offset:1024 sc1
    v_and_b32 v75, 0xffff0000, v92
    v_add_f32 v74, v74, v93
    v_add_f32 v75, v75, v94
    v_accvgpr_read_b32 v92, a226
    v_lshlrev_b32 v93, 16, v98
    s_waitcnt vmcnt(10)
    v_mfma_f32_32x32x16_bf16 v[192:207], a[128:131], v[16:19], v[192:207]
    v_and_b32 v94, 0xffff0000, v98
    v_lshlrev_b32 v76, 16, v92
    v_and_b32 v77, 0xffff0000, v92
    v_add_f32 v76, v76, v93
    v_add_f32 v77, v77, v94
    v_accvgpr_read_b32 v92, a227
    v_mfma_f32_32x32x16_bf16 v[208:223], a[132:135], v[16:19], v[208:223]
    buffer_load_dwordx4 v[56:59], v3, s[52:55], s94 offen offset:2048 sc1
    v_lshlrev_b32 v93, 16, v99
    v_and_b32 v94, 0xffff0000, v99
    v_lshlrev_b32 v78, 16, v92
    v_and_b32 v79, 0xffff0000, v92
    v_add_f32 v78, v78, v93
    s_waitcnt vmcnt(10)
    v_mfma_f32_32x32x16_bf16 v[192:207], a[136:139], v[20:23], v[192:207]
    buffer_load_dword v14, v13, s[52:55], s75 offen offset:256 sc1
    v_add_f32 v79, v79, v94
    v_accvgpr_read_b32 v120, a228
    v_lshlrev_b32 v121, 16, v124
    v_and_b32 v122, 0xffff0000, v124
    v_lshlrev_b32 v100, 16, v120
    v_mfma_f32_32x32x16_bf16 v[208:223], a[140:143], v[20:23], v[208:223]
    buffer_load_dwordx4 v[60:63], v3, s[52:55], s94 offen offset:3072 sc1
    v_and_b32 v101, 0xffff0000, v120
    v_add_f32 v100, v100, v121
    v_add_f32 v101, v101, v122
    v_accvgpr_read_b32 v120, a229
    v_lshlrev_b32 v121, 16, v125
    s_waitcnt vmcnt(11)
    v_mfma_f32_32x32x16_bf16 v[192:207], a[144:147], v[24:27], v[192:207]
    v_and_b32 v122, 0xffff0000, v125
    v_lshlrev_b32 v102, 16, v120
    v_and_b32 v103, 0xffff0000, v120
    v_add_f32 v102, v102, v121
    v_add_f32 v103, v103, v122
    v_accvgpr_read_b32 v120, a230
    v_mfma_f32_32x32x16_bf16 v[208:223], a[148:151], v[24:27], v[208:223]
    v_lshlrev_b32 v121, 16, v126
    v_and_b32 v122, 0xffff0000, v126
    v_lshlrev_b32 v104, 16, v120
    v_and_b32 v105, 0xffff0000, v120
    v_add_f32 v104, v104, v121
    v_add_f32 v105, v105, v122
    s_waitcnt vmcnt(10)
    v_mfma_f32_32x32x16_bf16 v[192:207], a[152:155], v[28:31], v[192:207]
    v_accvgpr_read_b32 v120, a231
    v_lshlrev_b32 v121, 16, v127
    v_and_b32 v122, 0xffff0000, v127
    v_lshlrev_b32 v106, 16, v120
    v_and_b32 v107, 0xffff0000, v120
    v_add_f32 v106, v106, v121
    v_mfma_f32_32x32x16_bf16 v[208:223], a[156:159], v[28:31], v[208:223]
    v_add_f32 v107, v107, v122
    s_waitcnt vmcnt(9)
    v_mfma_f32_32x32x16_bf16 v[192:207], a[160:163], v[32:35], v[192:207]
    v_mfma_f32_32x32x16_bf16 v[208:223], a[164:167], v[32:35], v[208:223]
    s_waitcnt vmcnt(8)
    v_mfma_f32_32x32x16_bf16 v[192:207], a[168:171], v[36:39], v[192:207]
    v_mfma_f32_32x32x16_bf16 v[208:223], a[172:175], v[36:39], v[208:223]
    s_waitcnt vmcnt(6)
    v_mfma_f32_32x32x16_bf16 v[192:207], a[176:179], v[40:43], v[192:207]
    s_waitcnt vmcnt(1)
    v_cmp_gt_u32 vcc, 2, v14
    s_cbranch_vccnz FWAIT_116
FOK_115:
    buffer_load_dwordx4 v[16:19], v3, s[52:55], s95 offen offset:0 sc1
    v_mfma_f32_32x32x16_bf16 v[208:223], a[180:183], v[40:43], v[208:223]
    buffer_load_dwordx4 v[20:23], v3, s[52:55], s95 offen offset:1024 sc1
    v_mfma_f32_32x32x16_bf16 v[192:207], a[184:187], v[44:47], v[192:207]
    buffer_load_dwordx4 v[24:27], v3, s[52:55], s95 offen offset:2048 sc1
    v_mfma_f32_32x32x16_bf16 v[208:223], a[188:191], v[44:47], v[208:223]
    buffer_load_dwordx4 v[28:31], v3, s[52:55], s95 offen offset:3072 sc1
    v_mfma_f32_32x32x16_bf16 v[192:207], a[192:195], v[48:51], v[192:207]
    buffer_load_dwordx4 v[32:35], v3, s[52:55], s96 offen offset:0 sc1
    v_mfma_f32_32x32x16_bf16 v[208:223], a[196:199], v[48:51], v[208:223]
    buffer_load_dwordx4 v[36:39], v3, s[52:55], s96 offen offset:1024 sc1
    v_mfma_f32_32x32x16_bf16 v[192:207], a[200:203], v[52:55], v[192:207]
    buffer_load_dwordx4 v[40:43], v3, s[52:55], s96 offen offset:2048 sc1
    v_mfma_f32_32x32x16_bf16 v[208:223], a[204:207], v[52:55], v[208:223]
    buffer_load_dwordx4 v[44:47], v3, s[52:55], s96 offen offset:3072 sc1
    v_mfma_f32_32x32x16_bf16 v[192:207], a[208:211], v[56:59], v[192:207]
    v_mfma_f32_32x32x16_bf16 v[208:223], a[212:215], v[56:59], v[208:223]
    buffer_load_dwordx4 v[48:51], v3, s[52:55], s97 offen offset:0 sc1
    s_waitcnt vmcnt(9)
    v_mfma_f32_32x32x16_bf16 v[192:207], a[216:219], v[60:63], v[192:207]
    v_mfma_f32_32x32x16_bf16 v[208:223], a[220:223], v[60:63], v[208:223]
    buffer_load_dwordx4 v[52:55], v3, s[52:55], s97 offen offset:1024 sc1
    s_waitcnt vmcnt(9)
    v_mfma_f32_32x32x16_bf16 v[224:239], a[0:3], v[16:19], 0
    v_lshrrev_b32 v119, 7, v3
    v_lshlrev_b32 v119, 2, v119
    buffer_load_dword v116, v119, s[52:55], s43 offen offset:64 sc1
    s_nop 1
    v_mfma_f32_32x32x16_bf16 v[240:255], a[4:7], v[16:19], 0
    buffer_load_dwordx4 v[56:59], v3, s[52:55], s97 offen offset:2048 sc1
    s_waitcnt vmcnt(10)
    v_mfma_f32_32x32x16_bf16 v[224:239], a[8:11], v[20:23], v[224:239]
    ds_write_b128 v2, v[192:195] offset:0
    v_mfma_f32_32x32x16_bf16 v[240:255], a[12:15], v[20:23], v[240:255]
    buffer_load_dwordx4 v[60:63], v3, s[52:55], s97 offen offset:3072 sc1
    ds_write_b128 v2, v[196:199] offset:4352
    s_waitcnt vmcnt(10)
    v_mfma_f32_32x32x16_bf16 v[224:239], a[16:19], v[24:27], v[224:239]
    ds_write_b128 v2, v[200:203] offset:1088
    v_mfma_f32_32x32x16_bf16 v[240:255], a[20:23], v[24:27], v[240:255]
    buffer_load_dwordx4 v[16:19], v3, s[52:55], s98 offen offset:0 sc1
    ds_write_b128 v2, v[204:207] offset:5440
    s_waitcnt vmcnt(10)
    v_mfma_f32_32x32x16_bf16 v[224:239], a[24:27], v[28:31], v[224:239]
    ds_write_b128 v2, v[208:211] offset:2176
    v_mfma_f32_32x32x16_bf16 v[240:255], a[28:31], v[28:31], v[240:255]
    buffer_load_dwordx4 v[20:23], v3, s[52:55], s98 offen offset:1024 sc1
    ds_write_b128 v2, v[212:215] offset:6528
    s_waitcnt vmcnt(10)
    v_mfma_f32_32x32x16_bf16 v[224:239], a[32:35], v[32:35], v[224:239]
    ds_write_b128 v2, v[216:219] offset:3264
    v_mfma_f32_32x32x16_bf16 v[240:255], a[36:39], v[32:35], v[240:255]
    buffer_load_dwordx4 v[24:27], v3, s[52:55], s98 offen offset:2048 sc1
    ds_write_b128 v2, v[220:223] offset:7616
    s_waitcnt vmcnt(10)
    v_mfma_f32_32x32x16_bf16 v[224:239], a[40:43], v[36:39], v[224:239]
    v_mfma_f32_32x32x16_bf16 v[240:255], a[44:47], v[36:39], v[240:255]
    buffer_load_dwordx4 v[28:31], v3, s[52:55], s98 offen offset:3072 sc1
    s_waitcnt vmcnt(10)
    v_mfma_f32_32x32x16_bf16 v[224:239], a[48:51], v[40:43], v[224:239]
    v_mfma_f32_32x32x16_bf16 v[240:255], a[52:55], v[40:43], v[240:255]
    buffer_load_dwordx4 v[32:35], v3, s[52:55], s99 offen offset:0 sc1
    s_waitcnt lgkmcnt(0)
    s_barrier
    ds_read_b128 v[160:163], v10 offset:0
    ds_read_b128 v[164:167], v10 offset:4352
    ds_read_b128 v[168:171], v10 offset:8704
    s_waitcnt vmcnt(10)
    v_mfma_f32_32x32x16_bf16 v[224:239], a[56:59], v[44:47], v[224:239]
    ds_read_b128 v[172:175], v10 offset:13056
    ds_read_b128 v[176:179], v10 offset:17408
    ds_read_b128 v[180:183], v10 offset:21760
    ds_read_b128 v[184:187], v10 offset:26112
    ds_read_b128 v[188:191], v10 offset:30464
    v_mfma_f32_32x32x16_bf16 v[240:255], a[60:63], v[44:47], v[240:255]
    buffer_load_dwordx4 v[36:39], v3, s[52:55], s99 offen offset:1024 sc1
    s_waitcnt vmcnt(10)
    v_mfma_f32_32x32x16_bf16 v[224:239], a[64:67], v[48:51], v[224:239]
    v_mfma_f32_32x32x16_bf16 v[240:255], a[68:71], v[48:51], v[240:255]
    buffer_load_dwordx4 v[40:43], v3, s[52:55], s99 offen offset:2048 sc1
    s_waitcnt lgkmcnt(4)
    v_add_f32 v160, v160, v168
    v_add_f32 v161, v161, v169
    v_add_f32 v162, v162, v170
    v_add_f32 v163, v163, v171
    s_waitcnt vmcnt(10)
    v_mfma_f32_32x32x16_bf16 v[224:239], a[72:75], v[52:55], v[224:239]
    v_add_f32 v164, v164, v172
    v_add_f32 v165, v165, v173
    v_add_f32 v166, v166, v174
    v_add_f32 v167, v167, v175
    s_waitcnt lgkmcnt(0)
    v_add_f32 v176, v176, v184
    v_mfma_f32_32x32x16_bf16 v[240:255], a[76:79], v[52:55], v[240:255]
    buffer_load_dwordx4 v[44:47], v3, s[52:55], s99 offen offset:3072 sc1
    v_add_f32 v177, v177, v185
    v_add_f32 v178, v178, v186
    v_add_f32 v179, v179, v187
    v_add_f32 v180, v180, v188
    v_add_f32 v181, v181, v189
    s_waitcnt vmcnt(9)
    v_mfma_f32_32x32x16_bf16 v[224:239], a[80:83], v[56:59], v[224:239]
    v_add_f32 v182, v182, v190
    v_add_f32 v183, v183, v191
    v_add_f32 v160, v160, v176
    v_add_f32 v161, v161, v177
    v_add_f32 v162, v162, v178
    v_add_f32 v163, v163, v179
    v_mfma_f32_32x32x16_bf16 v[240:255], a[84:87], v[56:59], v[240:255]
    buffer_load_dwordx4 v[48:51], v3, s[52:55], s100 offen offset:0 sc1
    v_add_f32 v164, v164, v180
    v_add_f32 v165, v165, v181
    v_add_f32 v166, v166, v182
    v_add_f32 v167, v167, v183
    v_fmac_f32 v72, v160, v88
    s_waitcnt vmcnt(9)
    v_mfma_f32_32x32x16_bf16 v[224:239], a[88:91], v[60:63], v[224:239]
    v_fmac_f32 v73, v161, v88
    v_fmac_f32 v74, v162, v88
    v_fmac_f32 v75, v163, v88
    v_fmac_f32 v76, v164, v88
    v_fmac_f32 v77, v165, v88
    v_fmac_f32 v78, v166, v88
    v_mfma_f32_32x32x16_bf16 v[240:255], a[92:95], v[60:63], v[240:255]
    buffer_load_dwordx4 v[52:55], v3, s[52:55], s100 offen offset:1024 sc1
    v_fmac_f32 v79, v167, v88
    v_cvt_pk_bf16_f32 v96, v72, v73
    v_cvt_pk_bf16_f32 v97, v74, v75
    v_cvt_pk_bf16_f32 v98, v76, v77
    v_cvt_pk_bf16_f32 v99, v78, v79
    s_waitcnt vmcnt(9)
    v_mfma_f32_32x32x16_bf16 v[224:239], a[96:99], v[16:19], v[224:239]
    buffer_store_dwordx4 v[96:99], v12, s[56:59], s47 offen offset:0
    v_mfma_f32_32x32x16_bf16 v[240:255], a[100:103], v[16:19], v[240:255]
    buffer_load_dwordx4 v[56:59], v3, s[52:55], s100 offen offset:2048 sc1
    s_waitcnt vmcnt(10)
    v_mfma_f32_32x32x16_bf16 v[224:239], a[104:107], v[20:23], v[224:239]
    v_mfma_f32_32x32x16_bf16 v[240:255], a[108:111], v[20:23], v[240:255]
    buffer_load_dwordx4 v[60:63], v3, s[52:55], s100 offen offset:3072 sc1
    s_waitcnt vmcnt(10)
    v_mfma_f32_32x32x16_bf16 v[224:239], a[112:115], v[24:27], v[224:239]
    s_barrier
    v_mfma_f32_32x32x16_bf16 v[240:255], a[116:119], v[24:27], v[240:255]
    buffer_load_dwordx4 v[16:19], v3, s[52:55], s101 offen offset:0 sc1
    s_waitcnt vmcnt(10)
    v_mfma_f32_32x32x16_bf16 v[224:239], a[120:123], v[28:31], v[224:239]
    v_mfma_f32_32x32x16_bf16 v[240:255], a[124:127], v[28:31], v[240:255]
    buffer_load_dwordx4 v[20:23], v3, s[52:55], s101 offen offset:1024 sc1
    s_waitcnt vmcnt(10)
    v_mfma_f32_32x32x16_bf16 v[224:239], a[128:131], v[32:35], v[224:239]
    v_mfma_f32_32x32x16_bf16 v[240:255], a[132:135], v[32:35], v[240:255]
    buffer_load_dwordx4 v[24:27], v3, s[52:55], s101 offen offset:2048 sc1
    s_waitcnt vmcnt(10)
    v_mfma_f32_32x32x16_bf16 v[224:239], a[136:139], v[36:39], v[224:239]
    v_mfma_f32_32x32x16_bf16 v[240:255], a[140:143], v[36:39], v[240:255]
    buffer_load_dwordx4 v[28:31], v3, s[52:55], s101 offen offset:3072 sc1
    s_waitcnt vmcnt(10)
    v_mfma_f32_32x32x16_bf16 v[224:239], a[144:147], v[40:43], v[224:239]
    v_mfma_f32_32x32x16_bf16 v[240:255], a[148:151], v[40:43], v[240:255]
    s_waitcnt vmcnt(9)
    v_mfma_f32_32x32x16_bf16 v[224:239], a[152:155], v[44:47], v[224:239]
    v_mfma_f32_32x32x16_bf16 v[240:255], a[156:159], v[44:47], v[240:255]
    s_waitcnt vmcnt(8)
    v_mfma_f32_32x32x16_bf16 v[224:239], a[160:163], v[48:51], v[224:239]
    v_mfma_f32_32x32x16_bf16 v[240:255], a[164:167], v[48:51], v[240:255]
    s_waitcnt vmcnt(7)
    v_mfma_f32_32x32x16_bf16 v[224:239], a[168:171], v[52:55], v[224:239]
    v_mfma_f32_32x32x16_bf16 v[240:255], a[172:175], v[52:55], v[240:255]
    s_waitcnt vmcnt(5)
    v_mfma_f32_32x32x16_bf16 v[224:239], a[176:179], v[56:59], v[224:239]
    v_mfma_f32_32x32x16_bf16 v[240:255], a[180:183], v[56:59], v[240:255]
    s_waitcnt vmcnt(4)
    v_mfma_f32_32x32x16_bf16 v[224:239], a[184:187], v[60:63], v[224:239]
    v_mfma_f32_32x32x16_bf16 v[240:255], a[188:191], v[60:63], v[240:255]
    s_waitcnt vmcnt(3)
    v_mfma_f32_32x32x16_bf16 v[224:239], a[192:195], v[16:19], v[224:239]
    s_waitcnt vmcnt(2)
    v_mfma_f32_32x32x16_bf16 v[224:239], a[200:203], v[20:23], v[224:239]
    s_waitcnt vmcnt(1)
    v_mfma_f32_32x32x16_bf16 v[224:239], a[208:211], v[24:27], v[224:239]
    s_waitcnt vmcnt(0)
    v_mfma_f32_32x32x16_bf16 v[224:239], a[216:219], v[28:31], v[224:239]
    v_mfma_f32_32x32x16_bf16 v[240:255], a[196:199], v[16:19], v[240:255]
    s_nop 4
    v_mfma_f32_32x32x16_bf16 v[240:255], a[204:207], v[20:23], v[240:255]
    s_nop 4
    v_mfma_f32_32x32x16_bf16 v[240:255], a[212:215], v[24:27], v[240:255]
    ds_write_b128 v2, v[224:227] offset:0
    ds_write_b128 v2, v[228:231] offset:4352
    v_mfma_f32_32x32x16_bf16 v[240:255], a[220:223], v[28:31], v[240:255]
    ds_write_b128 v2, v[232:235] offset:1088
    ds_write_b128 v2, v[236:239] offset:5440
    s_nop 9
    ds_write_b128 v2, v[240:243] offset:2176
    ds_write_b128 v2, v[244:247] offset:6528
    ds_write_b128 v2, v[248:251] offset:3264
    ds_write_b128 v2, v[252:255] offset:7616
    s_waitcnt lgkmcnt(0)
    s_barrier
    ds_read_b128 v[16:19], v10 offset:0
    ds_read_b128 v[20:23], v10 offset:4352
    ds_read_b128 v[24:27], v10 offset:8704
    ds_read_b128 v[28:31], v10 offset:13056
    ds_read_b128 v[32:35], v10 offset:17408
    ds_read_b128 v[36:39], v10 offset:21760
    ds_read_b128 v[40:43], v10 offset:26112
    ds_read_b128 v[44:47], v10 offset:30464
    s_waitcnt lgkmcnt(4)
    v_pk_add_f32 v[16:17], v[16:17], v[24:25]
    v_pk_add_f32 v[18:19], v[18:19], v[26:27]
    v_pk_add_f32 v[20:21], v[20:21], v[28:29]
    v_pk_add_f32 v[22:23], v[22:23], v[30:31]
    s_waitcnt lgkmcnt(0)
    v_pk_add_f32 v[32:33], v[32:33], v[40:41]
    v_pk_add_f32 v[34:35], v[34:35], v[42:43]
    v_pk_add_f32 v[36:37], v[36:37], v[44:45]
    v_pk_add_f32 v[38:39], v[38:39], v[46:47]
    v_pk_add_f32 v[16:17], v[16:17], v[32:33]
    v_pk_add_f32 v[18:19], v[18:19], v[34:35]
    v_pk_add_f32 v[20:21], v[20:21], v[36:37]
    v_pk_add_f32 v[22:23], v[22:23], v[38:39]
    v_pk_fma_f32 v[100:101], v[16:17], v[116:117], v[100:101] op_sel_hi:[1,0,1]
    v_pk_fma_f32 v[102:103], v[18:19], v[116:117], v[102:103] op_sel_hi:[1,0,1]
    v_pk_fma_f32 v[104:105], v[20:21], v[116:117], v[104:105] op_sel_hi:[1,0,1]
    v_pk_fma_f32 v[106:107], v[22:23], v[116:117], v[106:107] op_sel_hi:[1,0,1]
    v_cvt_pk_bf16_f32 v124, v100, v101
    v_cvt_pk_bf16_f32 v125, v102, v103
    v_cvt_pk_bf16_f32 v126, v104, v105
    v_cvt_pk_bf16_f32 v127, v106, v107
    buffer_store_dwordx4 v[124:127], v12, s[56:59], s47 offen offset:1024
    s_endpgm
FWAIT_85:
    s_mov_b32 s40, 200000
POLL_117:
    buffer_load_dword v14, v13, s[52:55], s69 offen offset:512 sc1
    s_sub_u32 s40, s40, 1
    s_cbranch_scc1 POLLX_118
    s_waitcnt vmcnt(0)
    v_cmp_gt_u32 vcc, 2, v14
    s_cbranch_vccnz POLL_117
POLLX_118:
    s_waitcnt vmcnt(0)
    s_branch FOK_84
SWAIT_88:
    s_mov_b32 s40, 200000
SX_89:
    buffer_load_dwordx4 v[68:71], v4, s[52:55], s8 offen offset:0 sc1
    s_waitcnt vmcnt(0)
    s_sub_u32 s40, s40, 1
    s_cbranch_scc1 SOK_87
    v_or_b32 v64, v69, v71
    v_cmp_gt_i32 vcc, 0, v64
    s_cbranch_vccnz SX_89
    s_branch SOK_87
SWAIT_91:
    s_mov_b32 s40, 200000
SX_92:
    buffer_load_dwordx4 v[68:71], v4, s[52:55], s8 offen offset:1024 sc1
    s_waitcnt vmcnt(0)
    s_sub_u32 s40, s40, 1
    s_cbranch_scc1 SOK_90
    v_or_b32 v66, v69, v71
    v_cmp_gt_i32 vcc, 0, v66
    s_cbranch_vccnz SX_92
    s_branch SOK_90
FWAIT_94:
    s_mov_b32 s40, 200000
POLL_119:
    buffer_load_dword v14, v13, s[52:55], s75 offen offset:0 sc1
    s_sub_u32 s40, s40, 1
    s_cbranch_scc1 POLLX_120
    s_waitcnt vmcnt(0)
    v_cmp_gt_u32 vcc, 1, v14
    s_cbranch_vccnz POLL_119
POLLX_120:
    s_waitcnt vmcnt(0)
    s_branch FOK_93
FWAIT_96:
    s_mov_b32 s40, 200000
POLL_121:
    buffer_load_dword v14, v13, s[52:55], s75 offen offset:0 sc1
    s_sub_u32 s40, s40, 1
    s_cbranch_scc1 POLLX_122
    s_waitcnt vmcnt(0)
    v_cmp_gt_u32 vcc, 2, v14
    s_cbranch_vccnz POLL_121
POLLX_122:
    s_waitcnt vmcnt(0)
    s_branch FOK_95
SWAIT_98:
    s_mov_b32 s40, 200000
SX_99:
    buffer_load_dwordx2 v[92:93], v5, s[52:55], s7 offen offset:0 sc1
    s_waitcnt vmcnt(0)
    s_sub_u32 s40, s40, 1
    s_cbranch_scc1 SOK_97
    v_cmp_gt_i32 vcc, 0, v93
    s_cbranch_vccnz SX_99
    s_branch SOK_97
FWAIT_101:
    s_mov_b32 s40, 200000
POLL_123:
    buffer_load_dword v14, v13, s[52:55], s69 offen offset:512 sc1
    s_sub_u32 s40, s40, 1
    s_cbranch_scc1 POLLX_124
    s_waitcnt vmcnt(0)
    v_cmp_gt_u32 vcc, 3, v14
    s_cbranch_vccnz POLL_123
POLLX_124:
    s_waitcnt vmcnt(0)
    s_branch FOK_100
SWAIT_103:
    s_mov_b32 s40, 200000
SX_104:
    buffer_load_dwordx2 v[120:121], v5, s[52:55], s7 offen offset:1024 sc1
    s_waitcnt vmcnt(0)
    s_sub_u32 s40, s40, 1
    s_cbranch_scc1 SOK_102
    v_cmp_gt_i32 vcc, 0, v121
    s_cbranch_vccnz SX_104
    s_branch SOK_102
FWAIT_106:
    s_mov_b32 s40, 200000
POLL_125:
    buffer_load_dword v14, v13, s[52:55], s69 offen offset:512 sc1
    s_sub_u32 s40, s40, 1
    s_cbranch_scc1 POLLX_126
    s_waitcnt vmcnt(0)
    v_cmp_gt_u32 vcc, 4, v14
    s_cbranch_vccnz POLL_125
POLLX_126:
    s_waitcnt vmcnt(0)
    s_branch FOK_105
SWAIT_108:
    s_mov_b32 s40, 200000
SX_109:
    buffer_load_dwordx4 v[68:71], v4, s[52:55], s8 offen offset:0 sc1
    s_waitcnt vmcnt(0)
    s_sub_u32 s40, s40, 1
    s_cbranch_scc1 SOK_107
    v_or_b32 v64, v69, v71
    v_cmp_gt_i32 vcc, 0, v64
    s_cbranch_vccnz SX_109
    s_branch SOK_107
SWAIT_111:
    s_mov_b32 s40, 200000
SX_112:
    buffer_load_dwordx4 v[68:71], v4, s[52:55], s8 offen offset:1024 sc1
    s_waitcnt vmcnt(0)
    s_sub_u32 s40, s40, 1
    s_cbranch_scc1 SOK_110
    v_or_b32 v66, v69, v71
    v_cmp_gt_i32 vcc, 0, v66
    s_cbranch_vccnz SX_112
    s_branch SOK_110
FWAIT_114:
    s_mov_b32 s40, 200000
POLL_127:
    buffer_load_dword v14, v13, s[52:55], s75 offen offset:256 sc1
    s_sub_u32 s40, s40, 1
    s_cbranch_scc1 POLLX_128
    s_waitcnt vmcnt(0)
    v_cmp_gt_u32 vcc, 1, v14
    s_cbranch_vccnz POLL_127
POLLX_128:
    s_waitcnt vmcnt(0)
    s_branch FOK_113
FWAIT_116:
    s_mov_b32 s40, 200000
POLL_129:
    buffer_load_dword v14, v13, s[52:55], s75 offen offset:256 sc1
    s_sub_u32 s40, s40, 1
    s_cbranch_scc1 POLLX_130
    s_waitcnt vmcnt(0)
    v_cmp_gt_u32 vcc, 2, v14
    s_cbranch_vccnz POLL_129
POLLX_130:
    s_waitcnt vmcnt(0)
    s_branch FOK_115
K_END:
    s_endpgm

.section .rodata,"a"
.p2align 6
.amdhsa_kernel interleave_layers__ssm_conv_h3__dense_activation_squared_relu__prompt_kernel
  .amdhsa_next_free_vgpr 512
  .amdhsa_next_free_sgpr 102
  .amdhsa_accum_offset 256
  .amdhsa_group_segment_fixed_size 0
  .amdhsa_kernarg_size 112
  .amdhsa_user_sgpr_count 2
  .amdhsa_user_sgpr_kernarg_segment_ptr 1
  .amdhsa_system_sgpr_workgroup_id_x 1
  .amdhsa_float_denorm_mode_32 3
.end_amdhsa_kernel
```
